```python
import torch

def _softmax(x, axis=-1):
    return torch.softmax(x, dim=axis)
def _gelu(x):
    return torch.nn.functional.gelu(x, approximate="tanh")
def _silu(x):
    return torch.nn.functional.silu(x)
def _sigmoid(x):
    return torch.sigmoid(x)
def _layernorm(x, axis=-1, eps=1e-5):
    m = x.mean(dim=axis, keepdim=True)
    v = x.var(dim=axis, keepdim=True, unbiased=False)
    return (x - m) / torch.sqrt(v + eps)
def _scatter_add(tgt, idx, src, axis=0):
    return tgt.clone().index_add_(axis, idx, src)
def _segment_sum(src, seg, n):
    out = torch.zeros((n,) + src.shape[1:], dtype=src.dtype)
    return out.index_add_(0, seg, src)
def _pad(x, pw):
    flat = tuple(v for pair in reversed(pw) for v in pair)
    return torch.nn.functional.pad(x, flat)

kernel_name = 'sequential_preLN__softmax_full_mha__glu_gated_reglu__prompt'

def setup_inputs():

    _w = (lambda a: (lambda t: t.to(torch.bfloat16) if t.is_floating_point() else t)(torch.as_tensor(a)))
    def _A_setup():
        B, S, D = 1, 2048, 576
        return {
            "x": _w((lambda *s: torch.randn(*s, dtype=torch.bfloat16) * 0.05)(B, S, D)),
            "wqkv": _w((lambda *s: torch.randn(*s, dtype=torch.bfloat16) * 0.05)(D, 3 * D)),
            "wo": _w((lambda *s: torch.randn(*s, dtype=torch.bfloat16) * 0.05)(D, D)),
        }
    _A_in = _A_setup()

    def _B_setup():
        B, S, D, F = 1, 2048, 576, 4608
        return {
            "x": _w((lambda *s: torch.randn(*s, dtype=torch.bfloat16) * 0.05)(B, S, D)),
            "W_gate": _w((lambda *s: torch.randn(*s, dtype=torch.bfloat16) * 0.4)(D, F) * (2.0 / D) ** 0.5),
            "W_up": _w((lambda *s: torch.randn(*s, dtype=torch.bfloat16) * 0.4)(D, F) * (2.0 / D) ** 0.5),
            "W_down": _w((lambda *s: torch.randn(*s, dtype=torch.bfloat16) * 0.4)(F, D) * (1.0 / F) ** 0.5),
        }
    _B_in = _B_setup()

    return {
        "A_x": _A_in["x"],
        "A_wqkv": _A_in["wqkv"],
        "A_wo": _A_in["wo"],
        "B_x": _B_in["x"],
        "B_W_gate": _B_in["W_gate"],
        "B_W_up": _B_in["W_up"],
        "B_W_down": _B_in["W_down"],
    }

def reference(A_x, A_wqkv, A_wo, B_x, B_W_gate, B_W_up, B_W_down):
    def _A_ref(x, wqkv, wo):
        B, S, D = x.shape
        H = 32; Dh = D // H
        qkv = (lambda x, *d: x.permute(*d))((x @ wqkv).reshape(B, S, 3, H, Dh), 2, 0, 3, 1, 4)
        q, k, v = qkv[0], qkv[1], qkv[2]
        scale = Dh ** -0.5
        scores = torch.einsum("bhqd,bhkd->bhqk", q, k) * scale
        p = _softmax(scores, axis=-1)
        o = torch.einsum("bhqk,bhkd->bhqd", p, v)
        return (lambda x, *d: x.permute(*d))(o, 0, 2, 1, 3).reshape(B, S, D) @ wo

    def _B_ref(x, W_gate, W_up, W_down):
        gate = torch.einsum("bsd,df->bsf", x, W_gate)
        up = torch.einsum("bsd,df->bsf", x, W_up)
        gate = gate * (lambda x, dt: x.to(dt))(gate > 0, gate.dtype)
        h = gate * up
        return torch.einsum("bsf,fd->bsd", h, W_down)

    x = A_x
    h = x + _A_ref(_layernorm(x, axis=-1), A_wqkv, A_wo)
    h2 = h + _B_ref(_layernorm(h, axis=-1), B_W_gate, B_W_up, B_W_down)
    return h2
```

```asm
; @launch kernel=fused_kernel grid=(256,1,1) block=(512,1,1) lds=161792
.amdgcn_target "amdgcn-amd-amdhsa--gfx950"
.text
.globl fused_kernel
.p2align 8
.type fused_kernel,@function
fused_kernel:
    s_cmp_ge_u32 s2, 256
    s_cbranch_scc1 fused_kernel_end
    s_load_dwordx4 s[4:7], s[0:1], 0
    s_load_dwordx2 s[8:9], s[0:1], 72
    s_load_dwordx2 s[10:11], s[0:1], 64
    s_cmp_ge_u32 s2, 192
    s_cbranch_scc1 fused_kernel_p1_aux
    v_lshrrev_b32 v1, 6, v0
    v_and_b32 v2, 63, v0
    v_readfirstlane_b32 s24, v1
    s_bfe_u32 s25, s2, 0x20001
    s_lshl_b32 s25, s25, 2
    s_bfe_u32 s26, s2, 0x20003
    s_add_u32 s25, s25, s26
    s_and_b32 s26, s2, 1
    s_mul_i32 s26, s26, 6
    s_lshr_b32 s27, s2, 5
    s_add_u32 s26, s26, s27
    s_and_b32 s50, s24, 3
    s_lshl_b32 s29, s25, 2
    s_add_u32 s29, s29, s50
    v_and_b32 v1, 31, v2
    s_mov_b32 s56, 0
    s_mov_b32 s57, 0
    s_cmp_ge_u32 s24, 4
    s_cbranch_scc1 fused_kernel_p1_cw
    s_mul_i32 s52, s27, 0
    s_and_b32 s53, s25, 3
    s_mul_i32 s53, s53, 0
    s_add_u32 s52, s52, s53
    s_lshr_b32 s52, s52, 2
    s_cmp_ge_u32 s52, 9
    s_cselect_b32 s53, 9, 0
    s_sub_u32 s52, s52, s53
    s_lshl_b32 s30, s29, 5
    v_lshrrev_b32 v76, 3, v2
    v_add_u32 v101, s30, v76
    v_mul_u32_u24 v101, 1152, v101
    v_lshrrev_b32 v76, 4, v2
    v_and_b32 v77, 7, v2
    v_xor_b32 v76, v76, v77
    v_lshl_add_u32 v101, v76, 4, v101
    v_xor_b32 v102, 64, v101
    v_add_u32 v102, 9216, v102
    v_add_u32 v103, 18432, v101
    v_add_u32 v104, 18432, v102
    s_mul_i32 s32, s50, 5120
    s_lshl_b32 s60, s50, 10
    s_sub_u32 s60, 20480, s60
    s_add_u32 s55, s32, 147456
    s_mul_i32 s33, s52, 221184
    s_lshl_b32 s54, s52, 7
    s_add_u32 s61, s32, s60
    s_add_u32 s63, s27, s25
    s_and_b32 s63, s63, 1
    s_waitcnt lgkmcnt(0)
    s_mov_b32 s12, s4
    s_and_b32 s13, s5, 0xffff
    s_mov_b32 s14, 2359296
    s_mov_b32 s15, 0x20000
    s_add_u32 m0, s61, 0
    s_nop 0
    buffer_load_dwordx4 v101, s[12:15], s54 offen lds
    s_add_u32 m0, s61, 1024
    s_nop 0
    buffer_load_dwordx4 v102, s[12:15], s54 offen lds
    s_add_u32 m0, s61, 2048
    s_nop 0
    buffer_load_dwordx4 v103, s[12:15], s54 offen lds
    s_add_u32 m0, s61, 3072
    s_nop 0
    buffer_load_dwordx4 v104, s[12:15], s54 offen lds
    s_mov_b32 s16, s6
    s_and_b32 s17, s7, 0xffff
    s_mov_b32 s18, 1990656
    s_mov_b32 s19, 0x20000
    s_mul_i32 s30, s50, 55296
    s_mul_i32 s31, s26, 288
    s_add_u32 s30, s30, s31
    s_cmp_ge_u32 s26, 8
    s_cselect_b32 s34, 0, 8
    s_cselect_b32 s36, 16, 72
    s_cselect_b32 s37, 0, 1120
    s_cselect_b32 s41, 18, 20
    s_sub_u32 s37, s30, s37
    s_movk_i32 s35, 3456
    v_mov_b32 v81, 2146435072
    v_mov_b32 v82, s30
    v_mov_b32 v83, s37
    v_add_u32 v76, 0, v2
    v_mul_u32_u24 v77, 3277, v76
    v_lshrrev_b32 v77, 16, v77
    v_mul_u32_u24 v78, 20, v77
    v_sub_u32 v76, v76, v78
    v_add_u32 v78, 2, v76
    v_lshrrev_b32 v78, 2, v78
    v_cmp_gt_u32 vcc, 16, v76
    v_mad_u32_u24 v78, v78, s34, v82
    v_mad_u32_u24 v79, v76, s36, v83
    v_lshl_add_u32 v78, v76, 4, v78
    v_cndmask_b32 v78, v79, v78, vcc
    v_cmp_gt_u32 vcc, s41, v76
    v_mad_u32_u24 v78, v77, s35, v78
    s_add_u32 m0, s32, 0
    v_cndmask_b32 v96, v81, v78, vcc
    buffer_load_dwordx4 v96, s[16:19], s33 offen lds
    v_add_u32 v76, 64, v2
    v_mul_u32_u24 v77, 3277, v76
    v_lshrrev_b32 v77, 16, v77
    v_mul_u32_u24 v78, 20, v77
    v_sub_u32 v76, v76, v78
    v_add_u32 v78, 2, v76
    v_lshrrev_b32 v78, 2, v78
    v_cmp_gt_u32 vcc, 16, v76
    v_mad_u32_u24 v78, v78, s34, v82
    v_mad_u32_u24 v79, v76, s36, v83
    v_lshl_add_u32 v78, v76, 4, v78
    v_cndmask_b32 v78, v79, v78, vcc
    v_cmp_gt_u32 vcc, s41, v76
    v_mad_u32_u24 v78, v77, s35, v78
    s_add_u32 m0, s32, 1024
    v_cndmask_b32 v97, v81, v78, vcc
    buffer_load_dwordx4 v97, s[16:19], s33 offen lds
    v_add_u32 v76, 128, v2
    v_mul_u32_u24 v77, 3277, v76
    v_lshrrev_b32 v77, 16, v77
    v_mul_u32_u24 v78, 20, v77
    v_sub_u32 v76, v76, v78
    v_add_u32 v78, 2, v76
    v_lshrrev_b32 v78, 2, v78
    v_cmp_gt_u32 vcc, 16, v76
    v_mad_u32_u24 v78, v78, s34, v82
    v_mad_u32_u24 v79, v76, s36, v83
    v_lshl_add_u32 v78, v76, 4, v78
    v_cndmask_b32 v78, v79, v78, vcc
    v_cmp_gt_u32 vcc, s41, v76
    v_mad_u32_u24 v78, v77, s35, v78
    s_add_u32 m0, s32, 2048
    v_cndmask_b32 v98, v81, v78, vcc
    buffer_load_dwordx4 v98, s[16:19], s33 offen lds
    v_add_u32 v76, 192, v2
    v_mul_u32_u24 v77, 3277, v76
    v_lshrrev_b32 v77, 16, v77
    v_mul_u32_u24 v78, 20, v77
    v_sub_u32 v76, v76, v78
    v_add_u32 v78, 2, v76
    v_lshrrev_b32 v78, 2, v78
    v_cmp_gt_u32 vcc, 16, v76
    v_mad_u32_u24 v78, v78, s34, v82
    v_mad_u32_u24 v79, v76, s36, v83
    v_lshl_add_u32 v78, v76, 4, v78
    v_cndmask_b32 v78, v79, v78, vcc
    v_cmp_gt_u32 vcc, s41, v76
    v_mad_u32_u24 v78, v77, s35, v78
    s_add_u32 m0, s32, 3072
    v_cndmask_b32 v99, v81, v78, vcc
    buffer_load_dwordx4 v99, s[16:19], s33 offen lds
    v_add_u32 v76, 256, v2
    v_mul_u32_u24 v77, 3277, v76
    v_lshrrev_b32 v77, 16, v77
    v_mul_u32_u24 v78, 20, v77
    v_sub_u32 v76, v76, v78
    v_add_u32 v78, 2, v76
    v_lshrrev_b32 v78, 2, v78
    v_cmp_gt_u32 vcc, 16, v76
    v_mad_u32_u24 v78, v78, s34, v82
    v_mad_u32_u24 v79, v76, s36, v83
    v_lshl_add_u32 v78, v76, 4, v78
    v_cndmask_b32 v78, v79, v78, vcc
    v_cmp_gt_u32 vcc, s41, v76
    v_mad_u32_u24 v78, v77, s35, v78
    s_add_u32 m0, s32, 4096
    v_cndmask_b32 v100, v81, v78, vcc
    buffer_load_dwordx4 v100, s[16:19], s33 offen lds
    s_add_u32 s32, s32, 36864
    s_cmp_ge_u32 s32, s55
    s_cselect_b32 s34, 147456, 0
    s_sub_u32 s32, s32, s34
    s_add_u32 s61, s32, s60
    s_add_u32 s52, s52, 1
    s_cmp_eq_u32 s52, 9
    s_cselect_b32 s52, 0, s52
    s_sub_u32 s34, s52, 1
    s_xor_b32 s34, s34, s63
    s_add_u32 s34, s34, 1
    s_mul_i32 s33, s34, 221184
    s_lshl_b32 s54, s34, 7
    s_add_u32 m0, s61, 0
    s_nop 0
    buffer_load_dwordx4 v101, s[12:15], s54 offen lds
    s_add_u32 m0, s61, 1024
    s_nop 0
    buffer_load_dwordx4 v102, s[12:15], s54 offen lds
    s_add_u32 m0, s61, 2048
    s_nop 0
    buffer_load_dwordx4 v103, s[12:15], s54 offen lds
    s_add_u32 m0, s61, 3072
    s_nop 0
    buffer_load_dwordx4 v104, s[12:15], s54 offen lds
    s_add_u32 m0, s32, 0
    s_nop 0
    buffer_load_dwordx4 v96, s[16:19], s33 offen lds
    s_add_u32 m0, s32, 1024
    s_nop 0
    buffer_load_dwordx4 v97, s[16:19], s33 offen lds
    s_add_u32 m0, s32, 2048
    s_nop 0
    buffer_load_dwordx4 v98, s[16:19], s33 offen lds
    s_add_u32 m0, s32, 3072
    s_nop 0
    buffer_load_dwordx4 v99, s[16:19], s33 offen lds
    s_add_u32 m0, s32, 4096
    s_nop 0
    buffer_load_dwordx4 v100, s[16:19], s33 offen lds
    s_add_u32 s32, s32, 36864
    s_cmp_ge_u32 s32, s55
    s_cselect_b32 s34, 147456, 0
    s_sub_u32 s32, s32, s34
    s_add_u32 s61, s32, s60
    s_add_u32 s52, s52, 1
    s_cmp_eq_u32 s52, 9
    s_cselect_b32 s52, 0, s52
    s_sub_u32 s34, s52, 1
    s_xor_b32 s34, s34, s63
    s_add_u32 s34, s34, 1
    s_mul_i32 s33, s34, 221184
    s_lshl_b32 s54, s34, 7
    s_mov_b32 s20, s8
    s_and_b32 s21, s9, 0xffff
    s_mov_b32 s22, 71303168
    s_mov_b32 s23, 0x20000
fused_kernel_p1_ld:
    s_mov_b32 s39, 0xffff0000
    s_setprio 3
    s_waitcnt vmcnt(9)
    s_barrier
    s_add_u32 m0, s61, 0
    s_nop 0
    buffer_load_dwordx4 v101, s[12:15], s54 offen lds
    s_add_u32 m0, s61, 1024
    s_nop 0
    buffer_load_dwordx4 v102, s[12:15], s54 offen lds
    s_add_u32 m0, s61, 2048
    s_nop 0
    buffer_load_dwordx4 v103, s[12:15], s54 offen lds
    s_add_u32 m0, s61, 3072
    s_nop 0
    buffer_load_dwordx4 v104, s[12:15], s54 offen lds
    s_add_u32 m0, s32, 0
    s_nop 0
    buffer_load_dwordx4 v96, s[16:19], s33 offen lds
    s_add_u32 m0, s32, 1024
    s_nop 0
    buffer_load_dwordx4 v97, s[16:19], s33 offen lds
    s_add_u32 m0, s32, 2048
    s_nop 0
    buffer_load_dwordx4 v98, s[16:19], s33 offen lds
    s_add_u32 m0, s32, 3072
    s_nop 0
    buffer_load_dwordx4 v99, s[16:19], s33 offen lds
    s_add_u32 m0, s32, 4096
    s_nop 0
    buffer_load_dwordx4 v100, s[16:19], s33 offen lds
    s_add_u32 s32, s32, 36864
    s_cmp_ge_u32 s32, s55
    s_cselect_b32 s34, 147456, 0
    s_sub_u32 s32, s32, s34
    s_add_u32 s61, s32, s60
    s_add_u32 s52, s52, 1
    s_cmp_eq_u32 s52, 9
    s_cselect_b32 s52, 0, s52
    s_sub_u32 s34, s52, 1
    s_xor_b32 s34, s34, s63
    s_add_u32 s34, s34, 1
    s_mul_i32 s33, s34, 221184
    s_lshl_b32 s54, s34, 7
fused_kernel_p1_LL:
    s_waitcnt vmcnt(9)
    s_barrier
    s_add_u32 m0, s61, 0
    s_nop 0
    buffer_load_dwordx4 v101, s[12:15], s54 offen lds
    s_add_u32 m0, s61, 1024
    s_nop 0
    buffer_load_dwordx4 v102, s[12:15], s54 offen lds
    s_add_u32 m0, s61, 2048
    s_nop 0
    buffer_load_dwordx4 v103, s[12:15], s54 offen lds
    s_add_u32 m0, s61, 3072
    s_nop 0
    buffer_load_dwordx4 v104, s[12:15], s54 offen lds
    s_add_u32 m0, s32, 0
    s_nop 0
    buffer_load_dwordx4 v96, s[16:19], s33 offen lds
    s_add_u32 m0, s32, 1024
    s_nop 0
    buffer_load_dwordx4 v97, s[16:19], s33 offen lds
    s_add_u32 m0, s32, 2048
    s_nop 0
    buffer_load_dwordx4 v98, s[16:19], s33 offen lds
    s_add_u32 m0, s32, 3072
    s_nop 0
    buffer_load_dwordx4 v99, s[16:19], s33 offen lds
    s_add_u32 m0, s32, 4096
    s_nop 0
    buffer_load_dwordx4 v100, s[16:19], s33 offen lds
    s_add_u32 s32, s32, 36864
    s_cmp_ge_u32 s32, s55
    s_cselect_b32 s34, 147456, 0
    s_sub_u32 s32, s32, s34
    s_add_u32 s61, s32, s60
    s_add_u32 s52, s52, 1
    s_cmp_eq_u32 s52, 9
    s_cselect_b32 s52, 0, s52
    s_sub_u32 s34, s52, 1
    s_xor_b32 s34, s34, s63
    s_add_u32 s34, s34, 1
    s_mul_i32 s33, s34, 221184
    s_lshl_b32 s54, s34, 7
    s_add_u32 s56, s56, 1
    s_cmp_lt_u32 s56, 6
    s_cbranch_scc1 fused_kernel_p1_LL
    s_mov_b32 s40, s10
    s_and_b32 s41, s11, 0xffff
    s_mov_b32 s42, 256
    s_mov_b32 s43, 0x20000
    s_lshl_b32 s45, s29, 8
    s_add_u32 s45, s45, 67633152
    s_mul_i32 s46, s26, 144
    s_lshr_b32 s47, s46, 6
    s_add_u32 s48, s46, 143
    s_lshr_b32 s48, s48, 6
    s_add_u32 s47, s47, 31
    s_add_u32 s48, s48, 32
    s_lshr_b32 s49, s29, 1
    v_add_u32 v76, s47, v2
    v_min_u32 v76, s48, v76
    v_mov_b32 v77, s49
    v_cmp_eq_u32 vcc, 0, v2
    s_nop 1
    v_cndmask_b32 v76, v76, v77, vcc
    v_mov_b32 v77, 91
    v_cmp_eq_u32 vcc, 5, v2
    s_nop 1
    v_cndmask_b32 v76, v76, v77, vcc
    v_lshlrev_b32 v76, 1, v76
    v_lshlrev_b32 v77, 2, v2
    s_cmp_ge_u32 s26, 8
    s_cselect_b32 s47, 32, 36
    s_cselect_b32 s48, 0, 4
    s_cselect_b32 s49, 4, 36
    s_cselect_b32 s51, 128, 16
    s_mul_i32 s47, s47, s50
    v_lshrrev_b32 v80, 4, v1
    v_mul_u32_u24 v80, s48, v80
    v_add3_u32 v80, v80, v1, s47
    v_bfe_u32 v81, v2, 2, 2
    v_mul_u32_u24 v81, s49, v81
    v_and_b32 v82, 3, v2
    v_add3_u32 v81, v81, v82, s51
    v_cmp_gt_u32 vcc, 32, v2
    s_nop 1
    v_cndmask_b32 v80, v81, v80, vcc
    v_lshlrev_b32 v80, 2, v80
    s_lshl_b32 s46, s46, 2
    s_add_u32 s46, s46, 67698688
    s_lshl_b32 s47, s50, 8
    v_mov_b32 v81, 1024
    v_mov_b32 v82, s47
    v_cndmask_b32 v81, v81, v82, vcc
    v_lshl_add_u32 v81, v1, 3, v81
    v_add_u32 v81, 147456, v81
    s_lshl_b32 s47, s50, 9
    s_add_u32 s47, s47, 148992
    v_lshl_add_u32 v82, v2, 3, s47
    s_lshl_b32 s47, s50, 7
    s_add_u32 s47, s47, 151040
    v_lshl_add_u32 v83, v1, 2, s47
    s_waitcnt vmcnt(9)
    s_barrier
    buffer_load_ushort v79, v76, s[40:43], 0 offen sc1
    s_mov_b32 s57, 0
    s_waitcnt vmcnt(1)
    s_barrier
    s_waitcnt vmcnt(0)
    v_cmp_ne_u32 vcc, 1, v79
    s_nop 0
    s_cbranch_vccz fused_kernel_p1_sq
fused_kernel_p1_sp:
    buffer_load_ushort v79, v76, s[40:43], 0 offen sc1
    s_add_u32 s57, s57, 1
    s_waitcnt vmcnt(0)
    v_cmp_ne_u32 vcc, 1, v79
    s_cmp_gt_u32 s57, 0x40000
    s_cbranch_scc1 fused_kernel_p1_sq
    s_cbranch_vccz fused_kernel_p1_sq
    s_sleep 3
    s_branch fused_kernel_p1_sp
fused_kernel_p1_sq:
    buffer_load_dword v79, v77, s[20:23], s45 offen sc1
    buffer_load_dword v78, v80, s[20:23], s46 offen sc1
    v_cmp_gt_u32 vcc, 32, v2
    s_waitcnt vmcnt(0)
    v_cvt_pk_bf16_f32 v85, v78, 0
    v_cndmask_b32 v88, 0, v79, vcc
    v_lshlrev_b32 v84, 16, v85
    v_cvt_pk_bf16_f32 v86, v88, v88
    v_sub_f32 v84, v78, v84
    v_and_b32 v87, s39, v86
    v_cvt_pk_bf16_f32 v84, v78, v84
    v_sub_f32 v87, v88, v87
    ds_write_b64 v81, v[84:85]
    v_cvt_pk_bf16_f32 v87, v87, 0
    s_mov_b32 exec_lo, 0
    ds_write_b32 v83, v79
    s_mov_b32 exec_lo, -1
    ds_write_b64 v82, v[86:87]
    s_waitcnt lgkmcnt(0)
    s_barrier
    s_setprio 0
    s_branch fused_kernel_p1_done
fused_kernel_p1_cw:
    s_waitcnt lgkmcnt(0)
    s_mov_b32 s20, s8
    s_and_b32 s21, s9, 0xffff
    s_mov_b32 s22, 71303168
    s_mov_b32 s23, 0x20000
    s_cmp_ge_u32 s26, 8
    s_cselect_b32 s42, 3, 4
    v_and_b32 v76, 15, v2
    v_lshrrev_b32 v77, 2, v76
    v_lshrrev_b32 v78, 5, v2
    v_lshl_add_u32 v77, v78, 3, v77
    v_mul_u32_u24 v77, 320, v77
    v_and_b32 v76, 3, v76
    v_bfe_u32 v79, v2, 4, 1
    v_lshl_add_u32 v79, v79, 5, v77
    v_lshl_add_u32 v4, v76, 3, v79
    v_lshlrev_b32 v76, s42, v76
    v_add_u32 v5, v76, v77
    v_bfe_u32 v80, v2, 1, 3
    v_xor_b32 v80, v80, v78
    v_lshlrev_b32 v80, 4, v80
    v_lshl_add_u32 v80, v1, 7, v80
    s_lshl_b32 s44, s50, 12
    s_add_u32 s44, s44, 20480
    v_add_u32 v8, s44, v80
    v_xor_b32 v9, 32, v8
    v_xor_b32 v10, 64, v8
    v_xor_b32 v11, 96, v8
    v_lshlrev_b32 v246, 3, v1
    v_add_u32 v246, 147456, v246
    s_lshl_b32 s45, s50, 9
    s_add_u32 s45, s45, 148992
    v_lshl_add_u32 v247, v2, 3, s45
    s_lshl_b32 s45, s50, 7
    s_add_u32 s45, s45, 151040
    v_lshl_add_u32 v248, v1, 2, s45
    v_lshl_add_u32 v249, v78, 4, s45
    s_cmp_lt_u32 s26, 4
    s_cselect_b32 s41, 0x3eae1a93, 1.0
    v_lshlrev_b32 v3, 4, v2
    s_mul_i32 s48, s50, 9216
    s_add_u32 s48, s48, 36864
    v_mov_b32 v40, 0
    v_mov_b32 v41, 0
    v_mov_b32 v42, 0
    v_mov_b32 v43, 0
    v_mov_b32 v44, 0
    v_mov_b32 v45, 0
    v_mov_b32 v46, 0
    v_mov_b32 v47, 0
    v_mov_b32 v48, 0
    v_mov_b32 v49, 0
    v_mov_b32 v50, 0
    v_mov_b32 v51, 0
    v_mov_b32 v52, 0
    v_mov_b32 v53, 0
    v_mov_b32 v54, 0
    v_mov_b32 v55, 0
    v_mov_b32 v56, 0
    v_mov_b32 v57, 0
    v_mov_b32 v58, 0
    v_mov_b32 v59, 0
    v_mov_b32 v60, 0
    v_mov_b32 v61, 0
    v_mov_b32 v62, 0
    v_mov_b32 v63, 0
    v_mov_b32 v96, 0
    v_mov_b32 v97, 0
    v_mov_b32 v98, 0
    v_mov_b32 v99, 0
    v_mov_b32 v100, 0
    v_mov_b32 v101, 0
    v_mov_b32 v102, 0
    v_mov_b32 v103, 0
    v_mov_b32 v104, 0
    v_mov_b32 v105, 0
    v_mov_b32 v106, 0
    v_mov_b32 v107, 0
    v_mov_b32 v108, 0
    v_mov_b32 v109, 0
    v_mov_b32 v110, 0
    v_mov_b32 v111, 0
    v_mov_b32 v112, 0
    v_mov_b32 v113, 0
    v_mov_b32 v114, 0
    v_mov_b32 v115, 0
    v_mov_b32 v116, 0
    v_mov_b32 v117, 0
    v_mov_b32 v118, 0
    v_mov_b32 v119, 0
    v_mov_b32 v120, 0
    v_mov_b32 v121, 0
    v_mov_b32 v122, 0
    v_mov_b32 v123, 0
    v_mov_b32 v124, 0
    v_mov_b32 v125, 0
    v_mov_b32 v126, 0
    v_mov_b32 v127, 0
    v_mov_b32 v128, 0
    v_mov_b32 v129, 0
    v_mov_b32 v130, 0
    v_mov_b32 v131, 0
    v_mov_b32 v132, 0
    v_mov_b32 v133, 0
    v_mov_b32 v134, 0
    v_mov_b32 v135, 0
    v_mov_b32 v136, 0
    v_mov_b32 v137, 0
    v_mov_b32 v138, 0
    v_mov_b32 v139, 0
    v_mov_b32 v140, 0
    v_mov_b32 v141, 0
    v_mov_b32 v142, 0
    v_mov_b32 v143, 0
    v_mov_b32 v144, 0
    v_mov_b32 v145, 0
    v_mov_b32 v146, 0
    v_mov_b32 v147, 0
    v_mov_b32 v148, 0
    v_mov_b32 v149, 0
    v_mov_b32 v150, 0
    v_mov_b32 v151, 0
    v_mov_b32 v152, 0
    v_mov_b32 v153, 0
    v_mov_b32 v154, 0
    v_mov_b32 v155, 0
    v_mov_b32 v156, 0
    v_mov_b32 v157, 0
    v_mov_b32 v158, 0
    v_mov_b32 v159, 0
    v_mov_b32 v160, 0
    v_mov_b32 v161, 0
    v_mov_b32 v162, 0
    v_mov_b32 v163, 0
    v_mov_b32 v164, 0
    v_mov_b32 v165, 0
    v_mov_b32 v166, 0
    v_mov_b32 v167, 0
    v_mov_b32 v168, 0
    v_mov_b32 v169, 0
    v_mov_b32 v170, 0
    v_mov_b32 v171, 0
    v_mov_b32 v172, 0
    v_mov_b32 v173, 0
    v_mov_b32 v174, 0
    v_mov_b32 v175, 0
    s_cmp_ge_u32 s26, 8
    s_cbranch_scc1 fused_kernel_p1_mv
    s_cmp_ge_u32 s26, 4
    s_mov_b32 s42, 65536
    s_cselect_b32 s42, 147456, s42
    s_mov_b32 s43, 8192
    s_cselect_b32 s43, 147456, s43
    s_lshr_b32 s44, s29, 3
    s_mul_i32 s44, s44, 18432
    s_add_u32 s44, s44, 2359296
    s_and_b32 s45, s29, 7
    s_lshl_b32 s46, s45, 7
    s_lshl_b32 s45, s45, 10
    s_add_u32 s45, s45, s44
    s_add_u32 s44, s44, s46
    s_add_u32 s44, s44, 8192
    s_lshl_b32 s46, s29, 10
    s_add_u32 s46, s46, 0
    s_lshl_b32 s47, s29, 7
    s_add_u32 s47, s47, 2097152
    s_cmp_ge_u32 s26, 4
    s_cselect_b32 s45, s45, s46
    s_cselect_b32 s44, s44, s47
    s_and_b32 s46, s26, 3
    s_lshl_b32 s46, s46, 3
    s_mul_i32 s47, s46, s43
    s_add_u32 s44, s44, s47
    s_mul_i32 s47, s46, s42
    s_add_u32 s45, s45, s47
    v_lshlrev_b32 v232, 8, v78
    v_lshl_add_u32 v232, v1, 2, v232
    v_add_u32 v232, s48, v232
    v_add_u32 v233, s48, v3
    v_lshrrev_b32 v234, 3, v2
    v_mul_lo_u32 v234, v234, s43
    v_and_b32 v81, 7, v2
    v_lshl_add_u32 v234, v81, 4, v234
    s_barrier
    ds_read_b128 v[12:15], v8
    ds_read_b64_tr_b16 v[20:21], v4 offset:0
    ds_read_b64_tr_b16 v[22:23], v4 offset:1280
    ds_read_b64_tr_b16 v[24:25], v4 offset:64
    ds_read_b64_tr_b16 v[26:27], v4 offset:1344
    ds_read_b64_tr_b16 v[28:29], v4 offset:128
    ds_read_b64_tr_b16 v[30:31], v4 offset:1408
    ds_read_b64_tr_b16 v[32:33], v4 offset:192
    ds_read_b64_tr_b16 v[34:35], v4 offset:1472
    ds_read_b64_tr_b16 v[36:37], v5 offset:256
    ds_read_b64_tr_b16 v[38:39], v5 offset:1536
.p2align 4
fused_kernel_p1_L0:
    s_add_u32 s57, s57, 1
    s_and_b32 s57, s57, 3
    s_cmp_eq_u32 s57, 0
    s_mov_b32 s59, 36864
    s_cselect_b32 s59, 4294856704, s59
    s_waitcnt lgkmcnt(8)
    v_mfma_f32_32x32x16_bf16 v[96:111], v[20:23], v[12:15], v[96:111]
    ds_read_b128 v[16:19], v9
    ds_read_b64_tr_b16 v[20:21], v4 offset:5120
    ds_read_b64_tr_b16 v[22:23], v4 offset:6400
    s_waitcnt lgkmcnt(9)
    v_mfma_f32_32x32x16_bf16 v[112:127], v[24:27], v[12:15], v[112:127]
    ds_read_b64_tr_b16 v[24:25], v4 offset:5184
    ds_read_b64_tr_b16 v[26:27], v4 offset:6464
    s_waitcnt lgkmcnt(9)
    v_mfma_f32_32x32x16_bf16 v[128:143], v[28:31], v[12:15], v[128:143]
    ds_read_b64_tr_b16 v[28:29], v4 offset:5248
    ds_read_b64_tr_b16 v[30:31], v4 offset:6528
    v_add_u32 v8, s59, v8
    s_waitcnt lgkmcnt(9)
    v_mfma_f32_32x32x16_bf16 v[144:159], v[32:35], v[12:15], v[144:159]
    ds_read_b64_tr_b16 v[32:33], v4 offset:5312
    ds_read_b64_tr_b16 v[34:35], v4 offset:6592
    s_waitcnt lgkmcnt(9)
    v_mfma_f32_32x32x16_bf16 v[160:175], v[36:39], v[12:15], v[160:175]
    ds_read_b64_tr_b16 v[36:37], v5 offset:5376
    ds_read_b64_tr_b16 v[38:39], v5 offset:6656
    s_waitcnt lgkmcnt(8)
    v_mfma_f32_32x32x16_bf16 v[96:111], v[20:23], v[16:19], v[96:111]
    ds_read_b128 v[12:15], v10
    ds_read_b64_tr_b16 v[20:21], v4 offset:10240
    ds_read_b64_tr_b16 v[22:23], v4 offset:11520
    s_waitcnt lgkmcnt(9)
    v_mfma_f32_32x32x16_bf16 v[112:127], v[24:27], v[16:19], v[112:127]
    ds_read_b64_tr_b16 v[24:25], v4 offset:10304
    ds_read_b64_tr_b16 v[26:27], v4 offset:11584
    s_waitcnt lgkmcnt(9)
    v_mfma_f32_32x32x16_bf16 v[128:143], v[28:31], v[16:19], v[128:143]
    ds_read_b64_tr_b16 v[28:29], v4 offset:10368
    ds_read_b64_tr_b16 v[30:31], v4 offset:11648
    v_add_u32 v9, s59, v9
    s_waitcnt lgkmcnt(9)
    v_mfma_f32_32x32x16_bf16 v[144:159], v[32:35], v[16:19], v[144:159]
    ds_read_b64_tr_b16 v[32:33], v4 offset:10432
    ds_read_b64_tr_b16 v[34:35], v4 offset:11712
    s_waitcnt lgkmcnt(9)
    v_mfma_f32_32x32x16_bf16 v[160:175], v[36:39], v[16:19], v[160:175]
    ds_read_b64_tr_b16 v[36:37], v5 offset:10496
    ds_read_b64_tr_b16 v[38:39], v5 offset:11776
    s_waitcnt lgkmcnt(8)
    v_mfma_f32_32x32x16_bf16 v[96:111], v[20:23], v[12:15], v[96:111]
    s_cmp_eq_u32 s56, 8
    s_cbranch_scc1 fused_kernel_p1_L0_nb
    s_barrier
fused_kernel_p1_L0_nb:
    ds_read_b128 v[16:19], v11
    ds_read_b64_tr_b16 v[20:21], v4 offset:15360
    ds_read_b64_tr_b16 v[22:23], v4 offset:16640
    s_waitcnt lgkmcnt(9)
    v_mfma_f32_32x32x16_bf16 v[112:127], v[24:27], v[12:15], v[112:127]
    ds_read_b64_tr_b16 v[24:25], v4 offset:15424
    ds_read_b64_tr_b16 v[26:27], v4 offset:16704
    s_waitcnt lgkmcnt(9)
    v_mfma_f32_32x32x16_bf16 v[128:143], v[28:31], v[12:15], v[128:143]
    ds_read_b64_tr_b16 v[28:29], v4 offset:15488
    ds_read_b64_tr_b16 v[30:31], v4 offset:16768
    v_add_u32 v10, s59, v10
    s_waitcnt lgkmcnt(9)
    v_mfma_f32_32x32x16_bf16 v[144:159], v[32:35], v[12:15], v[144:159]
    ds_read_b64_tr_b16 v[32:33], v4 offset:15552
    ds_read_b64_tr_b16 v[34:35], v4 offset:16832
    s_waitcnt lgkmcnt(9)
    v_mfma_f32_32x32x16_bf16 v[160:175], v[36:39], v[12:15], v[160:175]
    ds_read_b64_tr_b16 v[36:37], v5 offset:15616
    ds_read_b64_tr_b16 v[38:39], v5 offset:16896
    s_waitcnt lgkmcnt(8)
    v_mfma_f32_32x32x16_bf16 v[96:111], v[20:23], v[16:19], v[96:111]
    v_add_u32 v4, s59, v4
    v_add_u32 v5, s59, v5
    ds_read_b128 v[12:15], v8
    ds_read_b64_tr_b16 v[20:21], v4 offset:0
    ds_read_b64_tr_b16 v[22:23], v4 offset:1280
    s_waitcnt lgkmcnt(9)
    v_mfma_f32_32x32x16_bf16 v[112:127], v[24:27], v[16:19], v[112:127]
    ds_read_b64_tr_b16 v[24:25], v4 offset:64
    ds_read_b64_tr_b16 v[26:27], v4 offset:1344
    s_waitcnt lgkmcnt(9)
    v_mfma_f32_32x32x16_bf16 v[128:143], v[28:31], v[16:19], v[128:143]
    ds_read_b64_tr_b16 v[28:29], v4 offset:128
    ds_read_b64_tr_b16 v[30:31], v4 offset:1408
    v_add_u32 v11, s59, v11
    s_waitcnt lgkmcnt(9)
    v_mfma_f32_32x32x16_bf16 v[144:159], v[32:35], v[16:19], v[144:159]
    ds_read_b64_tr_b16 v[32:33], v4 offset:192
    ds_read_b64_tr_b16 v[34:35], v4 offset:1472
    s_waitcnt lgkmcnt(9)
    v_mfma_f32_32x32x16_bf16 v[160:175], v[36:39], v[16:19], v[160:175]
    ds_read_b64_tr_b16 v[36:37], v5 offset:256
    ds_read_b64_tr_b16 v[38:39], v5 offset:1536
    s_add_u32 s56, s56, 1
    s_cmp_lt_u32 s56, 9
    s_cbranch_scc1 fused_kernel_p1_L0
    s_barrier
    s_waitcnt lgkmcnt(4)
    ds_read_b64 v[60:61], v247
    ds_read_b64 v[40:41], v246 offset:0
    ds_read_b64 v[44:45], v246 offset:256
    ds_read_b64 v[48:49], v246 offset:512
    ds_read_b64 v[52:53], v246 offset:768
    ds_read_b64 v[56:57], v246 offset:1024
    ds_read_b32 v77, v248
    s_waitcnt lgkmcnt(5)
    v_mfma_f32_32x32x16_bf16 v[96:111], v[40:43], v[60:63], v[96:111]
    s_waitcnt lgkmcnt(4)
    v_mfma_f32_32x32x16_bf16 v[112:127], v[44:47], v[60:63], v[112:127]
    s_waitcnt lgkmcnt(3)
    v_mfma_f32_32x32x16_bf16 v[128:143], v[48:51], v[60:63], v[128:143]
    s_waitcnt lgkmcnt(2)
    v_mfma_f32_32x32x16_bf16 v[144:159], v[52:55], v[60:63], v[144:159]
    s_waitcnt lgkmcnt(1)
    v_mfma_f32_32x32x16_bf16 v[160:175], v[56:59], v[60:63], v[160:175]
    s_waitcnt lgkmcnt(0)
    v_mul_f32 v77, s41, v77
    s_nop 1
    v_pk_mul_f32 v[96:97], v[96:97], v[76:77] op_sel:[0,1] op_sel_hi:[1,1]
    v_pk_mul_f32 v[98:99], v[98:99], v[76:77] op_sel:[0,1] op_sel_hi:[1,1]
    v_pk_mul_f32 v[100:101], v[100:101], v[76:77] op_sel:[0,1] op_sel_hi:[1,1]
    v_pk_mul_f32 v[102:103], v[102:103], v[76:77] op_sel:[0,1] op_sel_hi:[1,1]
    v_cvt_pk_bf16_f32 v192, v96, v97
    v_cvt_pk_bf16_f32 v193, v98, v99
    v_cvt_pk_bf16_f32 v194, v100, v101
    v_cvt_pk_bf16_f32 v195, v102, v103
    buffer_store_dwordx4 v[192:195], v3, s[20:23], s45 offen sc1
    s_add_u32 s45, s45, s42
    v_pk_mul_f32 v[104:105], v[104:105], v[76:77] op_sel:[0,1] op_sel_hi:[1,1]
    v_pk_mul_f32 v[106:107], v[106:107], v[76:77] op_sel:[0,1] op_sel_hi:[1,1]
    v_pk_mul_f32 v[108:109], v[108:109], v[76:77] op_sel:[0,1] op_sel_hi:[1,1]
    v_pk_mul_f32 v[110:111], v[110:111], v[76:77] op_sel:[0,1] op_sel_hi:[1,1]
    v_cvt_pk_bf16_f32 v196, v104, v105
    v_cvt_pk_bf16_f32 v197, v106, v107
    v_cvt_pk_bf16_f32 v198, v108, v109
    v_cvt_pk_bf16_f32 v199, v110, v111
    buffer_store_dwordx4 v[196:199], v3, s[20:23], s45 offen sc1
    s_add_u32 s45, s45, s42
    v_pk_mul_f32 v[112:113], v[112:113], v[76:77] op_sel:[0,1] op_sel_hi:[1,1]
    v_pk_mul_f32 v[114:115], v[114:115], v[76:77] op_sel:[0,1] op_sel_hi:[1,1]
    v_pk_mul_f32 v[116:117], v[116:117], v[76:77] op_sel:[0,1] op_sel_hi:[1,1]
    v_pk_mul_f32 v[118:119], v[118:119], v[76:77] op_sel:[0,1] op_sel_hi:[1,1]
    v_cvt_pk_bf16_f32 v200, v112, v113
    v_cvt_pk_bf16_f32 v201, v114, v115
    v_cvt_pk_bf16_f32 v202, v116, v117
    v_cvt_pk_bf16_f32 v203, v118, v119
    buffer_store_dwordx4 v[200:203], v3, s[20:23], s45 offen sc1
    s_add_u32 s45, s45, s42
    v_pk_mul_f32 v[120:121], v[120:121], v[76:77] op_sel:[0,1] op_sel_hi:[1,1]
    v_pk_mul_f32 v[122:123], v[122:123], v[76:77] op_sel:[0,1] op_sel_hi:[1,1]
    v_pk_mul_f32 v[124:125], v[124:125], v[76:77] op_sel:[0,1] op_sel_hi:[1,1]
    v_pk_mul_f32 v[126:127], v[126:127], v[76:77] op_sel:[0,1] op_sel_hi:[1,1]
    v_cvt_pk_bf16_f32 v204, v120, v121
    v_cvt_pk_bf16_f32 v205, v122, v123
    v_cvt_pk_bf16_f32 v206, v124, v125
    v_cvt_pk_bf16_f32 v207, v126, v127
    buffer_store_dwordx4 v[204:207], v3, s[20:23], s45 offen sc1
    s_add_u32 s45, s45, s42
    v_pk_mul_f32 v[128:129], v[128:129], v[76:77] op_sel:[0,1] op_sel_hi:[1,1]
    v_pk_mul_f32 v[130:131], v[130:131], v[76:77] op_sel:[0,1] op_sel_hi:[1,1]
    v_pk_mul_f32 v[132:133], v[132:133], v[76:77] op_sel:[0,1] op_sel_hi:[1,1]
    v_pk_mul_f32 v[134:135], v[134:135], v[76:77] op_sel:[0,1] op_sel_hi:[1,1]
    v_cvt_pk_bf16_f32 v208, v128, v129
    v_cvt_pk_bf16_f32 v209, v130, v131
    v_cvt_pk_bf16_f32 v210, v132, v133
    v_cvt_pk_bf16_f32 v211, v134, v135
    buffer_store_dwordx4 v[208:211], v3, s[20:23], s45 offen sc1
    s_add_u32 s45, s45, s42
    v_pk_mul_f32 v[136:137], v[136:137], v[76:77] op_sel:[0,1] op_sel_hi:[1,1]
    v_pk_mul_f32 v[138:139], v[138:139], v[76:77] op_sel:[0,1] op_sel_hi:[1,1]
    v_pk_mul_f32 v[140:141], v[140:141], v[76:77] op_sel:[0,1] op_sel_hi:[1,1]
    v_pk_mul_f32 v[142:143], v[142:143], v[76:77] op_sel:[0,1] op_sel_hi:[1,1]
    v_cvt_pk_bf16_f32 v212, v136, v137
    v_cvt_pk_bf16_f32 v213, v138, v139
    v_cvt_pk_bf16_f32 v214, v140, v141
    v_cvt_pk_bf16_f32 v215, v142, v143
    buffer_store_dwordx4 v[212:215], v3, s[20:23], s45 offen sc1
    s_add_u32 s45, s45, s42
    v_pk_mul_f32 v[144:145], v[144:145], v[76:77] op_sel:[0,1] op_sel_hi:[1,1]
    v_pk_mul_f32 v[146:147], v[146:147], v[76:77] op_sel:[0,1] op_sel_hi:[1,1]
    v_pk_mul_f32 v[148:149], v[148:149], v[76:77] op_sel:[0,1] op_sel_hi:[1,1]
    v_pk_mul_f32 v[150:151], v[150:151], v[76:77] op_sel:[0,1] op_sel_hi:[1,1]
    v_cvt_pk_bf16_f32 v216, v144, v145
    v_cvt_pk_bf16_f32 v217, v146, v147
    v_cvt_pk_bf16_f32 v218, v148, v149
    v_cvt_pk_bf16_f32 v219, v150, v151
    buffer_store_dwordx4 v[216:219], v3, s[20:23], s45 offen sc1
    s_add_u32 s45, s45, s42
    v_pk_mul_f32 v[152:153], v[152:153], v[76:77] op_sel:[0,1] op_sel_hi:[1,1]
    v_pk_mul_f32 v[154:155], v[154:155], v[76:77] op_sel:[0,1] op_sel_hi:[1,1]
    v_pk_mul_f32 v[156:157], v[156:157], v[76:77] op_sel:[0,1] op_sel_hi:[1,1]
    v_pk_mul_f32 v[158:159], v[158:159], v[76:77] op_sel:[0,1] op_sel_hi:[1,1]
    v_cvt_pk_bf16_f32 v220, v152, v153
    v_cvt_pk_bf16_f32 v221, v154, v155
    v_cvt_pk_bf16_f32 v222, v156, v157
    v_cvt_pk_bf16_f32 v223, v158, v159
    buffer_store_dwordx4 v[220:223], v3, s[20:23], s45 offen sc1
    s_add_u32 s45, s45, s42
    v_pk_mul_f32 v[160:161], v[160:161], v[76:77] op_sel:[0,1] op_sel_hi:[1,1]
    v_pk_mul_f32 v[162:163], v[162:163], v[76:77] op_sel:[0,1] op_sel_hi:[1,1]
    v_pk_mul_f32 v[164:165], v[164:165], v[76:77] op_sel:[0,1] op_sel_hi:[1,1]
    v_pk_mul_f32 v[166:167], v[166:167], v[76:77] op_sel:[0,1] op_sel_hi:[1,1]
    v_cvt_pk_bf16_f32 v224, v160, v161
    v_cvt_pk_bf16_f32 v225, v162, v163
    v_cvt_pk_bf16_f32 v226, v164, v165
    v_cvt_pk_bf16_f32 v227, v166, v167
    ds_write2_b32 v232, v224, v225 offset0:0 offset1:32
    ds_write2_b32 v232, v226, v227 offset0:128 offset1:160
    ds_read_b128 v[228:231], v233
    s_waitcnt lgkmcnt(0)
    buffer_store_dwordx4 v[228:231], v234, s[20:23], s44 offen sc1
    s_branch fused_kernel_p1_done
fused_kernel_p1_mv:
    s_lshr_b32 s44, s29, 3
    s_mul_i32 s44, s44, 18432
    s_and_b32 s45, s29, 7
    s_mul_i32 s45, s45, 1152
    s_add_u32 s44, s44, s45
    s_add_u32 s44, s44, 2368512
    s_sub_u32 s46, s26, 8
    s_mul_i32 s45, s46, 1179648
    s_add_u32 s44, s44, s45
    s_mov_b32 s47, 146304
    v_mul_u32_u24 v77, 288, v78
    v_add_u32 v77, s48, v77
    v_add_u32 v248, s48, v3
    v_add_u32 v78, 0, v1
    v_mul_u32_u24 v79, 3641, v78
    v_lshrrev_b32 v79, 16, v79
    v_mul_u32_u24 v79, 864, v79
    v_lshl_add_u32 v78, v78, 4, v77
    v_add_u32 v232, v78, v79
    v_add_u32 v78, 32, v1
    v_mul_u32_u24 v79, 3641, v78
    v_lshrrev_b32 v79, 16, v79
    v_mul_u32_u24 v79, 864, v79
    v_lshl_add_u32 v78, v78, 4, v77
    v_add_u32 v233, v78, v79
    v_add_u32 v78, 64, v1
    v_mul_u32_u24 v79, 3641, v78
    v_lshrrev_b32 v79, 16, v79
    v_mul_u32_u24 v79, 864, v79
    v_lshl_add_u32 v78, v78, 4, v77
    v_add_u32 v234, v78, v79
    v_add_u32 v78, 96, v1
    v_mul_u32_u24 v79, 3641, v78
    v_lshrrev_b32 v79, 16, v79
    v_mul_u32_u24 v79, 864, v79
    v_lshl_add_u32 v78, v78, 4, v77
    v_add_u32 v235, v78, v79
    v_and_b32 v78, 15, v1
    v_add_u32 v78, 128, v78
    v_mul_u32_u24 v79, 3641, v78
    v_lshrrev_b32 v79, 16, v79
    v_mul_u32_u24 v79, 864, v79
    v_lshl_add_u32 v78, v78, 4, v77
    v_add_u32 v236, v78, v79
    v_add_u32 v78, 0, v2
    v_lshrrev_b32 v79, 3, v78
    v_mul_u32_u24 v79, 7282, v79
    v_lshrrev_b32 v79, 16, v79
    v_mul_lo_u32 v79, v79, s47
    v_lshl_add_u32 v237, v78, 4, v79
    v_add_u32 v78, 64, v2
    v_lshrrev_b32 v79, 3, v78
    v_mul_u32_u24 v79, 7282, v79
    v_lshrrev_b32 v79, 16, v79
    v_mul_lo_u32 v79, v79, s47
    v_lshl_add_u32 v238, v78, 4, v79
    v_add_u32 v78, 128, v2
    v_lshrrev_b32 v79, 3, v78
    v_mul_u32_u24 v79, 7282, v79
    v_lshrrev_b32 v79, 16, v79
    v_mul_lo_u32 v79, v79, s47
    v_lshl_add_u32 v239, v78, 4, v79
    v_add_u32 v78, 192, v2
    v_lshrrev_b32 v79, 3, v78
    v_mul_u32_u24 v79, 7282, v79
    v_lshrrev_b32 v79, 16, v79
    v_mul_lo_u32 v79, v79, s47
    v_lshl_add_u32 v240, v78, 4, v79
    v_add_u32 v78, 256, v2
    v_lshrrev_b32 v79, 3, v78
    v_mul_u32_u24 v79, 7282, v79
    v_lshrrev_b32 v79, 16, v79
    v_mul_lo_u32 v79, v79, s47
    v_lshl_add_u32 v241, v78, 4, v79
    v_add_u32 v78, 320, v2
    v_lshrrev_b32 v79, 3, v78
    v_mul_u32_u24 v79, 7282, v79
    v_lshrrev_b32 v79, 16, v79
    v_mul_lo_u32 v79, v79, s47
    v_lshl_add_u32 v242, v78, 4, v79
    v_add_u32 v78, 384, v2
    v_lshrrev_b32 v79, 3, v78
    v_mul_u32_u24 v79, 7282, v79
    v_lshrrev_b32 v79, 16, v79
    v_mul_lo_u32 v79, v79, s47
    v_lshl_add_u32 v243, v78, 4, v79
    v_add_u32 v78, 448, v2
    v_lshrrev_b32 v79, 3, v78
    v_mul_u32_u24 v79, 7282, v79
    v_lshrrev_b32 v79, 16, v79
    v_mul_lo_u32 v79, v79, s47
    v_lshl_add_u32 v244, v78, 4, v79
    v_add_u32 v78, 512, v2
    v_lshrrev_b32 v79, 3, v78
    v_mul_u32_u24 v79, 7282, v79
    v_lshrrev_b32 v79, 16, v79
    v_mul_lo_u32 v79, v79, s47
    v_lshl_add_u32 v245, v78, 4, v79
    s_barrier
    ds_read_b128 v[12:15], v8
    ds_read_b64_tr_b16 v[20:21], v4 offset:0
    ds_read_b64_tr_b16 v[22:23], v4 offset:1280
    ds_read_b64_tr_b16 v[24:25], v4 offset:64
    ds_read_b64_tr_b16 v[26:27], v4 offset:1344
    ds_read_b64_tr_b16 v[28:29], v4 offset:128
    ds_read_b64_tr_b16 v[30:31], v4 offset:1408
    ds_read_b64_tr_b16 v[32:33], v4 offset:192
    ds_read_b64_tr_b16 v[34:35], v4 offset:1472
    ds_read_b64_tr_b16 v[36:37], v5 offset:256
    ds_read_b64_tr_b16 v[38:39], v5 offset:1536
.p2align 4
fused_kernel_p1_L1:
    s_add_u32 s57, s57, 1
    s_and_b32 s57, s57, 3
    s_cmp_eq_u32 s57, 0
    s_mov_b32 s59, 36864
    s_cselect_b32 s59, 4294856704, s59
    s_waitcnt lgkmcnt(8)
    v_mfma_f32_32x32x16_bf16 v[96:111], v[12:15], v[20:23], v[96:111]
    ds_read_b128 v[16:19], v9
    ds_read_b64_tr_b16 v[20:21], v4 offset:5120
    ds_read_b64_tr_b16 v[22:23], v4 offset:6400
    s_waitcnt lgkmcnt(9)
    v_mfma_f32_32x32x16_bf16 v[112:127], v[12:15], v[24:27], v[112:127]
    ds_read_b64_tr_b16 v[24:25], v4 offset:5184
    ds_read_b64_tr_b16 v[26:27], v4 offset:6464
    s_waitcnt lgkmcnt(9)
    v_mfma_f32_32x32x16_bf16 v[128:143], v[12:15], v[28:31], v[128:143]
    ds_read_b64_tr_b16 v[28:29], v4 offset:5248
    ds_read_b64_tr_b16 v[30:31], v4 offset:6528
    v_add_u32 v8, s59, v8
    s_waitcnt lgkmcnt(9)
    v_mfma_f32_32x32x16_bf16 v[144:159], v[12:15], v[32:35], v[144:159]
    ds_read_b64_tr_b16 v[32:33], v4 offset:5312
    ds_read_b64_tr_b16 v[34:35], v4 offset:6592
    s_waitcnt lgkmcnt(9)
    v_mfma_f32_32x32x16_bf16 v[160:175], v[12:15], v[36:39], v[160:175]
    ds_read_b64_tr_b16 v[36:37], v5 offset:5376
    ds_read_b64_tr_b16 v[38:39], v5 offset:6656
    s_waitcnt lgkmcnt(8)
    v_mfma_f32_32x32x16_bf16 v[96:111], v[16:19], v[20:23], v[96:111]
    ds_read_b128 v[12:15], v10
    ds_read_b64_tr_b16 v[20:21], v4 offset:10240
    ds_read_b64_tr_b16 v[22:23], v4 offset:11520
    s_waitcnt lgkmcnt(9)
    v_mfma_f32_32x32x16_bf16 v[112:127], v[16:19], v[24:27], v[112:127]
    ds_read_b64_tr_b16 v[24:25], v4 offset:10304
    ds_read_b64_tr_b16 v[26:27], v4 offset:11584
    s_waitcnt lgkmcnt(9)
    v_mfma_f32_32x32x16_bf16 v[128:143], v[16:19], v[28:31], v[128:143]
    ds_read_b64_tr_b16 v[28:29], v4 offset:10368
    ds_read_b64_tr_b16 v[30:31], v4 offset:11648
    v_add_u32 v9, s59, v9
    s_waitcnt lgkmcnt(9)
    v_mfma_f32_32x32x16_bf16 v[144:159], v[16:19], v[32:35], v[144:159]
    ds_read_b64_tr_b16 v[32:33], v4 offset:10432
    ds_read_b64_tr_b16 v[34:35], v4 offset:11712
    s_waitcnt lgkmcnt(9)
    v_mfma_f32_32x32x16_bf16 v[160:175], v[16:19], v[36:39], v[160:175]
    ds_read_b64_tr_b16 v[36:37], v5 offset:10496
    ds_read_b64_tr_b16 v[38:39], v5 offset:11776
    s_waitcnt lgkmcnt(8)
    v_mfma_f32_32x32x16_bf16 v[96:111], v[12:15], v[20:23], v[96:111]
    s_cmp_eq_u32 s56, 8
    s_cbranch_scc1 fused_kernel_p1_L1_nb
    s_barrier
fused_kernel_p1_L1_nb:
    ds_read_b128 v[16:19], v11
    ds_read_b64_tr_b16 v[20:21], v4 offset:15360
    ds_read_b64_tr_b16 v[22:23], v4 offset:16640
    s_waitcnt lgkmcnt(9)
    v_mfma_f32_32x32x16_bf16 v[112:127], v[12:15], v[24:27], v[112:127]
    ds_read_b64_tr_b16 v[24:25], v4 offset:15424
    ds_read_b64_tr_b16 v[26:27], v4 offset:16704
    s_waitcnt lgkmcnt(9)
    v_mfma_f32_32x32x16_bf16 v[128:143], v[12:15], v[28:31], v[128:143]
    ds_read_b64_tr_b16 v[28:29], v4 offset:15488
    ds_read_b64_tr_b16 v[30:31], v4 offset:16768
    v_add_u32 v10, s59, v10
    s_waitcnt lgkmcnt(9)
    v_mfma_f32_32x32x16_bf16 v[144:159], v[12:15], v[32:35], v[144:159]
    ds_read_b64_tr_b16 v[32:33], v4 offset:15552
    ds_read_b64_tr_b16 v[34:35], v4 offset:16832
    s_waitcnt lgkmcnt(9)
    v_mfma_f32_32x32x16_bf16 v[160:175], v[12:15], v[36:39], v[160:175]
    ds_read_b64_tr_b16 v[36:37], v5 offset:15616
    ds_read_b64_tr_b16 v[38:39], v5 offset:16896
    s_waitcnt lgkmcnt(8)
    v_mfma_f32_32x32x16_bf16 v[96:111], v[16:19], v[20:23], v[96:111]
    v_add_u32 v4, s59, v4
    v_add_u32 v5, s59, v5
    ds_read_b128 v[12:15], v8
    ds_read_b64_tr_b16 v[20:21], v4 offset:0
    ds_read_b64_tr_b16 v[22:23], v4 offset:1280
    s_waitcnt lgkmcnt(9)
    v_mfma_f32_32x32x16_bf16 v[112:127], v[16:19], v[24:27], v[112:127]
    ds_read_b64_tr_b16 v[24:25], v4 offset:64
    ds_read_b64_tr_b16 v[26:27], v4 offset:1344
    s_waitcnt lgkmcnt(9)
    v_mfma_f32_32x32x16_bf16 v[128:143], v[16:19], v[28:31], v[128:143]
    ds_read_b64_tr_b16 v[28:29], v4 offset:128
    ds_read_b64_tr_b16 v[30:31], v4 offset:1408
    v_add_u32 v11, s59, v11
    s_waitcnt lgkmcnt(9)
    v_mfma_f32_32x32x16_bf16 v[144:159], v[16:19], v[32:35], v[144:159]
    ds_read_b64_tr_b16 v[32:33], v4 offset:192
    ds_read_b64_tr_b16 v[34:35], v4 offset:1472
    s_waitcnt lgkmcnt(9)
    v_mfma_f32_32x32x16_bf16 v[160:175], v[16:19], v[36:39], v[160:175]
    ds_read_b64_tr_b16 v[36:37], v5 offset:256
    ds_read_b64_tr_b16 v[38:39], v5 offset:1536
    s_add_u32 s56, s56, 1
    s_cmp_lt_u32 s56, 9
    s_cbranch_scc1 fused_kernel_p1_L1
    s_barrier
    s_waitcnt lgkmcnt(4)
    ds_read_b64 v[60:61], v247
    ds_read_b64 v[40:41], v246 offset:0
    ds_read_b64 v[44:45], v246 offset:256
    ds_read_b64 v[48:49], v246 offset:512
    ds_read_b64 v[52:53], v246 offset:768
    ds_read_b64 v[56:57], v246 offset:1024
    ds_read_b128 v[176:179], v249 offset:0
    ds_read_b128 v[180:183], v249 offset:32
    ds_read_b128 v[184:187], v249 offset:64
    ds_read_b128 v[188:191], v249 offset:96
    s_waitcnt lgkmcnt(8)
    v_mfma_f32_32x32x16_bf16 v[96:111], v[60:63], v[40:43], v[96:111]
    s_waitcnt lgkmcnt(7)
    v_mfma_f32_32x32x16_bf16 v[112:127], v[60:63], v[44:47], v[112:127]
    s_waitcnt lgkmcnt(6)
    v_mfma_f32_32x32x16_bf16 v[128:143], v[60:63], v[48:51], v[128:143]
    s_waitcnt lgkmcnt(5)
    v_mfma_f32_32x32x16_bf16 v[144:159], v[60:63], v[52:55], v[144:159]
    s_waitcnt lgkmcnt(4)
    v_mfma_f32_32x32x16_bf16 v[160:175], v[60:63], v[56:59], v[160:175]
    s_waitcnt lgkmcnt(0)
    s_nop 2
    v_pk_mul_f32 v[96:97], v[96:97], v[176:177]
    v_pk_mul_f32 v[98:99], v[98:99], v[178:179]
    v_pk_mul_f32 v[100:101], v[100:101], v[180:181]
    v_pk_mul_f32 v[102:103], v[102:103], v[182:183]
    v_cvt_pk_bf16_f32 v192, v96, v97
    v_cvt_pk_bf16_f32 v193, v98, v99
    v_cvt_pk_bf16_f32 v194, v100, v101
    v_cvt_pk_bf16_f32 v195, v102, v103
    ds_write_b128 v232, v[192:195] offset:0
    v_pk_mul_f32 v[104:105], v[104:105], v[184:185]
    v_pk_mul_f32 v[106:107], v[106:107], v[186:187]
    v_pk_mul_f32 v[108:109], v[108:109], v[188:189]
    v_pk_mul_f32 v[110:111], v[110:111], v[190:191]
    v_cvt_pk_bf16_f32 v196, v104, v105
    v_cvt_pk_bf16_f32 v197, v106, v107
    v_cvt_pk_bf16_f32 v198, v108, v109
    v_cvt_pk_bf16_f32 v199, v110, v111
    ds_write_b128 v232, v[196:199] offset:576
    ds_read_b128 v[96:99], v248 offset:0
    v_pk_mul_f32 v[112:113], v[112:113], v[176:177]
    v_pk_mul_f32 v[114:115], v[114:115], v[178:179]
    v_pk_mul_f32 v[116:117], v[116:117], v[180:181]
    v_pk_mul_f32 v[118:119], v[118:119], v[182:183]
    v_cvt_pk_bf16_f32 v200, v112, v113
    v_cvt_pk_bf16_f32 v201, v114, v115
    v_cvt_pk_bf16_f32 v202, v116, v117
    v_cvt_pk_bf16_f32 v203, v118, v119
    ds_write_b128 v233, v[200:203] offset:0
    v_pk_mul_f32 v[120:121], v[120:121], v[184:185]
    v_pk_mul_f32 v[122:123], v[122:123], v[186:187]
    v_pk_mul_f32 v[124:125], v[124:125], v[188:189]
    v_pk_mul_f32 v[126:127], v[126:127], v[190:191]
    v_cvt_pk_bf16_f32 v204, v120, v121
    v_cvt_pk_bf16_f32 v205, v122, v123
    v_cvt_pk_bf16_f32 v206, v124, v125
    v_cvt_pk_bf16_f32 v207, v126, v127
    ds_write_b128 v233, v[204:207] offset:576
    s_waitcnt lgkmcnt(2)
    buffer_store_dwordx4 v[96:99], v237, s[20:23], s44 offen sc1
    ds_read_b128 v[100:103], v248 offset:1024
    ds_read_b128 v[104:107], v248 offset:2048
    v_pk_mul_f32 v[128:129], v[128:129], v[176:177]
    v_pk_mul_f32 v[130:131], v[130:131], v[178:179]
    v_pk_mul_f32 v[132:133], v[132:133], v[180:181]
    v_pk_mul_f32 v[134:135], v[134:135], v[182:183]
    v_cvt_pk_bf16_f32 v208, v128, v129
    v_cvt_pk_bf16_f32 v209, v130, v131
    v_cvt_pk_bf16_f32 v210, v132, v133
    v_cvt_pk_bf16_f32 v211, v134, v135
    ds_write_b128 v234, v[208:211] offset:0
    v_pk_mul_f32 v[136:137], v[136:137], v[184:185]
    v_pk_mul_f32 v[138:139], v[138:139], v[186:187]
    v_pk_mul_f32 v[140:141], v[140:141], v[188:189]
    v_pk_mul_f32 v[142:143], v[142:143], v[190:191]
    v_cvt_pk_bf16_f32 v212, v136, v137
    v_cvt_pk_bf16_f32 v213, v138, v139
    v_cvt_pk_bf16_f32 v214, v140, v141
    v_cvt_pk_bf16_f32 v215, v142, v143
    ds_write_b128 v234, v[212:215] offset:576
    s_waitcnt lgkmcnt(2)
    buffer_store_dwordx4 v[100:103], v238, s[20:23], s44 offen sc1
    buffer_store_dwordx4 v[104:107], v239, s[20:23], s44 offen sc1
    ds_read_b128 v[108:111], v248 offset:3072
    ds_read_b128 v[112:115], v248 offset:4096
    v_pk_mul_f32 v[144:145], v[144:145], v[176:177]
    v_pk_mul_f32 v[146:147], v[146:147], v[178:179]
    v_pk_mul_f32 v[148:149], v[148:149], v[180:181]
    v_pk_mul_f32 v[150:151], v[150:151], v[182:183]
    v_cvt_pk_bf16_f32 v216, v144, v145
    v_cvt_pk_bf16_f32 v217, v146, v147
    v_cvt_pk_bf16_f32 v218, v148, v149
    v_cvt_pk_bf16_f32 v219, v150, v151
    ds_write_b128 v235, v[216:219] offset:0
    v_pk_mul_f32 v[152:153], v[152:153], v[184:185]
    v_pk_mul_f32 v[154:155], v[154:155], v[186:187]
    v_pk_mul_f32 v[156:157], v[156:157], v[188:189]
    v_pk_mul_f32 v[158:159], v[158:159], v[190:191]
    v_cvt_pk_bf16_f32 v220, v152, v153
    v_cvt_pk_bf16_f32 v221, v154, v155
    v_cvt_pk_bf16_f32 v222, v156, v157
    v_cvt_pk_bf16_f32 v223, v158, v159
    ds_write_b128 v235, v[220:223] offset:576
    s_waitcnt lgkmcnt(2)
    buffer_store_dwordx4 v[108:111], v240, s[20:23], s44 offen sc1
    buffer_store_dwordx4 v[112:115], v241, s[20:23], s44 offen sc1
    ds_read_b128 v[116:119], v248 offset:5120
    ds_read_b128 v[120:123], v248 offset:6144
    v_pk_mul_f32 v[160:161], v[160:161], v[176:177]
    v_pk_mul_f32 v[162:163], v[162:163], v[178:179]
    v_pk_mul_f32 v[164:165], v[164:165], v[180:181]
    v_pk_mul_f32 v[166:167], v[166:167], v[182:183]
    v_cvt_pk_bf16_f32 v224, v160, v161
    v_cvt_pk_bf16_f32 v225, v162, v163
    v_cvt_pk_bf16_f32 v226, v164, v165
    v_cvt_pk_bf16_f32 v227, v166, v167
    ds_write_b128 v236, v[224:227] offset:0
    v_pk_mul_f32 v[168:169], v[168:169], v[184:185]
    v_pk_mul_f32 v[170:171], v[170:171], v[186:187]
    v_pk_mul_f32 v[172:173], v[172:173], v[188:189]
    v_pk_mul_f32 v[174:175], v[174:175], v[190:191]
    v_cvt_pk_bf16_f32 v228, v168, v169
    v_cvt_pk_bf16_f32 v229, v170, v171
    v_cvt_pk_bf16_f32 v230, v172, v173
    v_cvt_pk_bf16_f32 v231, v174, v175
    ds_write_b128 v236, v[228:231] offset:576
    s_waitcnt lgkmcnt(2)
    buffer_store_dwordx4 v[116:119], v242, s[20:23], s44 offen sc1
    buffer_store_dwordx4 v[120:123], v243, s[20:23], s44 offen sc1
    ds_read_b128 v[124:127], v248 offset:7168
    ds_read_b128 v[128:131], v248 offset:8192
    s_waitcnt lgkmcnt(1)
    buffer_store_dwordx4 v[124:127], v244, s[20:23], s44 offen sc1
    s_waitcnt lgkmcnt(0)
    buffer_store_dwordx4 v[128:131], v245, s[20:23], s44 offen sc1
    s_branch fused_kernel_p1_done
fused_kernel_p1_aux:
    s_load_dwordx2 s[36:37], s[0:1], 16
    v_readfirstlane_b32 s24, v0
    s_cmp_lt_u32 s2, 224
    s_cbranch_scc1 fused_kernel_p1_st
    s_cmp_ge_u32 s2, 251
    s_cbranch_scc1 fused_kernel_p1_zr
    v_lshrrev_b32 v1, 3, v0
    v_lshrrev_b32 v2, 3, v1
    v_and_b32 v3, 7, v1
    v_mul_u32_u24 v4, 72, v2
    v_add_u32 v4, v4, v3
    v_mul_u32_u24 v4, 3456, v4
    v_and_b32 v3, 7, v0
    v_lshl_add_u32 v4, v3, 4, v4
    s_sub_u32 s25, s2, 224
    s_lshl_b32 s26, s25, 7
    s_mov_b32 s38, 0x00003f80
    s_mov_b32 s39, 0x3f800000
    s_waitcnt lgkmcnt(0)
    s_mov_b32 s16, s6
    s_and_b32 s17, s7, 0xffff
    s_mov_b32 s18, 1990656
    s_mov_b32 s19, 0x20000
    buffer_load_dwordx4 v[16:19], v4, s[16:19], s26 offen
    s_add_u32 s26, s26, 27648
    buffer_load_dwordx4 v[20:23], v4, s[16:19], s26 offen
    s_add_u32 s26, s26, 27648
    buffer_load_dwordx4 v[24:27], v4, s[16:19], s26 offen
    s_add_u32 s26, s26, 27648
    buffer_load_dwordx4 v[28:31], v4, s[16:19], s26 offen
    s_add_u32 s26, s26, 27648
    buffer_load_dwordx4 v[32:35], v4, s[16:19], s26 offen
    s_add_u32 s26, s26, 27648
    buffer_load_dwordx4 v[36:39], v4, s[16:19], s26 offen
    s_add_u32 s26, s26, 27648
    buffer_load_dwordx4 v[40:43], v4, s[16:19], s26 offen
    s_add_u32 s26, s26, 27648
    buffer_load_dwordx4 v[44:47], v4, s[16:19], s26 offen
    s_add_u32 s26, s26, 27648
    buffer_load_dwordx4 v[48:51], v4, s[16:19], s26 offen
    s_add_u32 s26, s26, 27648
    s_mov_b32 s20, s8
    s_and_b32 s21, s9, 0xffff
    s_mov_b32 s22, 71303168
    s_mov_b32 s23, 0x20000
    s_mov_b32 s40, s10
    s_and_b32 s41, s11, 0xffff
    s_mov_b32 s42, 256
    s_mov_b32 s43, 0x20000
    v_mul_u32_u24 v5, 1152, v3
    v_lshrrev_b32 v1, 1, v1
    v_lshl_add_u32 v5, v1, 2, v5
    v_mov_b32 v8, 0
    v_mov_b32 v9, 0
    v_mov_b32 v10, 0
    v_mov_b32 v11, 0
    v_mov_b32 v12, 0
    v_mov_b32 v13, 0
    v_mov_b32 v14, 0
    v_mov_b32 v15, 0
    s_waitcnt vmcnt(8)
    v_dot2c_f32_bf16 v8, s38, v16
    v_dot2c_f32_bf16 v9, s39, v16
    v_dot2c_f32_bf16 v10, s38, v17
    v_dot2c_f32_bf16 v11, s39, v17
    v_dot2c_f32_bf16 v12, s38, v18
    v_dot2c_f32_bf16 v13, s39, v18
    v_dot2c_f32_bf16 v14, s38, v19
    v_dot2c_f32_bf16 v15, s39, v19
    s_waitcnt vmcnt(7)
    v_dot2c_f32_bf16 v8, s38, v20
    v_dot2c_f32_bf16 v9, s39, v20
    v_dot2c_f32_bf16 v10, s38, v21
    v_dot2c_f32_bf16 v11, s39, v21
    v_dot2c_f32_bf16 v12, s38, v22
    v_dot2c_f32_bf16 v13, s39, v22
    v_dot2c_f32_bf16 v14, s38, v23
    v_dot2c_f32_bf16 v15, s39, v23
    s_waitcnt vmcnt(6)
    v_dot2c_f32_bf16 v8, s38, v24
    v_dot2c_f32_bf16 v9, s39, v24
    v_dot2c_f32_bf16 v10, s38, v25
    v_dot2c_f32_bf16 v11, s39, v25
    v_dot2c_f32_bf16 v12, s38, v26
    v_dot2c_f32_bf16 v13, s39, v26
    v_dot2c_f32_bf16 v14, s38, v27
    v_dot2c_f32_bf16 v15, s39, v27
    s_waitcnt vmcnt(5)
    v_dot2c_f32_bf16 v8, s38, v28
    v_dot2c_f32_bf16 v9, s39, v28
    v_dot2c_f32_bf16 v10, s38, v29
    v_dot2c_f32_bf16 v11, s39, v29
    v_dot2c_f32_bf16 v12, s38, v30
    v_dot2c_f32_bf16 v13, s39, v30
    v_dot2c_f32_bf16 v14, s38, v31
    v_dot2c_f32_bf16 v15, s39, v31
    s_waitcnt vmcnt(4)
    v_dot2c_f32_bf16 v8, s38, v32
    v_dot2c_f32_bf16 v9, s39, v32
    v_dot2c_f32_bf16 v10, s38, v33
    v_dot2c_f32_bf16 v11, s39, v33
    v_dot2c_f32_bf16 v12, s38, v34
    v_dot2c_f32_bf16 v13, s39, v34
    v_dot2c_f32_bf16 v14, s38, v35
    v_dot2c_f32_bf16 v15, s39, v35
    s_waitcnt vmcnt(3)
    v_dot2c_f32_bf16 v8, s38, v36
    v_dot2c_f32_bf16 v9, s39, v36
    v_dot2c_f32_bf16 v10, s38, v37
    v_dot2c_f32_bf16 v11, s39, v37
    v_dot2c_f32_bf16 v12, s38, v38
    v_dot2c_f32_bf16 v13, s39, v38
    v_dot2c_f32_bf16 v14, s38, v39
    v_dot2c_f32_bf16 v15, s39, v39
    s_waitcnt vmcnt(2)
    v_dot2c_f32_bf16 v8, s38, v40
    v_dot2c_f32_bf16 v9, s39, v40
    v_dot2c_f32_bf16 v10, s38, v41
    v_dot2c_f32_bf16 v11, s39, v41
    v_dot2c_f32_bf16 v12, s38, v42
    v_dot2c_f32_bf16 v13, s39, v42
    v_dot2c_f32_bf16 v14, s38, v43
    v_dot2c_f32_bf16 v15, s39, v43
    s_waitcnt vmcnt(1)
    v_dot2c_f32_bf16 v8, s38, v44
    v_dot2c_f32_bf16 v9, s39, v44
    v_dot2c_f32_bf16 v10, s38, v45
    v_dot2c_f32_bf16 v11, s39, v45
    v_dot2c_f32_bf16 v12, s38, v46
    v_dot2c_f32_bf16 v13, s39, v46
    v_dot2c_f32_bf16 v14, s38, v47
    v_dot2c_f32_bf16 v15, s39, v47
    s_waitcnt vmcnt(0)
    v_dot2c_f32_bf16 v8, s38, v48
    v_dot2c_f32_bf16 v9, s39, v48
    v_dot2c_f32_bf16 v10, s38, v49
    v_dot2c_f32_bf16 v11, s39, v49
    v_dot2c_f32_bf16 v12, s38, v50
    v_dot2c_f32_bf16 v13, s39, v50
    v_dot2c_f32_bf16 v14, s38, v51
    v_dot2c_f32_bf16 v15, s39, v51
    v_add_f32_dpp v8, v8, v8 row_ror:8 row_mask:0xf bank_mask:0xf
    v_add_f32_dpp v9, v9, v9 row_ror:8 row_mask:0xf bank_mask:0xf
    v_add_f32_dpp v10, v10, v10 row_ror:8 row_mask:0xf bank_mask:0xf
    v_add_f32_dpp v11, v11, v11 row_ror:8 row_mask:0xf bank_mask:0xf
    v_add_f32_dpp v12, v12, v12 row_ror:8 row_mask:0xf bank_mask:0xf
    v_add_f32_dpp v13, v13, v13 row_ror:8 row_mask:0xf bank_mask:0xf
    v_add_f32_dpp v14, v14, v14 row_ror:8 row_mask:0xf bank_mask:0xf
    v_add_f32_dpp v15, v15, v15 row_ror:8 row_mask:0xf bank_mask:0xf
    ds_write_b32 v5, v8 offset:0
    ds_write_b32 v5, v9 offset:144
    ds_write_b32 v5, v10 offset:288
    ds_write_b32 v5, v11 offset:432
    ds_write_b32 v5, v12 offset:576
    ds_write_b32 v5, v13 offset:720
    ds_write_b32 v5, v14 offset:864
    ds_write_b32 v5, v15 offset:1008
    s_waitcnt lgkmcnt(0)
    s_barrier
    s_cmp_lg_u32 s24, 0
    s_cbranch_scc1 fused_kernel_p1_az
    v_mul_u32_u24 v5, 144, v0
    ds_read_b128 v[16:19], v5 offset:0
    ds_read_b128 v[20:23], v5 offset:16
    ds_read_b128 v[24:27], v5 offset:32
    ds_read_b128 v[28:31], v5 offset:48
    ds_read_b128 v[32:35], v5 offset:64
    ds_read_b128 v[36:39], v5 offset:80
    ds_read_b128 v[40:43], v5 offset:96
    ds_read_b128 v[44:47], v5 offset:112
    s_waitcnt lgkmcnt(0)
    v_add_f32 v16, v16, v32
    v_add_f32 v17, v17, v33
    v_add_f32 v18, v18, v34
    v_add_f32 v19, v19, v35
    v_add_f32 v20, v20, v36
    v_add_f32 v21, v21, v37
    v_add_f32 v22, v22, v38
    v_add_f32 v23, v23, v39
    v_add_f32 v24, v24, v40
    v_add_f32 v25, v25, v41
    v_add_f32 v26, v26, v42
    v_add_f32 v27, v27, v43
    v_add_f32 v28, v28, v44
    v_add_f32 v29, v29, v45
    v_add_f32 v30, v30, v46
    v_add_f32 v31, v31, v47
    v_add_f32 v16, v16, v24
    v_add_f32 v17, v17, v25
    v_add_f32 v18, v18, v26
    v_add_f32 v19, v19, v27
    v_add_f32 v20, v20, v28
    v_add_f32 v21, v21, v29
    v_add_f32 v22, v22, v30
    v_add_f32 v23, v23, v31
    v_add_f32 v16, v16, v20
    v_add_f32 v17, v17, v21
    v_add_f32 v18, v18, v22
    v_add_f32 v19, v19, v23
    v_add_f32 v16, v16, v18
    v_add_f32 v17, v17, v19
    v_add_f32 v16, v16, v17
    s_lshl_b32 s26, s25, 8
    s_add_u32 s26, s26, 67698688
    v_lshlrev_b32 v5, 2, v0
    buffer_store_dword v16, v5, s[20:23], s26 offen sc1
    s_lshl_b32 s26, s25, 1
    s_add_u32 s26, s26, 64
    v_mov_b32 v10, 1
    s_waitcnt vmcnt(0)
    s_mov_b64 exec, 1
    buffer_store_short v10, v5, s[40:43], s26 offen sc1
    s_mov_b64 exec, -1
    s_branch fused_kernel_p1_az
fused_kernel_p1_zr:
    s_waitcnt lgkmcnt(0)
    s_mov_b32 s20, s8
    s_and_b32 s21, s9, 0xffff
    s_mov_b32 s22, 71303168
    s_mov_b32 s23, 0x20000
    s_mov_b32 s40, s10
    s_and_b32 s41, s11, 0xffff
    s_mov_b32 s42, 256
    s_mov_b32 s43, 0x20000
    v_lshlrev_b32 v5, 4, v0
    v_mov_b32 v12, 0
    v_mov_b32 v13, 0
    v_mov_b32 v14, 0
    v_mov_b32 v15, 0
    s_sub_u32 s25, s2, 251
    s_lshl_b32 s25, s25, 15
    s_add_u32 s25, s25, 67108864
    s_cmp_eq_u32 s2, 255
    s_cselect_b32 s25, 68321280, s25
    s_cmp_eq_u32 s2, 253
    s_cbranch_scc1 fused_kernel_p1_az
    s_cmp_eq_u32 s2, 254
    s_cbranch_scc1 fused_kernel_p1_az
    buffer_store_dwordx4 v[12:15], v5, s[20:23], s25 offen sc1
    s_add_u32 s25, s25, 8192
    buffer_store_dwordx4 v[12:15], v5, s[20:23], s25 offen sc1
    s_add_u32 s25, s25, 8192
    buffer_store_dwordx4 v[12:15], v5, s[20:23], s25 offen sc1
    s_add_u32 s25, s25, 8192
    buffer_store_dwordx4 v[12:15], v5, s[20:23], s25 offen sc1
    s_add_u32 s25, s25, 8192
    s_cmp_lg_u32 s2, 255
    s_cbranch_scc1 fused_kernel_p1_az
    buffer_store_dwordx4 v[12:15], v5, s[20:23], s25 offen sc1
    s_add_u32 s25, s25, 8192
    buffer_store_dwordx4 v[12:15], v5, s[20:23], s25 offen sc1
    s_add_u32 s25, s25, 8192
    buffer_store_dwordx4 v[12:15], v5, s[20:23], s25 offen sc1
    s_add_u32 s25, s25, 8192
    buffer_store_dwordx4 v[12:15], v5, s[20:23], s25 offen sc1
    s_add_u32 s25, s25, 8192
    v_mov_b32 v10, 1
    s_waitcnt vmcnt(0)
    s_barrier
    s_cmp_lg_u32 s24, 0
    s_cbranch_scc1 fused_kernel_p1_az
    s_mov_b64 exec, 1
    buffer_store_short v10, v12, s[40:43], 0 offen offset:182 sc1
    s_mov_b64 exec, -1
    s_branch fused_kernel_p1_az
fused_kernel_p1_st:
    s_cmp_lt_u32 s24, 256
    s_cbranch_scc1 fused_kernel_p1_s1
    s_lshr_b32 s25, s2, 3
    s_sub_u32 s25, s25, 25
    s_lshl_b32 s25, s25, 8
    v_add_u32 v1, s25, v0
    s_getpc_b64 s[26:27]
L_pf4:
    s_add_u32 s26, s26, (fused_kernel-L_pf4)&0xffffffff
    s_addc_u32 s27, s27, ((fused_kernel-L_pf4)>>32)&0xffffffff
    v_lshlrev_b32 v2, 7, v1
    v_min_u32 v2, code_end-fused_kernel, v2
    global_load_dword v7, v2, s[26:27]
fused_kernel_p1_s1:
    s_sub_u32 s27, s2, 192
    s_mul_i32 s25, s27, 73728
    v_lshrrev_b32 v3, 3, v0
    v_mul_u32_u24 v4, 1152, v3
    v_and_b32 v5, 7, v0
    v_lshl_add_u32 v4, v5, 4, v4
    s_mov_b32 s38, 0x3f803f80
    s_waitcnt lgkmcnt(0)
    s_mov_b32 s12, s4
    s_and_b32 s13, s5, 0xffff
    s_mov_b32 s14, 2359296
    s_mov_b32 s15, 0x20000
    buffer_load_dwordx4 v[16:19], v4, s[12:15], s25 offen offset:0
    buffer_load_dwordx4 v[20:23], v4, s[12:15], s25 offen offset:128
    buffer_load_dwordx4 v[24:27], v4, s[12:15], s25 offen offset:256
    buffer_load_dwordx4 v[28:31], v4, s[12:15], s25 offen offset:384
    buffer_load_dwordx4 v[32:35], v4, s[12:15], s25 offen offset:512
    buffer_load_dwordx4 v[36:39], v4, s[12:15], s25 offen offset:640
    buffer_load_dwordx4 v[40:43], v4, s[12:15], s25 offen offset:768
    buffer_load_dwordx4 v[44:47], v4, s[12:15], s25 offen offset:896
    buffer_load_dwordx4 v[48:51], v4, s[12:15], s25 offen offset:1024
    s_mov_b32 s44, s36
    s_and_b32 s45, s37, 0xffff
    s_mov_b32 s46, 663552
    s_mov_b32 s47, 0x20000
    s_sub_u32 s31, s2, 192
    s_mul_i32 s31, s31, 192
    s_sub_u32 s31, s31, 64
    v_add_u32 v100, s31, v0
    s_add_u32 s31, s31, s24
    s_sub_u32 s30, s24, 64
    s_cmp_ge_u32 s31, 5184
    s_cselect_b32 s30, 999, s30
    s_cmp_lt_u32 s30, 192
    s_cselect_b32 s46, s46, 0
    v_lshrrev_b32 v101, 3, v100
    v_mul_u32_u24 v101, 7282, v101
    v_lshrrev_b32 v101, 16, v101
    v_mul_u32_u24 v102, 72, v101
    v_sub_u32 v100, v100, v102
    v_lshrrev_b32 v102, 1, v101
    v_and_b32 v103, 1, v101
    v_lshrrev_b32 v104, 3, v100
    v_mul_u32_u24 v104, 36, v104
    v_add_u32 v104, v104, v102
    v_lshlrev_b32 v104, 11, v104
    v_lshl_add_u32 v104, v103, 9, v104
    v_and_b32 v105, 7, v100
    v_lshl_add_u32 v106, v105, 4, v104
    v_mul_u32_u24 v104, 18, v102
    v_lshl_add_u32 v104, v103, 2, v104
    s_mov_b32 s32, 2304
    s_mov_b32 s33, 9216
    s_cmp_ge_u32 s31, 4608
    s_cbranch_scc0 fused_kernel_p1_a1
    v_subrev_u32 v104, 64, v101
    v_mul_u32_u24 v104, 72, v104
    v_add_u32 v104, 16, v104
    s_mov_b32 s32, 20736
    s_mov_b32 s33, 41472
fused_kernel_p1_a1:
    v_mul_u32_u24 v104, 1152, v104
    v_lshl_add_u32 v101, v100, 4, v104
    s_add_u32 s34, s32, s33
    s_mov_b32 s28, 0x05040100
    s_mov_b32 s29, 0x07060302
    s_mov_b32 s35, 12582912
    buffer_load_dwordx4 v[112:115], v101, s[44:47], 0 offen offset:0
    buffer_load_dwordx4 v[116:119], v101, s[44:47], 0 offen offset:1152
    buffer_load_dwordx4 v[120:123], v101, s[44:47], s32 offen offset:0
    buffer_load_dwordx4 v[124:127], v101, s[44:47], s32 offen offset:1152
    buffer_load_dwordx4 v[128:131], v101, s[44:47], s33 offen offset:0
    buffer_load_dwordx4 v[132:135], v101, s[44:47], s33 offen offset:1152
    buffer_load_dwordx4 v[136:139], v101, s[44:47], s34 offen offset:0
    buffer_load_dwordx4 v[140:143], v101, s[44:47], s34 offen offset:1152
    s_mov_b32 s20, s8
    s_and_b32 s21, s9, 0xffff
    s_mov_b32 s22, 71303168
    s_mov_b32 s23, 0x20000
    s_mov_b32 s40, s10
    s_and_b32 s41, s11, 0xffff
    s_mov_b32 s42, 256
    s_mov_b32 s43, 0x20000
    v_mov_b32 v8, 0
    v_mov_b32 v12, 0
    v_lshrrev_b32 v6, 5, v3
    v_lshl_add_u32 v3, v6, 5, v3
    v_and_b32 v6, 1, v0
    v_lshl_add_u32 v3, v6, 5, v3
    v_lshlrev_b32 v3, 2, v3
    v_cmp_eq_u32 vcc, 0, v6
    s_waitcnt vmcnt(12)
    v_dot2c_f32_bf16 v8, s38, v16
    v_dot2c_f32_bf16 v12, v16, v16
    v_dot2c_f32_bf16 v8, s38, v17
    v_dot2c_f32_bf16 v12, v17, v17
    v_dot2c_f32_bf16 v8, s38, v18
    v_dot2c_f32_bf16 v12, v18, v18
    v_dot2c_f32_bf16 v8, s38, v19
    v_dot2c_f32_bf16 v12, v19, v19
    v_dot2c_f32_bf16 v8, s38, v20
    v_dot2c_f32_bf16 v12, v20, v20
    v_dot2c_f32_bf16 v8, s38, v21
    v_dot2c_f32_bf16 v12, v21, v21
    v_dot2c_f32_bf16 v8, s38, v22
    v_dot2c_f32_bf16 v12, v22, v22
    v_dot2c_f32_bf16 v8, s38, v23
    v_dot2c_f32_bf16 v12, v23, v23
    v_dot2c_f32_bf16 v8, s38, v24
    v_dot2c_f32_bf16 v12, v24, v24
    v_dot2c_f32_bf16 v8, s38, v25
    v_dot2c_f32_bf16 v12, v25, v25
    v_dot2c_f32_bf16 v8, s38, v26
    v_dot2c_f32_bf16 v12, v26, v26
    v_dot2c_f32_bf16 v8, s38, v27
    v_dot2c_f32_bf16 v12, v27, v27
    v_dot2c_f32_bf16 v8, s38, v28
    v_dot2c_f32_bf16 v12, v28, v28
    v_dot2c_f32_bf16 v8, s38, v29
    v_dot2c_f32_bf16 v12, v29, v29
    v_dot2c_f32_bf16 v8, s38, v30
    v_dot2c_f32_bf16 v12, v30, v30
    v_dot2c_f32_bf16 v8, s38, v31
    v_dot2c_f32_bf16 v12, v31, v31
    v_dot2c_f32_bf16 v8, s38, v32
    v_dot2c_f32_bf16 v12, v32, v32
    v_dot2c_f32_bf16 v8, s38, v33
    v_dot2c_f32_bf16 v12, v33, v33
    v_dot2c_f32_bf16 v8, s38, v34
    v_dot2c_f32_bf16 v12, v34, v34
    v_dot2c_f32_bf16 v8, s38, v35
    v_dot2c_f32_bf16 v12, v35, v35
    s_waitcnt vmcnt(8)
    v_dot2c_f32_bf16 v8, s38, v36
    v_dot2c_f32_bf16 v12, v36, v36
    v_dot2c_f32_bf16 v8, s38, v37
    v_dot2c_f32_bf16 v12, v37, v37
    v_dot2c_f32_bf16 v8, s38, v38
    v_dot2c_f32_bf16 v12, v38, v38
    v_dot2c_f32_bf16 v8, s38, v39
    v_dot2c_f32_bf16 v12, v39, v39
    v_dot2c_f32_bf16 v8, s38, v40
    v_dot2c_f32_bf16 v12, v40, v40
    v_dot2c_f32_bf16 v8, s38, v41
    v_dot2c_f32_bf16 v12, v41, v41
    v_dot2c_f32_bf16 v8, s38, v42
    v_dot2c_f32_bf16 v12, v42, v42
    v_dot2c_f32_bf16 v8, s38, v43
    v_dot2c_f32_bf16 v12, v43, v43
    v_dot2c_f32_bf16 v8, s38, v44
    v_dot2c_f32_bf16 v12, v44, v44
    v_dot2c_f32_bf16 v8, s38, v45
    v_dot2c_f32_bf16 v12, v45, v45
    v_dot2c_f32_bf16 v8, s38, v46
    v_dot2c_f32_bf16 v12, v46, v46
    v_dot2c_f32_bf16 v8, s38, v47
    v_dot2c_f32_bf16 v12, v47, v47
    v_dot2c_f32_bf16 v8, s38, v48
    v_dot2c_f32_bf16 v12, v48, v48
    v_dot2c_f32_bf16 v8, s38, v49
    v_dot2c_f32_bf16 v12, v49, v49
    v_dot2c_f32_bf16 v8, s38, v50
    v_dot2c_f32_bf16 v12, v50, v50
    v_dot2c_f32_bf16 v8, s38, v51
    v_dot2c_f32_bf16 v12, v51, v51
    s_nop 1
    v_add_f32_dpp v8, v8, v8 quad_perm:[1,0,3,2] row_mask:0xf bank_mask:0xf
    v_add_f32_dpp v12, v12, v12 quad_perm:[1,0,3,2] row_mask:0xf bank_mask:0xf
    s_nop 0
    v_add_f32_dpp v8, v8, v8 quad_perm:[2,3,0,1] row_mask:0xf bank_mask:0xf
    v_add_f32_dpp v12, v12, v12 quad_perm:[2,3,0,1] row_mask:0xf bank_mask:0xf
    s_nop 0
    v_add_f32_dpp v8, v8, v8 row_half_mirror row_mask:0xf bank_mask:0xf
    v_add_f32_dpp v12, v12, v12 row_half_mirror row_mask:0xf bank_mask:0xf
    v_mul_f32 v8, 0xbae38e39, v8
    v_mul_f32 v12, 0x3ae38e39, v12
    v_fma_f32 v12, -v8, v8, v12
    v_max_f32 v12, 0, v12
    v_add_f32 v12, 0x3727c5ac, v12
    v_rsq_f32 v12, v12
    v_lshlrev_b32 v4, 3, v0
    v_cndmask_b32 v8, v12, v8, vcc
    ds_write_b32 v3, v8
    s_waitcnt lgkmcnt(0)
    s_barrier
    s_cmp_lg_u32 s24, 0
    s_cbranch_scc1 fused_kernel_p1_wo
    ds_read_b64 v[8:9], v4
    s_lshl_b32 s25, s27, 9
    s_add_u32 s25, s25, 67633152
    v_mov_b32 v10, 1
    s_waitcnt lgkmcnt(0)
    buffer_store_dwordx2 v[8:9], v4, s[20:23], s25 offen sc1
    s_lshl_b32 s25, s27, 1
    s_waitcnt vmcnt(0)
    s_mov_b64 exec, 1
    buffer_store_short v10, v4, s[40:43], s25 offen sc1
    s_branch fused_kernel_p1_az
fused_kernel_p1_wo:
    s_cmp_ge_u32 s30, 192
    s_cbranch_scc1 fused_kernel_p1_az
    s_waitcnt vmcnt(0)
    v_perm_b32 v144, v116, v112, s28
    v_perm_b32 v145, v124, v120, s28
    v_perm_b32 v146, v132, v128, s28
    v_perm_b32 v147, v140, v136, s28
    buffer_store_dwordx4 v[144:147], v106, s[20:23], s35 offen offset:0 sc1
    v_perm_b32 v148, v116, v112, s29
    v_perm_b32 v149, v124, v120, s29
    v_perm_b32 v150, v132, v128, s29
    v_perm_b32 v151, v140, v136, s29
    buffer_store_dwordx4 v[148:151], v106, s[20:23], s35 offen offset:128 sc1
    v_perm_b32 v152, v117, v113, s28
    v_perm_b32 v153, v125, v121, s28
    v_perm_b32 v154, v133, v129, s28
    v_perm_b32 v155, v141, v137, s28
    buffer_store_dwordx4 v[152:155], v106, s[20:23], s35 offen offset:256 sc1
    v_perm_b32 v156, v117, v113, s29
    v_perm_b32 v157, v125, v121, s29
    v_perm_b32 v158, v133, v129, s29
    v_perm_b32 v159, v141, v137, s29
    buffer_store_dwordx4 v[156:159], v106, s[20:23], s35 offen offset:384 sc1
    v_perm_b32 v160, v118, v114, s28
    v_perm_b32 v161, v126, v122, s28
    v_perm_b32 v162, v134, v130, s28
    v_perm_b32 v163, v142, v138, s28
    buffer_store_dwordx4 v[160:163], v106, s[20:23], s35 offen offset:1024 sc1
    v_perm_b32 v164, v118, v114, s29
    v_perm_b32 v165, v126, v122, s29
    v_perm_b32 v166, v134, v130, s29
    v_perm_b32 v167, v142, v138, s29
    buffer_store_dwordx4 v[164:167], v106, s[20:23], s35 offen offset:1152 sc1
    v_perm_b32 v168, v119, v115, s28
    v_perm_b32 v169, v127, v123, s28
    v_perm_b32 v170, v135, v131, s28
    v_perm_b32 v171, v143, v139, s28
    buffer_store_dwordx4 v[168:171], v106, s[20:23], s35 offen offset:1280 sc1
    v_perm_b32 v172, v119, v115, s29
    v_perm_b32 v173, v127, v123, s29
    v_perm_b32 v174, v135, v131, s29
    v_perm_b32 v175, v143, v139, s29
    buffer_store_dwordx4 v[172:175], v106, s[20:23], s35 offen offset:1408 sc1
fused_kernel_p1_az:
    s_mov_b64 exec, -1
    s_cmp_lg_u32 s24, 0
    s_cbranch_scc1 fused_kernel_p1_ay
    s_waitcnt lgkmcnt(0)
    s_mov_b32 s40, s10
    s_and_b32 s41, s11, 0xffff
    s_mov_b32 s42, 256
    s_mov_b32 s43, 0x20000
    s_mov_b32 s20, s8
    s_and_b32 s21, s9, 0xffff
    s_mov_b32 s22, 71303168
    s_mov_b32 s23, 0x20000
    v_and_b32 v2, 63, v0
    v_mov_b32 v12, 0
    v_mov_b32 v13, 0
    v_mov_b32 v14, 0
    v_mov_b32 v15, 0
    v_lshrrev_b32 v6, 5, v2
    v_lshlrev_b32 v6, 15, v6
    v_and_b32 v7, 31, v2
    v_lshl_add_u32 v6, v7, 4, v6
    s_sub_u32 s49, s2, 192
    s_lshl_b32 s49, s49, 9
    s_add_u32 s49, s49, 68157440
    buffer_store_dwordx4 v[12:15], v6, s[20:23], s49 offen sc1
    s_add_u32 s49, s49, 65536
    buffer_store_dwordx4 v[12:15], v6, s[20:23], s49 offen sc1
    s_add_u32 s49, s49, 65536
    buffer_store_dwordx4 v[12:15], v6, s[20:23], s49 offen sc1
    v_mov_b32 v4, 0
    s_mov_b32 s57, 0
fused_kernel_p1_zp:
    buffer_load_ushort v5, v4, s[40:43], 0 offen offset:182 sc1
    s_add_u32 s57, s57, 1
    s_waitcnt vmcnt(0)
    v_cmp_ne_u32 vcc, 1, v5
    s_cmp_gt_u32 s57, 0x40000
    s_cbranch_scc1 fused_kernel_p1_ay
    s_cbranch_vccz fused_kernel_p1_ay
    s_sleep 16
    s_branch fused_kernel_p1_zp
fused_kernel_p1_ay:
    s_lshr_b32 s24, s24, 6
fused_kernel_p1_done:
    s_lshl_b32 s3, s26, 4
    s_add_u32 s3, s3, s25
    s_cmp_ge_u32 s2, 192
    s_cselect_b32 s3, s2, s3
    s_lshl_b32 s3, s3, 7
    s_add_u32 s3, s3, 68354048
    s_cmp_eq_u32 s24, 0
    s_cselect_b32 s3, s3, 0x7ff00000
    s_waitcnt lgkmcnt(0)
    s_mov_b32 s16, s8
    s_and_b32 s17, s9, 0xffff
    s_mov_b32 s18, 71303168
    s_mov_b32 s19, 0x20000
    v_mov_b32 v48, 0
    v_mov_b32 v49, 1
    s_waitcnt vmcnt(0)
    s_barrier
    s_mov_b64 exec, 1
    buffer_store_dword v49, v48, s[16:19], s3 offen sc1
    s_mov_b64 exec, -1
    s_load_dwordx2 s[8:9], s[0:1], 72
    s_load_dwordx4 s[52:55], s[0:1], 32
    s_load_dwordx2 s[56:57], s[0:1], 48
    s_load_dwordx2 s[10:11], s[0:1], 0
    s_load_dwordx2 s[6:7], s[0:1], 56
    v_lshrrev_b32 v1, 6, v0
    v_and_b32 v2, 63, v0
    v_readfirstlane_b32 s24, v1
    s_and_b32 s25, s2, 7
    s_lshl_b32 s25, s25, 2
    s_lshr_b32 s26, s2, 3
    s_and_b32 s26, s26, 3
    s_add_u32 s25, s25, s26
    s_lshr_b32 s26, s2, 5
    s_lshl_b32 s26, s26, 3
    s_add_u32 s26, s26, s24
    v_lshlrev_b32 v3, 4, v2
    v_and_b32 v1, 31, v2
    v_lshlrev_b32 v192, 2, v1
    s_lshl_b32 s27, s25, 16
    s_lshl_b32 s28, s26, 10
    s_add_u32 s27, s27, s28
    s_add_u32 s27, s27, 0
    s_lshl_b32 s28, s25, 13
    s_lshl_b32 s29, s26, 7
    s_add_u32 s28, s28, s29
    s_add_u32 s28, s28, 2097152
    s_mul_i32 s29, s25, 147456
    s_add_u32 s29, s29, 2359296
    s_waitcnt lgkmcnt(0)
    s_mov_b32 s16, s8
    s_and_b32 s17, s9, 0xffff
    s_mov_b32 s18, 71303168
    s_mov_b32 s19, 0x20000
    s_mov_b32 s4, s28
    v_mov_b32 v240, v192
    s_add_u32 s12, s8, s29
    s_addc_u32 s13, s9, 0
    s_and_b32 s13, s13, 0xffff
    s_mov_b32 s14, 147456
    s_mov_b32 s15, 0x20000
    s_lshl_b32 s30, s24, 10
    s_lshl_b32 s31, s2, 3
    s_add_u32 s31, s31, s24
    s_mov_b32 s59, s31
    v_lshrrev_b32 v197, 5, v2
    v_mov_b32 v238, 2146435072
    s_cmp_lt_u32 s31, 1296
    s_cbranch_scc0 fused_kernel_w1
    s_cmp_ge_u32 s31, 648
    s_cselect_b32 s20, s54, s52
    s_cselect_b32 s21, s55, s53
    s_cselect_b32 s32, 648, 0
    s_cselect_b32 s33, 128, 0
    s_mov_b32 s22, 5308416
    s_sub_u32 s31, s31, s32
    s_mul_i32 s32, s31, 3641
    s_lshr_b32 s32, s32, 16
    s_mul_i32 s34, s32, 18
    s_sub_u32 s31, s31, s34
    s_lshr_b32 s34, s32, 2
    s_lshl_b32 s34, s34, 6
    s_and_b32 s35, s32, 3
    s_lshl_b32 s35, s35, 3
    s_add_u32 s34, s34, s35
    s_mul_i32 s34, s34, 9216
    s_lshl_b32 s35, s31, 9
    s_add_u32 s34, s34, s35
    v_mul_u32_u24 v193, 294912, v197
    v_lshl_add_u32 v193, v1, 4, v193
    v_add_u32 v193, s34, v193
    s_mul_i32 s34, s31, 589824
    s_lshl_b32 s35, s32, 9
    s_add_u32 s34, s34, s35
    s_mul_i32 s35, s33, 144
    s_add_u32 s34, s34, s35
    s_add_u32 s34, s34, 13631488
    v_lshrrev_b32 v194, 4, v1
    v_mul_u32_u24 v194, 294912, v194
    v_lshl_add_u32 v194, v197, 8, v194
    v_and_b32 v195, 15, v1
    v_lshl_add_u32 v194, v195, 4, v194
    v_add_u32 v14, s34, v194
    s_mov_b32 s60, 9216
    s_mov_b32 s61, 18432
    s_mov_b32 s62, 36864
    s_mov_b32 s63, 36864
    s_mov_b32 s58, 147456
    s_lshl_b32 s34, s31, 11
    s_lshr_b32 s35, s33, 1
    s_add_u32 s34, s34, s35
    s_add_u32 s34, s34, 67108864
    v_lshl_add_u32 v194, v195, 2, s34
    v_bfe_u32 v195, v2, 4, 1
    v_lshl_add_u32 v194, v195, 10, v194
    v_lshl_add_u32 v238, v197, 7, v194
    s_branch fused_kernel_wload
fused_kernel_w1:
    s_cmp_lt_u32 s31, 1872
    s_cbranch_scc0 fused_kernel_w2
    s_mov_b32 s20, s56
    s_mov_b32 s21, s57
    s_mov_b32 s22, 5308416
    s_sub_u32 s31, s31, 1296
    s_lshr_b32 s32, s31, 4
    s_lshl_b32 s32, s32, 7
    s_bfe_u32 s33, s31, 0x20002
    s_lshl_b32 s33, s33, 1
    s_add_u32 s32, s32, s33
    s_and_b32 s33, s31, 1
    s_lshl_b32 s33, s33, 5
    s_add_u32 s32, s32, s33
    s_lshr_b32 s33, s31, 2
    s_mul_i32 s35, s33, 7282
    s_lshr_b32 s35, s35, 16
    s_mul_i32 s35, s35, 9
    s_sub_u32 s33, s33, s35
    s_cmp_eq_u32 s33, 4
    s_cselect_b32 s33, 1, 64
    s_mov_b32 s62, 1152
    s_cselect_b32 s62, 73728, s62
    s_bfe_u32 s35, s31, 0x10001
    s_mul_i32 s33, s33, s35
    s_add_u32 s32, s32, s33
    s_mul_i32 s32, s32, 1152
    v_add_u32 v193, s32, v3
    s_lshr_b32 s32, s31, 2
    s_mul_i32 s33, s32, 3641
    s_lshr_b32 s33, s33, 16
    s_mul_i32 s33, s33, 18
    s_sub_u32 s32, s32, s33
    s_cmp_ge_u32 s32, 6
    s_mov_b32 s35, 114690080
    s_cselect_b32 s35, 275986596, s35
    s_cmp_ge_u32 s32, 12
    s_cselect_b32 s35, 582297103, s35
    s_mul_i32 s32, s32, 5
    s_cmp_ge_u32 s32, 30
    s_cselect_b32 s36, 30, 0
    s_sub_u32 s32, s32, s36
    s_cmp_ge_u32 s32, 30
    s_cselect_b32 s36, 30, 0
    s_sub_u32 s32, s32, s36
    s_lshr_b32 s35, s35, s32
    s_and_b32 s35, s35, 31
    s_add_u32 s32, s33, s35
    s_mul_i32 s32, s32, 9216
    s_and_b32 s33, s31, 3
    s_lshl_b32 s33, s33, 8
    s_add_u32 s32, s32, s33
    s_add_u32 s32, s32, 25165824
    v_lshrrev_b32 v194, 4, v2
    v_mul_u32_u24 v194, 1327104, v194
    v_and_b32 v195, 3, v2
    v_lshl_add_u32 v194, v195, 6, v194
    s_lshr_b32 s33, s31, 4
    s_mul_i32 s33, s33, 7282
    s_lshr_b32 s33, s33, 16
    v_bfe_u32 v195, v2, 2, 2
    v_xor_b32 v195, s33, v195
    v_lshl_add_u32 v194, v195, 4, v194
    v_add_u32 v14, s32, v194
    s_mov_b32 s60, 9216
    s_mov_b32 s61, 18432
    s_mov_b32 s63, 1024
    s_mov_b32 s58, 4096
    s_branch fused_kernel_wload
fused_kernel_w2:
    s_mov_b32 s20, s56
    s_mov_b32 s21, s57
    s_mov_b32 s22, 0
    v_mov_b32 v193, 0
    v_mov_b32 v14, 2146435072
    s_mov_b32 s60, 0
    s_mov_b32 s61, 0
    s_mov_b32 s62, 0
    s_mov_b32 s63, 0
    s_mov_b32 s58, 0
fused_kernel_wload:
    s_and_b32 s21, s21, 0xffff
    s_mov_b32 s23, 0x20000
    s_mov_b32 s40, 0
    s_mov_b32 s41, s60
    s_mov_b32 s42, s61
    s_add_u32 s43, s60, s61
    s_mov_b32 s44, s62
    s_add_u32 s45, s62, s41
    s_add_u32 s46, s62, s42
    s_add_u32 s47, s62, s43
    v_mov_b32 v12, v193
    s_lshl_b32 s61, s24, 8
    s_add_u32 s61, s61, s2
    s_mov_b32 s48, s56
    s_and_b32 s49, s57, 0xffff
    s_cmp_lt_u32 s61, 576
    s_cselect_b32 s50, 5308416, 0
    s_mov_b32 s34, 2146435072
    s_cselect_b32 s34, 25174016, s34
    s_mov_b32 s51, 0x20000
    s_lshr_b32 s32, s61, 4
    s_lshl_b32 s32, s32, 7
    s_bfe_u32 s33, s61, 0x20002
    s_lshl_b32 s33, s33, 1
    s_add_u32 s32, s32, s33
    s_and_b32 s33, s61, 1
    s_lshl_b32 s33, s33, 5
    s_add_u32 s32, s32, s33
    s_lshr_b32 s33, s61, 2
    s_mul_i32 s35, s33, 7282
    s_lshr_b32 s35, s35, 16
    s_mul_i32 s35, s35, 9
    s_sub_u32 s33, s33, s35
    s_cmp_eq_u32 s33, 4
    s_cselect_b32 s33, 1, 64
    s_mov_b32 s5, 1152
    s_cselect_b32 s5, 73728, s5
    s_bfe_u32 s35, s61, 0x10001
    s_mul_i32 s33, s33, s35
    s_add_u32 s32, s32, s33
    s_mul_i32 s32, s32, 1152
    s_add_u32 s32, s32, 1024
    v_lshl_add_u32 v13, v2, 1, s32
    s_lshr_b32 s32, s61, 2
    s_mul_i32 s33, s32, 3641
    s_lshr_b32 s33, s33, 16
    s_mul_i32 s33, s33, 18
    s_sub_u32 s32, s32, s33
    s_cmp_ge_u32 s32, 6
    s_mov_b32 s35, 114690080
    s_cselect_b32 s35, 275986596, s35
    s_cmp_ge_u32 s32, 12
    s_cselect_b32 s35, 582297103, s35
    s_mul_i32 s32, s32, 5
    s_cmp_ge_u32 s32, 30
    s_cselect_b32 s36, 30, 0
    s_sub_u32 s32, s32, s36
    s_cmp_ge_u32 s32, 30
    s_cselect_b32 s36, 30, 0
    s_sub_u32 s32, s32, s36
    s_lshr_b32 s35, s35, s32
    s_and_b32 s35, s35, 31
    s_add_u32 s32, s33, s35
    s_mul_i32 s32, s32, 9216
    s_and_b32 s33, s61, 3
    s_lshl_b32 s33, s33, 8
    s_add_u32 s32, s32, s33
    s_add_u32 s32, s32, s34
    v_lshrrev_b32 v194, 4, v2
    v_mul_u32_u24 v194, 1327104, v194
    v_and_b32 v195, 15, v2
    v_lshl_add_u32 v194, v195, 4, v194
    v_add_u32 v15, s32, v194
    v_and_b32 v192, 15, v2
    v_bfe_u32 v193, v2, 4, 1
    v_lshlrev_b32 v193, 2, v193
    v_cmp_eq_u32 vcc, v192, v193
    v_mov_b32 v194, 0x3f803f80
    v_add_u32 v193, 8, v193
    v_cndmask_b32 v140, 0, v194, vcc
    v_cmp_eq_u32 vcc, v192, v193
    v_mov_b32 v141, v140
    v_mov_b32 v142, v140
    v_mov_b32 v143, v140
    v_cndmask_b32 v248, 0, v194, vcc
    v_mov_b32 v249, v248
    v_mov_b32 v250, v248
    v_mov_b32 v251, v248
    v_mov_b32 v232, v3
    v_min_u32 v192, 17, v1
    v_lshrrev_b32 v193, 5, v2
    v_mul_u32_u24 v193, 288, v193
    v_lshl_add_u32 v235, v192, 4, v193
    v_lshlrev_b32 v239, 2, v2
    v_add_u32 v239, 8192, v239
    v_add_u32 v233, 65536, v232
    v_add_u32 v234, 131072, v232
    v_add_u32 v236, 65536, v235
    v_add_u32 v237, 131072, v235
    v_mov_b32 v9, 0
    v_mov_b32 v10, 0
    v_mov_b32 v32, 0
    v_mov_b32 v33, 0
    v_mov_b32 v34, 0
    v_mov_b32 v35, 0
    v_mov_b32 v36, 0
    v_mov_b32 v37, 0
    v_mov_b32 v38, 0
    v_mov_b32 v39, 0
    v_mov_b32 v40, 0
    v_mov_b32 v41, 0
    v_mov_b32 v42, 0
    v_mov_b32 v43, 0
    v_mov_b32 v44, 0
    v_mov_b32 v45, 0
    v_mov_b32 v46, 0
    v_mov_b32 v47, 0
    s_mov_b32 s28, 0x3ffff
    s_mov_b32 s29, 0x3ffff
    v_and_b32 v192, 27, v1
    v_cmp_eq_u32 vcc, 18, v192
    v_mov_b32 v193, 0x3f803f80
    s_nop 0
    v_cndmask_b32 v144, 0, v193, vcc
    v_mov_b32 v145, v144
    v_mov_b32 v146, v144
    v_mov_b32 v147, v144
    v_mov_b32 v148, v144
    v_mov_b32 v149, v144
    v_mov_b32 v150, v144
    v_mov_b32 v151, v144
    v_mov_b32 v152, v144
    v_mov_b32 v153, v144
    v_mov_b32 v154, v144
    v_mov_b32 v155, v144
    v_mov_b32 v156, v144
    v_mov_b32 v157, v144
    v_mov_b32 v158, v144
    v_mov_b32 v159, v144
    s_mov_b32 s39, s57
    s_cmp_lg_u32 s24, 0
    s_cbranch_scc1 fused_kernel_g1_n0
    s_lshl_b32 s33, s2, 7
    s_add_u32 s33, s33, 68321280
    v_mov_b32 v54, 0
    v_bfe_u32 v48, v2, 4, 1
    v_lshlrev_b32 v48, 6, v48
    v_and_b32 v49, 15, v2
    v_add3_u32 v48, v48, v49, 64
    s_lshr_b32 s34, s26, 3
    s_lshl_b32 s34, s34, 1
    v_and_b32 v49, 1, v2
    v_add_u32 v49, s34, v49
    v_cmp_gt_u32 vcc, 32, v2
    s_nop 1
    v_cndmask_b32 v54, v49, v48, vcc
    v_lshlrev_b32 v54, 7, v54
    s_lshr_b32 s33, s25, 3
    s_lshl_b32 s33, s33, 11
    s_add_u32 s33, s33, 68354048
    s_mov_b32 s57, 0
fused_kernel_g1_op:
    buffer_load_dword v55, v54, s[16:19], s33 offen sc1
    s_add_u32 s57, s57, 1
    s_waitcnt vmcnt(0)
    v_cmp_ne_u32 vcc, 1, v55
    s_cmp_gt_u32 s57, 0x40000
    s_cbranch_scc1 fused_kernel_g1_oq
    s_cbranch_vccz fused_kernel_g1_oq
    s_sleep 4
    s_branch fused_kernel_g1_op
fused_kernel_g1_oq:
fused_kernel_g1_n0:
    s_mov_b32 s57, s39
    s_barrier
    buffer_load_dwordx4 v[4:7], v3, s[16:19], s27 offen sc1
    buffer_load_dword v8, v240, s[16:19], s4 offen sc1
    s_add_u32 s31, s30, 0
    s_mov_b32 m0, s31
    s_nop 0
    buffer_load_dwordx4 v3, s[12:15], s31 offen sc1 lds
    s_add_u32 s31, s30, 8192
    s_mov_b32 m0, s31
    s_nop 0
    buffer_load_dwordx4 v3, s[12:15], s31 offen sc1 lds
    s_add_u32 s31, s30, 16384
    s_mov_b32 m0, s31
    s_nop 0
    buffer_load_dwordx4 v3, s[12:15], s31 offen sc1 lds
    s_add_u32 s31, s30, 24576
    s_mov_b32 m0, s31
    s_nop 0
    buffer_load_dwordx4 v3, s[12:15], s31 offen sc1 lds
    s_waitcnt vmcnt(2)
    v_mov_b32 v11, v8
    s_waitcnt lgkmcnt(0)
    s_barrier
    ds_read_b128 v[128:131], v232 offset:0
    ds_read_b128 v[132:135], v232 offset:1024
    ds_read2st64_b32 v[136:137], v239 offset0:0 offset1:1
    ds_read2st64_b32 v[138:139], v239 offset0:2 offset1:3
    v_add_u32 v239, 18432, v239
    s_mov_b64 exec, s[28:29]
    ds_read_b128 v[144:147], v235 offset:9216
    s_mov_b64 exec, -1
    s_mov_b64 exec, s[28:29]
    ds_read_b128 v[148:151], v235 offset:9792
    s_mov_b64 exec, -1
    s_mov_b64 exec, s[28:29]
    ds_read_b128 v[152:155], v235 offset:10368
    s_mov_b64 exec, -1
    s_mov_b64 exec, s[28:29]
    ds_read_b128 v[156:159], v235 offset:10944
    s_mov_b64 exec, -1
    s_waitcnt lgkmcnt(4)
    v_mfma_f32_32x32x16_bf16 v[80:95], v[128:131], v[4:7], 0
    v_mfma_f32_32x32x16_bf16 v[96:111], v[132:135], v[4:7], 0
    s_nop 9
    v_mfma_f32_32x32x4_2b_bf16 v[80:111], v[136:137], v[8:9], v[80:111]
    s_nop 15
    s_nop 3
    v_max3_f32 v192, v80, v81, v82
    v_max3_f32 v193, v83, v84, v85
    v_max3_f32 v192, v192, v86, v87
    v_max3_f32 v193, v193, v88, v89
    v_max3_f32 v192, v192, v90, v91
    v_max3_f32 v193, v193, v92, v93
    v_max3_f32 v192, v192, v94, v95
    v_max3_f32 v193, v193, v96, v97
    v_max3_f32 v192, v192, v98, v99
    v_max3_f32 v193, v193, v100, v101
    v_max3_f32 v192, v192, v102, v103
    v_max3_f32 v193, v193, v104, v105
    v_max3_f32 v192, v192, v106, v107
    v_max3_f32 v193, v193, v108, v109
    v_max3_f32 v192, v192, v110, v111
    v_max_f32 v192, v192, v193
    v_mov_b32 v193, v192
    s_nop 1
    v_permlane32_swap_b32 v192, v193
    v_max_f32 v192, v192, v193
    v_sub_f32 v16, 0, v192
    v_sub_f32 v17, 0, v192
    v_sub_f32 v18, 0, v192
    v_sub_f32 v19, 0, v192
    v_sub_f32 v20, 0, v192
    v_sub_f32 v21, 0, v192
    v_sub_f32 v22, 0, v192
    v_sub_f32 v23, 0, v192
    v_sub_f32 v24, 0, v192
    v_sub_f32 v25, 0, v192
    v_sub_f32 v26, 0, v192
    v_sub_f32 v27, 0, v192
    v_sub_f32 v28, 0, v192
    v_sub_f32 v29, 0, v192
    v_sub_f32 v30, 0, v192
    v_sub_f32 v31, 0, v192
    s_nop 1
    v_mfma_f32_32x32x16_bf16 v[48:63], v[128:131], v[4:7], v[16:31]
    ds_read_b128 v[128:131], v232 offset:2048
    v_mfma_f32_32x32x16_bf16 v[64:79], v[132:135], v[4:7], v[16:31]
    ds_read_b128 v[132:135], v232 offset:3072
    s_nop 8
    v_mfma_f32_32x32x4_2b_bf16 v[48:79], v[136:137], v[8:9], v[48:79]
    s_waitcnt lgkmcnt(0)
    s_mov_b32 s37, 0x05040100
    s_mov_b32 s38, 0x07060302
    s_add_u32 s31, s30, 32768
    s_mov_b32 m0, s31
    s_nop 0
    buffer_load_dwordx4 v3, s[12:15], s31 offen sc1 lds
    s_add_u32 s31, s30, 40960
    s_mov_b32 m0, s31
    s_nop 0
    buffer_load_dwordx4 v3, s[12:15], s31 offen sc1 lds
    s_setprio 3
    s_nop 7
    v_exp_f32 v48, v48
    v_exp_f32 v49, v49
    v_exp_f32 v50, v50
    v_exp_f32 v51, v51
    v_exp_f32 v52, v52
    v_exp_f32 v53, v53
    v_exp_f32 v54, v54
    v_exp_f32 v55, v55
    v_mfma_f32_32x32x16_bf16 v[80:95], v[128:131], v[4:7], v[16:31]
    ds_read_b128 v[128:131], v232 offset:4096
    s_add_u32 s31, s30, 49152
    s_mov_b32 m0, s31
    s_nop 0
    buffer_load_dwordx4 v3, s[12:15], s31 offen sc1 lds
    v_cvt_pk_bf16_f32 v112, v48, v49
    v_cvt_pk_bf16_f32 v113, v50, v51
    v_cvt_pk_bf16_f32 v114, v52, v53
    v_cvt_pk_bf16_f32 v115, v54, v55
    v_exp_f32 v56, v56
    v_exp_f32 v57, v57
    v_exp_f32 v58, v58
    s_waitcnt lgkmcnt(4)
    v_mfma_f32_32x32x16_bf16 v[32:47], v[144:147], v[112:115], v[32:47]
    s_mov_b64 exec, s[28:29]
    ds_read_b128 v[144:147], v235 offset:11520
    s_mov_b64 exec, -1
    v_exp_f32 v59, v59
    v_exp_f32 v60, v60
    v_exp_f32 v61, v61
    v_exp_f32 v62, v62
    v_exp_f32 v63, v63
    v_mfma_f32_32x32x16_bf16 v[96:111], v[132:135], v[4:7], v[16:31]
    ds_read_b128 v[132:135], v232 offset:5120
    s_add_u32 s31, s30, 57344
    s_mov_b32 m0, s31
    s_nop 0
    buffer_load_dwordx4 v3, s[12:15], s31 offen sc1 lds
    v_cvt_pk_bf16_f32 v116, v56, v57
    v_cvt_pk_bf16_f32 v117, v58, v59
    v_cvt_pk_bf16_f32 v118, v60, v61
    v_cvt_pk_bf16_f32 v119, v62, v63
    v_exp_f32 v64, v64
    v_exp_f32 v65, v65
    s_waitcnt lgkmcnt(4)
    v_mfma_f32_32x32x16_bf16 v[32:47], v[148:151], v[116:119], v[32:47]
    s_mov_b64 exec, s[28:29]
    ds_read_b128 v[148:151], v235 offset:12096
    s_mov_b64 exec, -1
    v_exp_f32 v66, v66
    v_exp_f32 v67, v67
    v_exp_f32 v68, v68
    v_mfma_f32_32x32x4_2b_bf16 v[80:111], v[136:137], v[10:11], v[80:111]
    v_exp_f32 v69, v69
    v_exp_f32 v70, v70
    v_exp_f32 v71, v71
    v_cvt_pk_bf16_f32 v120, v64, v65
    v_cvt_pk_bf16_f32 v121, v66, v67
    v_cvt_pk_bf16_f32 v122, v68, v69
    v_cvt_pk_bf16_f32 v123, v70, v71
    v_exp_f32 v72, v72
    v_exp_f32 v73, v73
    v_exp_f32 v74, v74
    s_waitcnt lgkmcnt(4)
    v_mfma_f32_32x32x16_bf16 v[32:47], v[152:155], v[120:123], v[32:47]
    s_mov_b64 exec, s[28:29]
    ds_read_b128 v[152:155], v235 offset:12672
    s_mov_b64 exec, -1
    v_exp_f32 v75, v75
    v_exp_f32 v76, v76
    v_exp_f32 v77, v77
    v_exp_f32 v78, v78
    v_exp_f32 v79, v79
    v_cvt_pk_bf16_f32 v124, v72, v73
    v_cvt_pk_bf16_f32 v125, v74, v75
    v_cvt_pk_bf16_f32 v126, v76, v77
    v_cvt_pk_bf16_f32 v127, v78, v79
    s_waitcnt vmcnt(4)
    s_barrier
    v_exp_f32 v80, v80
    v_exp_f32 v81, v81
    v_exp_f32 v82, v82
    s_waitcnt lgkmcnt(4)
    v_mfma_f32_32x32x16_bf16 v[32:47], v[156:159], v[124:127], v[32:47]
    s_mov_b64 exec, s[28:29]
    ds_read_b128 v[156:159], v235 offset:13248
    s_mov_b64 exec, -1
    v_exp_f32 v83, v83
    v_exp_f32 v84, v84
    v_exp_f32 v85, v85
    v_exp_f32 v86, v86
    v_exp_f32 v87, v87
    v_mfma_f32_32x32x16_bf16 v[48:63], v[128:131], v[4:7], v[16:31]
    ds_read_b128 v[128:131], v232 offset:6144
    s_add_u32 s31, s30, 65536
    s_mov_b32 m0, s31
    s_nop 0
    buffer_load_dwordx4 v3, s[12:15], s31 offen sc1 lds
    v_cvt_pk_bf16_f32 v112, v80, v81
    v_cvt_pk_bf16_f32 v113, v82, v83
    v_cvt_pk_bf16_f32 v114, v84, v85
    v_cvt_pk_bf16_f32 v115, v86, v87
    v_exp_f32 v88, v88
    v_exp_f32 v89, v89
    v_exp_f32 v90, v90
    s_waitcnt lgkmcnt(4)
    v_mfma_f32_32x32x16_bf16 v[32:47], v[144:147], v[112:115], v[32:47]
    s_mov_b64 exec, s[28:29]
    ds_read_b128 v[144:147], v235 offset:13824
    s_mov_b64 exec, -1
    v_exp_f32 v91, v91
    v_exp_f32 v92, v92
    v_exp_f32 v93, v93
    v_exp_f32 v94, v94
    v_exp_f32 v95, v95
    v_mfma_f32_32x32x16_bf16 v[64:79], v[132:135], v[4:7], v[16:31]
    ds_read_b128 v[132:135], v232 offset:7168
    s_add_u32 s31, s30, 73728
    s_mov_b32 m0, s31
    s_nop 0
    buffer_load_dwordx4 v3, s[12:15], s31 offen sc1 lds
    v_cvt_pk_bf16_f32 v116, v88, v89
    v_cvt_pk_bf16_f32 v117, v90, v91
    v_cvt_pk_bf16_f32 v118, v92, v93
    v_cvt_pk_bf16_f32 v119, v94, v95
    v_exp_f32 v96, v96
    v_exp_f32 v97, v97
    s_waitcnt lgkmcnt(4)
    v_mfma_f32_32x32x16_bf16 v[32:47], v[148:151], v[116:119], v[32:47]
    s_mov_b64 exec, s[28:29]
    ds_read_b128 v[148:151], v235 offset:14400
    s_mov_b64 exec, -1
    v_exp_f32 v98, v98
    v_exp_f32 v99, v99
    v_exp_f32 v100, v100
    v_mfma_f32_32x32x4_2b_bf16 v[48:79], v[138:139], v[8:9], v[48:79]
    v_exp_f32 v101, v101
    v_exp_f32 v102, v102
    v_exp_f32 v103, v103
    v_cvt_pk_bf16_f32 v120, v96, v97
    v_cvt_pk_bf16_f32 v121, v98, v99
    v_cvt_pk_bf16_f32 v122, v100, v101
    v_cvt_pk_bf16_f32 v123, v102, v103
    v_exp_f32 v104, v104
    v_exp_f32 v105, v105
    v_exp_f32 v106, v106
    s_waitcnt lgkmcnt(4)
    v_mfma_f32_32x32x16_bf16 v[32:47], v[152:155], v[120:123], v[32:47]
    s_mov_b64 exec, s[28:29]
    ds_read_b128 v[152:155], v235 offset:14976
    s_mov_b64 exec, -1
    v_exp_f32 v107, v107
    v_exp_f32 v108, v108
    v_exp_f32 v109, v109
    v_exp_f32 v110, v110
    v_exp_f32 v111, v111
    v_cvt_pk_bf16_f32 v124, v104, v105
    v_cvt_pk_bf16_f32 v125, v106, v107
    v_cvt_pk_bf16_f32 v126, v108, v109
    v_cvt_pk_bf16_f32 v127, v110, v111
    v_exp_f32 v48, v48
    v_exp_f32 v49, v49
    v_exp_f32 v50, v50
    s_waitcnt lgkmcnt(4)
    v_mfma_f32_32x32x16_bf16 v[32:47], v[156:159], v[124:127], v[32:47]
    s_mov_b64 exec, s[28:29]
    ds_read_b128 v[156:159], v235 offset:15552
    s_mov_b64 exec, -1
    v_exp_f32 v51, v51
    v_exp_f32 v52, v52
    v_exp_f32 v53, v53
    v_exp_f32 v54, v54
    v_exp_f32 v55, v55
    v_mfma_f32_32x32x16_bf16 v[80:95], v[128:131], v[4:7], v[16:31]
    ds_read_b128 v[128:131], v232 offset:18432
    s_add_u32 s31, s30, 81920
    s_mov_b32 m0, s31
    s_nop 0
    buffer_load_dwordx4 v3, s[12:15], s31 offen sc1 lds
    v_cvt_pk_bf16_f32 v112, v48, v49
    v_cvt_pk_bf16_f32 v113, v50, v51
    v_cvt_pk_bf16_f32 v114, v52, v53
    v_cvt_pk_bf16_f32 v115, v54, v55
    v_exp_f32 v56, v56
    v_exp_f32 v57, v57
    v_exp_f32 v58, v58
    s_waitcnt lgkmcnt(4)
    v_mfma_f32_32x32x16_bf16 v[32:47], v[144:147], v[112:115], v[32:47]
    s_mov_b64 exec, s[28:29]
    ds_read_b128 v[144:147], v235 offset:16128
    s_mov_b64 exec, -1
    v_exp_f32 v59, v59
    v_exp_f32 v60, v60
    v_exp_f32 v61, v61
    v_exp_f32 v62, v62
    v_exp_f32 v63, v63
    v_mfma_f32_32x32x16_bf16 v[96:111], v[132:135], v[4:7], v[16:31]
    ds_read_b128 v[132:135], v232 offset:19456
    s_add_u32 s31, s30, 90112
    s_mov_b32 m0, s31
    s_nop 0
    buffer_load_dwordx4 v3, s[12:15], s31 offen sc1 lds
    v_cvt_pk_bf16_f32 v116, v56, v57
    v_cvt_pk_bf16_f32 v117, v58, v59
    v_cvt_pk_bf16_f32 v118, v60, v61
    v_cvt_pk_bf16_f32 v119, v62, v63
    v_exp_f32 v64, v64
    v_exp_f32 v65, v65
    s_waitcnt lgkmcnt(4)
    v_mfma_f32_32x32x16_bf16 v[32:47], v[148:151], v[116:119], v[32:47]
    s_mov_b64 exec, s[28:29]
    ds_read_b128 v[148:151], v235 offset:16704
    s_mov_b64 exec, -1
    v_exp_f32 v66, v66
    v_exp_f32 v67, v67
    v_exp_f32 v68, v68
    v_mfma_f32_32x32x4_2b_bf16 v[80:111], v[138:139], v[10:11], v[80:111]
    v_exp_f32 v69, v69
    v_exp_f32 v70, v70
    v_exp_f32 v71, v71
    v_cvt_pk_bf16_f32 v120, v64, v65
    v_cvt_pk_bf16_f32 v121, v66, v67
    v_cvt_pk_bf16_f32 v122, v68, v69
    v_cvt_pk_bf16_f32 v123, v70, v71
    v_exp_f32 v72, v72
    v_exp_f32 v73, v73
    v_exp_f32 v74, v74
    s_waitcnt lgkmcnt(4)
    v_mfma_f32_32x32x16_bf16 v[32:47], v[152:155], v[120:123], v[32:47]
    s_mov_b64 exec, s[28:29]
    ds_read_b128 v[152:155], v235 offset:17280
    s_mov_b64 exec, -1
    v_exp_f32 v75, v75
    v_exp_f32 v76, v76
    v_exp_f32 v77, v77
    v_exp_f32 v78, v78
    v_exp_f32 v79, v79
    ds_read2st64_b32 v[136:137], v239 offset0:0 offset1:1
    ds_read2st64_b32 v[138:139], v239 offset0:2 offset1:3
    v_add_u32 v239, 18432, v239
    v_cvt_pk_bf16_f32 v124, v72, v73
    v_cvt_pk_bf16_f32 v125, v74, v75
    v_cvt_pk_bf16_f32 v126, v76, v77
    v_cvt_pk_bf16_f32 v127, v78, v79
    s_cmp_lt_u32 s2, 248
    s_cbranch_scc1 fused_kernel_g1_nm
    s_cmp_lg_u32 s24, 1
    s_cbranch_scc1 fused_kernel_g1_nm
    v_lshlrev_b32 v198, 7, v2
    s_mov_b32 s57, 0
fused_kernel_g1_gp:
    s_sleep 2
    s_mov_b32 s33, 68354048
    buffer_load_dword v192, v198, s[16:19], s33 offen sc1
    s_add_u32 s33, s33, 8192
    buffer_load_dword v193, v198, s[16:19], s33 offen sc1
    s_add_u32 s33, s33, 8192
    buffer_load_dword v194, v198, s[16:19], s33 offen sc1
    s_add_u32 s33, s33, 8192
    buffer_load_dword v195, v198, s[16:19], s33 offen sc1
    s_add_u32 s57, s57, 1
    s_waitcnt vmcnt(0)
    v_and_b32 v192, v192, v193
    v_and_b32 v194, v194, v195
    v_and_b32 v192, v192, v194
    v_cmp_ne_u32 vcc, 1, v192
    s_cmp_gt_u32 s57, 0x40000
    s_cbranch_scc1 fused_kernel_g1_gq
    s_cbranch_vccnz fused_kernel_g1_gp
fused_kernel_g1_gq:
    s_and_b32 s33, s2, 7
    s_lshl_b32 s33, s33, 7
    s_add_u32 s33, s33, 68321280
    v_lshlrev_b32 v198, 10, v1
    v_mov_b32 v199, 1
    buffer_store_dword v199, v198, s[16:19], s33 offen sc1
fused_kernel_g1_nm:
    v_exp_f32 v80, v80
    v_exp_f32 v81, v81
    v_exp_f32 v82, v82
    s_waitcnt lgkmcnt(4)
    v_mfma_f32_32x32x16_bf16 v[32:47], v[156:159], v[124:127], v[32:47]
    s_mov_b64 exec, s[28:29]
    ds_read_b128 v[156:159], v235 offset:17856
    s_mov_b64 exec, -1
    v_exp_f32 v83, v83
    v_exp_f32 v84, v84
    v_exp_f32 v85, v85
    v_exp_f32 v86, v86
    v_exp_f32 v87, v87
    v_mfma_f32_32x32x16_bf16 v[48:63], v[128:131], v[4:7], v[16:31]
    ds_read_b128 v[128:131], v232 offset:20480
    s_add_u32 s31, s30, 98304
    s_mov_b32 m0, s31
    s_nop 0
    buffer_load_dwordx4 v3, s[12:15], s31 offen sc1 lds
    v_cvt_pk_bf16_f32 v112, v80, v81
    v_cvt_pk_bf16_f32 v113, v82, v83
    v_cvt_pk_bf16_f32 v114, v84, v85
    v_cvt_pk_bf16_f32 v115, v86, v87
    v_exp_f32 v88, v88
    v_exp_f32 v89, v89
    v_exp_f32 v90, v90
    s_waitcnt lgkmcnt(4)
    v_mfma_f32_32x32x16_bf16 v[32:47], v[144:147], v[112:115], v[32:47]
    s_mov_b64 exec, s[28:29]
    ds_read_b128 v[144:147], v235 offset:27648
    s_mov_b64 exec, -1
    v_exp_f32 v91, v91
    v_exp_f32 v92, v92
    v_exp_f32 v93, v93
    v_exp_f32 v94, v94
    v_exp_f32 v95, v95
    v_mfma_f32_32x32x16_bf16 v[64:79], v[132:135], v[4:7], v[16:31]
    ds_read_b128 v[132:135], v232 offset:21504
    s_add_u32 s31, s30, 106496
    s_mov_b32 m0, s31
    s_nop 0
    buffer_load_dwordx4 v3, s[12:15], s31 offen sc1 lds
    v_cvt_pk_bf16_f32 v116, v88, v89
    v_cvt_pk_bf16_f32 v117, v90, v91
    v_cvt_pk_bf16_f32 v118, v92, v93
    v_cvt_pk_bf16_f32 v119, v94, v95
    v_exp_f32 v96, v96
    v_exp_f32 v97, v97
    s_waitcnt lgkmcnt(4)
    v_mfma_f32_32x32x16_bf16 v[32:47], v[148:151], v[116:119], v[32:47]
    s_mov_b64 exec, s[28:29]
    ds_read_b128 v[148:151], v235 offset:28224
    s_mov_b64 exec, -1
    v_exp_f32 v98, v98
    v_exp_f32 v99, v99
    v_exp_f32 v100, v100
    v_mfma_f32_32x32x4_2b_bf16 v[48:79], v[136:137], v[8:9], v[48:79]
    v_exp_f32 v101, v101
    v_exp_f32 v102, v102
    v_exp_f32 v103, v103
    v_cvt_pk_bf16_f32 v120, v96, v97
    v_cvt_pk_bf16_f32 v121, v98, v99
    v_cvt_pk_bf16_f32 v122, v100, v101
    v_cvt_pk_bf16_f32 v123, v102, v103
    v_exp_f32 v104, v104
    v_exp_f32 v105, v105
    v_exp_f32 v106, v106
    s_waitcnt lgkmcnt(4)
    v_mfma_f32_32x32x16_bf16 v[32:47], v[152:155], v[120:123], v[32:47]
    s_mov_b64 exec, s[28:29]
    ds_read_b128 v[152:155], v235 offset:28800
    s_mov_b64 exec, -1
    v_exp_f32 v107, v107
    v_exp_f32 v108, v108
    v_exp_f32 v109, v109
    v_exp_f32 v110, v110
    v_exp_f32 v111, v111
    buffer_load_dwordx4 v[160:163], v12, s[20:23], s40 offen nt
    v_cvt_pk_bf16_f32 v124, v104, v105
    v_cvt_pk_bf16_f32 v125, v106, v107
    v_cvt_pk_bf16_f32 v126, v108, v109
    v_cvt_pk_bf16_f32 v127, v110, v111
    s_waitcnt vmcnt(6)
    s_barrier
    v_exp_f32 v48, v48
    v_exp_f32 v49, v49
    v_exp_f32 v50, v50
    s_waitcnt lgkmcnt(4)
    v_mfma_f32_32x32x16_bf16 v[32:47], v[156:159], v[124:127], v[32:47]
    s_mov_b64 exec, s[28:29]
    ds_read_b128 v[156:159], v235 offset:29376
    s_mov_b64 exec, -1
    v_exp_f32 v51, v51
    v_exp_f32 v52, v52
    v_exp_f32 v53, v53
    v_exp_f32 v54, v54
    v_exp_f32 v55, v55
    v_mfma_f32_32x32x16_bf16 v[80:95], v[128:131], v[4:7], v[16:31]
    ds_read_b128 v[128:131], v232 offset:22528
    s_add_u32 s31, s30, 114688
    s_mov_b32 m0, s31
    s_nop 0
    buffer_load_dwordx4 v3, s[12:15], s31 offen sc1 lds
    v_cvt_pk_bf16_f32 v112, v48, v49
    v_cvt_pk_bf16_f32 v113, v50, v51
    v_cvt_pk_bf16_f32 v114, v52, v53
    v_cvt_pk_bf16_f32 v115, v54, v55
    v_exp_f32 v56, v56
    v_exp_f32 v57, v57
    v_exp_f32 v58, v58
    s_waitcnt lgkmcnt(4)
    v_mfma_f32_32x32x16_bf16 v[32:47], v[144:147], v[112:115], v[32:47]
    s_mov_b64 exec, s[28:29]
    ds_read_b128 v[144:147], v235 offset:29952
    s_mov_b64 exec, -1
    v_exp_f32 v59, v59
    v_exp_f32 v60, v60
    v_exp_f32 v61, v61
    v_exp_f32 v62, v62
    v_exp_f32 v63, v63
    v_mfma_f32_32x32x16_bf16 v[96:111], v[132:135], v[4:7], v[16:31]
    ds_read_b128 v[132:135], v232 offset:23552
    s_add_u32 s31, s30, 122880
    s_mov_b32 m0, s31
    s_nop 0
    buffer_load_dwordx4 v3, s[12:15], s31 offen sc1 lds
    v_cvt_pk_bf16_f32 v116, v56, v57
    v_cvt_pk_bf16_f32 v117, v58, v59
    v_cvt_pk_bf16_f32 v118, v60, v61
    v_cvt_pk_bf16_f32 v119, v62, v63
    v_exp_f32 v64, v64
    v_exp_f32 v65, v65
    s_waitcnt lgkmcnt(4)
    v_mfma_f32_32x32x16_bf16 v[32:47], v[148:151], v[116:119], v[32:47]
    s_mov_b64 exec, s[28:29]
    ds_read_b128 v[148:151], v235 offset:30528
    s_mov_b64 exec, -1
    v_exp_f32 v66, v66
    v_exp_f32 v67, v67
    v_exp_f32 v68, v68
    v_mfma_f32_32x32x4_2b_bf16 v[80:111], v[136:137], v[10:11], v[80:111]
    v_exp_f32 v69, v69
    v_exp_f32 v70, v70
    v_exp_f32 v71, v71
    v_cvt_pk_bf16_f32 v120, v64, v65
    v_cvt_pk_bf16_f32 v121, v66, v67
    v_cvt_pk_bf16_f32 v122, v68, v69
    v_cvt_pk_bf16_f32 v123, v70, v71
    v_exp_f32 v72, v72
    v_exp_f32 v73, v73
    v_exp_f32 v74, v74
    s_waitcnt lgkmcnt(4)
    v_mfma_f32_32x32x16_bf16 v[32:47], v[152:155], v[120:123], v[32:47]
    s_mov_b64 exec, s[28:29]
    ds_read_b128 v[152:155], v235 offset:31104
    s_mov_b64 exec, -1
    v_exp_f32 v75, v75
    v_exp_f32 v76, v76
    v_exp_f32 v77, v77
    v_exp_f32 v78, v78
    v_exp_f32 v79, v79
    v_cvt_pk_bf16_f32 v124, v72, v73
    v_cvt_pk_bf16_f32 v125, v74, v75
    v_cvt_pk_bf16_f32 v126, v76, v77
    v_cvt_pk_bf16_f32 v127, v78, v79
    v_exp_f32 v80, v80
    v_exp_f32 v81, v81
    v_exp_f32 v82, v82
    s_waitcnt lgkmcnt(4)
    v_mfma_f32_32x32x16_bf16 v[32:47], v[156:159], v[124:127], v[32:47]
    s_mov_b64 exec, s[28:29]
    ds_read_b128 v[156:159], v235 offset:31680
    s_mov_b64 exec, -1
    v_exp_f32 v83, v83
    v_exp_f32 v84, v84
    v_exp_f32 v85, v85
    v_exp_f32 v86, v86
    v_exp_f32 v87, v87
    v_mfma_f32_32x32x16_bf16 v[48:63], v[128:131], v[4:7], v[16:31]
    ds_read_b128 v[128:131], v232 offset:24576
    s_add_u32 s31, s30, 131072
    s_mov_b32 m0, s31
    s_nop 0
    buffer_load_dwordx4 v3, s[12:15], s31 offen sc1 lds
    v_cvt_pk_bf16_f32 v112, v80, v81
    v_cvt_pk_bf16_f32 v113, v82, v83
    v_cvt_pk_bf16_f32 v114, v84, v85
    v_cvt_pk_bf16_f32 v115, v86, v87
    v_exp_f32 v88, v88
    v_exp_f32 v89, v89
    v_exp_f32 v90, v90
    s_waitcnt lgkmcnt(4)
    v_mfma_f32_32x32x16_bf16 v[32:47], v[144:147], v[112:115], v[32:47]
    s_mov_b64 exec, s[28:29]
    ds_read_b128 v[144:147], v235 offset:32256
    s_mov_b64 exec, -1
    v_exp_f32 v91, v91
    v_exp_f32 v92, v92
    v_exp_f32 v93, v93
    v_exp_f32 v94, v94
    v_exp_f32 v95, v95
    v_mfma_f32_32x32x16_bf16 v[64:79], v[132:135], v[4:7], v[16:31]
    ds_read_b128 v[132:135], v232 offset:25600
    s_add_u32 s31, s30, 139264
    s_mov_b32 m0, s31
    s_nop 0
    buffer_load_dwordx4 v3, s[12:15], s31 offen sc1 lds
    v_cvt_pk_bf16_f32 v116, v88, v89
    v_cvt_pk_bf16_f32 v117, v90, v91
    v_cvt_pk_bf16_f32 v118, v92, v93
    v_cvt_pk_bf16_f32 v119, v94, v95
    v_exp_f32 v96, v96
    v_exp_f32 v97, v97
    s_waitcnt lgkmcnt(4)
    v_mfma_f32_32x32x16_bf16 v[32:47], v[148:151], v[116:119], v[32:47]
    s_mov_b64 exec, s[28:29]
    ds_read_b128 v[148:151], v235 offset:32832
    s_mov_b64 exec, -1
    v_exp_f32 v98, v98
    v_exp_f32 v99, v99
    v_exp_f32 v100, v100
    v_mfma_f32_32x32x4_2b_bf16 v[48:79], v[138:139], v[8:9], v[48:79]
    v_exp_f32 v101, v101
    v_exp_f32 v102, v102
    v_exp_f32 v103, v103
    v_cvt_pk_bf16_f32 v120, v96, v97
    v_cvt_pk_bf16_f32 v121, v98, v99
    v_cvt_pk_bf16_f32 v122, v100, v101
    v_cvt_pk_bf16_f32 v123, v102, v103
    v_exp_f32 v104, v104
    v_exp_f32 v105, v105
    v_exp_f32 v106, v106
    s_waitcnt lgkmcnt(4)
    v_mfma_f32_32x32x16_bf16 v[32:47], v[152:155], v[120:123], v[32:47]
    s_mov_b64 exec, s[28:29]
    ds_read_b128 v[152:155], v235 offset:33408
    s_mov_b64 exec, -1
    v_exp_f32 v107, v107
    v_exp_f32 v108, v108
    v_exp_f32 v109, v109
    v_exp_f32 v110, v110
    v_exp_f32 v111, v111
    buffer_load_dwordx4 v[164:167], v12, s[20:23], s41 offen nt
    v_cvt_pk_bf16_f32 v124, v104, v105
    v_cvt_pk_bf16_f32 v125, v106, v107
    v_cvt_pk_bf16_f32 v126, v108, v109
    v_cvt_pk_bf16_f32 v127, v110, v111
    v_exp_f32 v48, v48
    v_exp_f32 v49, v49
    v_exp_f32 v50, v50
    s_waitcnt lgkmcnt(4)
    v_mfma_f32_32x32x16_bf16 v[32:47], v[156:159], v[124:127], v[32:47]
    s_mov_b64 exec, s[28:29]
    ds_read_b128 v[156:159], v235 offset:33984
    s_mov_b64 exec, -1
    v_exp_f32 v51, v51
    v_exp_f32 v52, v52
    v_exp_f32 v53, v53
    v_exp_f32 v54, v54
    v_exp_f32 v55, v55
    v_mfma_f32_32x32x16_bf16 v[80:95], v[128:131], v[4:7], v[16:31]
    ds_read_b128 v[128:131], v232 offset:36864
    v_cvt_pk_bf16_f32 v112, v48, v49
    v_cvt_pk_bf16_f32 v113, v50, v51
    v_cvt_pk_bf16_f32 v114, v52, v53
    v_cvt_pk_bf16_f32 v115, v54, v55
    v_exp_f32 v56, v56
    v_exp_f32 v57, v57
    v_exp_f32 v58, v58
    s_waitcnt lgkmcnt(4)
    v_mfma_f32_32x32x16_bf16 v[32:47], v[144:147], v[112:115], v[32:47]
    s_mov_b64 exec, s[28:29]
    ds_read_b128 v[144:147], v235 offset:34560
    s_mov_b64 exec, -1
    v_exp_f32 v59, v59
    v_exp_f32 v60, v60
    v_exp_f32 v61, v61
    v_exp_f32 v62, v62
    v_exp_f32 v63, v63
    v_mfma_f32_32x32x16_bf16 v[96:111], v[132:135], v[4:7], v[16:31]
    ds_read_b128 v[132:135], v232 offset:37888
    v_cvt_pk_bf16_f32 v116, v56, v57
    v_cvt_pk_bf16_f32 v117, v58, v59
    v_cvt_pk_bf16_f32 v118, v60, v61
    v_cvt_pk_bf16_f32 v119, v62, v63
    v_exp_f32 v64, v64
    v_exp_f32 v65, v65
    s_waitcnt lgkmcnt(4)
    v_mfma_f32_32x32x16_bf16 v[32:47], v[148:151], v[116:119], v[32:47]
    s_mov_b64 exec, s[28:29]
    ds_read_b128 v[148:151], v235 offset:35136
    s_mov_b64 exec, -1
    v_exp_f32 v66, v66
    v_exp_f32 v67, v67
    v_exp_f32 v68, v68
    v_mfma_f32_32x32x4_2b_bf16 v[80:111], v[138:139], v[10:11], v[80:111]
    v_exp_f32 v69, v69
    v_exp_f32 v70, v70
    v_exp_f32 v71, v71
    v_cvt_pk_bf16_f32 v120, v64, v65
    v_cvt_pk_bf16_f32 v121, v66, v67
    v_cvt_pk_bf16_f32 v122, v68, v69
    v_cvt_pk_bf16_f32 v123, v70, v71
    v_exp_f32 v72, v72
    v_exp_f32 v73, v73
    v_exp_f32 v74, v74
    s_waitcnt lgkmcnt(4)
    v_mfma_f32_32x32x16_bf16 v[32:47], v[152:155], v[120:123], v[32:47]
    s_mov_b64 exec, s[28:29]
    ds_read_b128 v[152:155], v235 offset:35712
    s_mov_b64 exec, -1
    v_exp_f32 v75, v75
    v_exp_f32 v76, v76
    v_exp_f32 v77, v77
    v_exp_f32 v78, v78
    v_exp_f32 v79, v79
    ds_read2st64_b32 v[136:137], v239 offset0:0 offset1:1
    ds_read2st64_b32 v[138:139], v239 offset0:2 offset1:3
    v_add_u32 v239, 18432, v239
    v_cvt_pk_bf16_f32 v124, v72, v73
    v_cvt_pk_bf16_f32 v125, v74, v75
    v_cvt_pk_bf16_f32 v126, v76, v77
    v_cvt_pk_bf16_f32 v127, v78, v79
    v_exp_f32 v80, v80
    v_exp_f32 v81, v81
    v_exp_f32 v82, v82
    s_waitcnt lgkmcnt(4)
    v_mfma_f32_32x32x16_bf16 v[32:47], v[156:159], v[124:127], v[32:47]
    s_mov_b64 exec, s[28:29]
    ds_read_b128 v[156:159], v235 offset:36288
    s_mov_b64 exec, -1
    v_exp_f32 v83, v83
    v_exp_f32 v84, v84
    v_exp_f32 v85, v85
    v_exp_f32 v86, v86
    v_exp_f32 v87, v87
    v_mfma_f32_32x32x16_bf16 v[48:63], v[128:131], v[4:7], v[16:31]
    ds_read_b128 v[128:131], v232 offset:38912
    v_cvt_pk_bf16_f32 v112, v80, v81
    v_cvt_pk_bf16_f32 v113, v82, v83
    v_cvt_pk_bf16_f32 v114, v84, v85
    v_cvt_pk_bf16_f32 v115, v86, v87
    v_exp_f32 v88, v88
    v_exp_f32 v89, v89
    v_exp_f32 v90, v90
    s_waitcnt lgkmcnt(4)
    v_mfma_f32_32x32x16_bf16 v[32:47], v[144:147], v[112:115], v[32:47]
    s_mov_b64 exec, s[28:29]
    ds_read_b128 v[144:147], v235 offset:46080
    s_mov_b64 exec, -1
    v_exp_f32 v91, v91
    v_exp_f32 v92, v92
    v_exp_f32 v93, v93
    v_exp_f32 v94, v94
    v_exp_f32 v95, v95
    v_mfma_f32_32x32x16_bf16 v[64:79], v[132:135], v[4:7], v[16:31]
    ds_read_b128 v[132:135], v232 offset:39936
    v_cvt_pk_bf16_f32 v116, v88, v89
    v_cvt_pk_bf16_f32 v117, v90, v91
    v_cvt_pk_bf16_f32 v118, v92, v93
    v_cvt_pk_bf16_f32 v119, v94, v95
    v_exp_f32 v96, v96
    v_exp_f32 v97, v97
    s_waitcnt lgkmcnt(4)
    v_mfma_f32_32x32x16_bf16 v[32:47], v[148:151], v[116:119], v[32:47]
    s_mov_b64 exec, s[28:29]
    ds_read_b128 v[148:151], v235 offset:46656
    s_mov_b64 exec, -1
    v_exp_f32 v98, v98
    v_exp_f32 v99, v99
    v_exp_f32 v100, v100
    v_mfma_f32_32x32x4_2b_bf16 v[48:79], v[136:137], v[8:9], v[48:79]
    v_exp_f32 v101, v101
    v_exp_f32 v102, v102
    v_exp_f32 v103, v103
    v_cvt_pk_bf16_f32 v120, v96, v97
    v_cvt_pk_bf16_f32 v121, v98, v99
    v_cvt_pk_bf16_f32 v122, v100, v101
    v_cvt_pk_bf16_f32 v123, v102, v103
    v_exp_f32 v104, v104
    v_exp_f32 v105, v105
    v_exp_f32 v106, v106
    s_waitcnt lgkmcnt(4)
    v_mfma_f32_32x32x16_bf16 v[32:47], v[152:155], v[120:123], v[32:47]
    s_mov_b64 exec, s[28:29]
    ds_read_b128 v[152:155], v235 offset:47232
    s_mov_b64 exec, -1
    v_exp_f32 v107, v107
    v_exp_f32 v108, v108
    v_exp_f32 v109, v109
    v_exp_f32 v110, v110
    v_exp_f32 v111, v111
    buffer_load_dwordx4 v[168:171], v12, s[20:23], s42 offen nt
    v_cvt_pk_bf16_f32 v124, v104, v105
    v_cvt_pk_bf16_f32 v125, v106, v107
    v_cvt_pk_bf16_f32 v126, v108, v109
    v_cvt_pk_bf16_f32 v127, v110, v111
    s_setprio 2
    v_exp_f32 v48, v48
    v_exp_f32 v49, v49
    v_exp_f32 v50, v50
    s_waitcnt lgkmcnt(4)
    v_mfma_f32_32x32x16_bf16 v[32:47], v[156:159], v[124:127], v[32:47]
    s_mov_b64 exec, s[28:29]
    ds_read_b128 v[156:159], v235 offset:47808
    s_mov_b64 exec, -1
    v_exp_f32 v51, v51
    v_exp_f32 v52, v52
    v_exp_f32 v53, v53
    v_exp_f32 v54, v54
    v_exp_f32 v55, v55
    v_mfma_f32_32x32x16_bf16 v[80:95], v[128:131], v[4:7], v[16:31]
    ds_read_b128 v[128:131], v232 offset:40960
    v_cvt_pk_bf16_f32 v112, v48, v49
    v_cvt_pk_bf16_f32 v113, v50, v51
    v_cvt_pk_bf16_f32 v114, v52, v53
    v_cvt_pk_bf16_f32 v115, v54, v55
    v_exp_f32 v56, v56
    v_exp_f32 v57, v57
    v_exp_f32 v58, v58
    s_waitcnt lgkmcnt(4)
    v_mfma_f32_32x32x16_bf16 v[32:47], v[144:147], v[112:115], v[32:47]
    s_mov_b64 exec, s[28:29]
    ds_read_b128 v[144:147], v235 offset:48384
    s_mov_b64 exec, -1
    v_exp_f32 v59, v59
    v_exp_f32 v60, v60
    v_exp_f32 v61, v61
    v_exp_f32 v62, v62
    v_exp_f32 v63, v63
    v_mfma_f32_32x32x16_bf16 v[96:111], v[132:135], v[4:7], v[16:31]
    ds_read_b128 v[132:135], v232 offset:41984
    v_mov_b32 v200, -1
    v_mov_b32 v201, -1
    v_mov_b32 v202, -1
    v_mov_b32 v203, -1
    s_lshl_b32 s39, s59, 12
    s_add_u32 s39, s39, 50331648
    buffer_store_dwordx4 v[200:203], v3, s[16:19], s39 offen sc1
    s_add_u32 s39, s39, 1024
    v_cvt_pk_bf16_f32 v116, v56, v57
    v_cvt_pk_bf16_f32 v117, v58, v59
    v_cvt_pk_bf16_f32 v118, v60, v61
    v_cvt_pk_bf16_f32 v119, v62, v63
    v_exp_f32 v64, v64
    v_exp_f32 v65, v65
    s_waitcnt lgkmcnt(4)
    v_mfma_f32_32x32x16_bf16 v[32:47], v[148:151], v[116:119], v[32:47]
    s_mov_b64 exec, s[28:29]
    ds_read_b128 v[148:151], v235 offset:48960
    s_mov_b64 exec, -1
    v_exp_f32 v66, v66
    v_exp_f32 v67, v67
    v_exp_f32 v68, v68
    v_mfma_f32_32x32x4_2b_bf16 v[80:111], v[136:137], v[10:11], v[80:111]
    v_exp_f32 v69, v69
    v_exp_f32 v70, v70
    v_exp_f32 v71, v71
    v_cvt_pk_bf16_f32 v120, v64, v65
    v_cvt_pk_bf16_f32 v121, v66, v67
    v_cvt_pk_bf16_f32 v122, v68, v69
    v_cvt_pk_bf16_f32 v123, v70, v71
    v_exp_f32 v72, v72
    v_exp_f32 v73, v73
    v_exp_f32 v74, v74
    s_waitcnt lgkmcnt(4)
    v_mfma_f32_32x32x16_bf16 v[32:47], v[152:155], v[120:123], v[32:47]
    s_mov_b64 exec, s[28:29]
    ds_read_b128 v[152:155], v235 offset:49536
    s_mov_b64 exec, -1
    v_exp_f32 v75, v75
    v_exp_f32 v76, v76
    v_exp_f32 v77, v77
    v_exp_f32 v78, v78
    v_exp_f32 v79, v79
    v_cvt_pk_bf16_f32 v124, v72, v73
    v_cvt_pk_bf16_f32 v125, v74, v75
    v_cvt_pk_bf16_f32 v126, v76, v77
    v_cvt_pk_bf16_f32 v127, v78, v79
    v_exp_f32 v80, v80
    v_exp_f32 v81, v81
    v_exp_f32 v82, v82
    s_waitcnt lgkmcnt(4)
    v_mfma_f32_32x32x16_bf16 v[32:47], v[156:159], v[124:127], v[32:47]
    s_mov_b64 exec, s[28:29]
    ds_read_b128 v[156:159], v235 offset:50112
    s_mov_b64 exec, -1
    v_exp_f32 v83, v83
    v_exp_f32 v84, v84
    v_exp_f32 v85, v85
    v_exp_f32 v86, v86
    v_exp_f32 v87, v87
    v_mfma_f32_32x32x16_bf16 v[48:63], v[128:131], v[4:7], v[16:31]
    ds_read_b128 v[128:131], v232 offset:43008
    v_cvt_pk_bf16_f32 v112, v80, v81
    v_cvt_pk_bf16_f32 v113, v82, v83
    v_cvt_pk_bf16_f32 v114, v84, v85
    v_cvt_pk_bf16_f32 v115, v86, v87
    v_exp_f32 v88, v88
    v_exp_f32 v89, v89
    v_exp_f32 v90, v90
    s_waitcnt lgkmcnt(4)
    v_mfma_f32_32x32x16_bf16 v[32:47], v[144:147], v[112:115], v[32:47]
    s_mov_b64 exec, s[28:29]
    ds_read_b128 v[144:147], v235 offset:50688
    s_mov_b64 exec, -1
    v_exp_f32 v91, v91
    v_exp_f32 v92, v92
    v_exp_f32 v93, v93
    v_exp_f32 v94, v94
    v_exp_f32 v95, v95
    v_mfma_f32_32x32x16_bf16 v[64:79], v[132:135], v[4:7], v[16:31]
    ds_read_b128 v[132:135], v232 offset:44032
    buffer_store_dwordx4 v[200:203], v3, s[16:19], s39 offen sc1
    s_add_u32 s39, s39, 1024
    v_cvt_pk_bf16_f32 v116, v88, v89
    v_cvt_pk_bf16_f32 v117, v90, v91
    v_cvt_pk_bf16_f32 v118, v92, v93
    v_cvt_pk_bf16_f32 v119, v94, v95
    v_exp_f32 v96, v96
    v_exp_f32 v97, v97
    s_waitcnt lgkmcnt(4)
    v_mfma_f32_32x32x16_bf16 v[32:47], v[148:151], v[116:119], v[32:47]
    s_mov_b64 exec, s[28:29]
    ds_read_b128 v[148:151], v235 offset:51264
    s_mov_b64 exec, -1
    v_exp_f32 v98, v98
    v_exp_f32 v99, v99
    v_exp_f32 v100, v100
    v_mfma_f32_32x32x4_2b_bf16 v[48:79], v[138:139], v[8:9], v[48:79]
    v_exp_f32 v101, v101
    v_exp_f32 v102, v102
    v_exp_f32 v103, v103
    v_cvt_pk_bf16_f32 v120, v96, v97
    v_cvt_pk_bf16_f32 v121, v98, v99
    v_cvt_pk_bf16_f32 v122, v100, v101
    v_cvt_pk_bf16_f32 v123, v102, v103
    v_exp_f32 v104, v104
    v_exp_f32 v105, v105
    v_exp_f32 v106, v106
    s_waitcnt lgkmcnt(4)
    v_mfma_f32_32x32x16_bf16 v[32:47], v[152:155], v[120:123], v[32:47]
    s_mov_b64 exec, s[28:29]
    ds_read_b128 v[152:155], v235 offset:51840
    s_mov_b64 exec, -1
    v_exp_f32 v107, v107
    v_exp_f32 v108, v108
    v_exp_f32 v109, v109
    v_exp_f32 v110, v110
    v_exp_f32 v111, v111
    buffer_load_dwordx4 v[172:175], v12, s[20:23], s43 offen nt
    v_cvt_pk_bf16_f32 v124, v104, v105
    v_cvt_pk_bf16_f32 v125, v106, v107
    v_cvt_pk_bf16_f32 v126, v108, v109
    v_cvt_pk_bf16_f32 v127, v110, v111
    s_setprio 1
    v_exp_f32 v48, v48
    v_exp_f32 v49, v49
    v_exp_f32 v50, v50
    s_waitcnt lgkmcnt(4)
    v_mfma_f32_32x32x16_bf16 v[32:47], v[156:159], v[124:127], v[32:47]
    s_mov_b64 exec, s[28:29]
    ds_read_b128 v[156:159], v235 offset:52416
    s_mov_b64 exec, -1
    v_exp_f32 v51, v51
    v_exp_f32 v52, v52
    v_exp_f32 v53, v53
    v_exp_f32 v54, v54
    v_exp_f32 v55, v55
    v_mfma_f32_32x32x16_bf16 v[80:95], v[128:131], v[4:7], v[16:31]
    ds_read_b128 v[128:131], v232 offset:55296
    v_cvt_pk_bf16_f32 v112, v48, v49
    v_cvt_pk_bf16_f32 v113, v50, v51
    v_cvt_pk_bf16_f32 v114, v52, v53
    v_cvt_pk_bf16_f32 v115, v54, v55
    v_exp_f32 v56, v56
    v_exp_f32 v57, v57
    v_exp_f32 v58, v58
    s_waitcnt lgkmcnt(4)
    v_mfma_f32_32x32x16_bf16 v[32:47], v[144:147], v[112:115], v[32:47]
    s_mov_b64 exec, s[28:29]
    ds_read_b128 v[144:147], v235 offset:52992
    s_mov_b64 exec, -1
    v_exp_f32 v59, v59
    v_exp_f32 v60, v60
    v_exp_f32 v61, v61
    v_exp_f32 v62, v62
    v_exp_f32 v63, v63
    v_mfma_f32_32x32x16_bf16 v[96:111], v[132:135], v[4:7], v[16:31]
    ds_read_b128 v[132:135], v232 offset:56320
    buffer_store_dwordx4 v[200:203], v3, s[16:19], s39 offen sc1
    s_add_u32 s39, s39, 1024
    v_cvt_pk_bf16_f32 v116, v56, v57
    v_cvt_pk_bf16_f32 v117, v58, v59
    v_cvt_pk_bf16_f32 v118, v60, v61
    v_cvt_pk_bf16_f32 v119, v62, v63
    v_exp_f32 v64, v64
    v_exp_f32 v65, v65
    s_waitcnt lgkmcnt(4)
    v_mfma_f32_32x32x16_bf16 v[32:47], v[148:151], v[116:119], v[32:47]
    s_mov_b64 exec, s[28:29]
    ds_read_b128 v[148:151], v235 offset:53568
    s_mov_b64 exec, -1
    v_exp_f32 v66, v66
    v_exp_f32 v67, v67
    v_exp_f32 v68, v68
    v_mfma_f32_32x32x4_2b_bf16 v[80:111], v[138:139], v[10:11], v[80:111]
    v_exp_f32 v69, v69
    v_exp_f32 v70, v70
    v_exp_f32 v71, v71
    v_cvt_pk_bf16_f32 v120, v64, v65
    v_cvt_pk_bf16_f32 v121, v66, v67
    v_cvt_pk_bf16_f32 v122, v68, v69
    v_cvt_pk_bf16_f32 v123, v70, v71
    v_exp_f32 v72, v72
    v_exp_f32 v73, v73
    v_exp_f32 v74, v74
    s_waitcnt lgkmcnt(4)
    v_mfma_f32_32x32x16_bf16 v[32:47], v[152:155], v[120:123], v[32:47]
    s_mov_b64 exec, s[28:29]
    ds_read_b128 v[152:155], v235 offset:54144
    s_mov_b64 exec, -1
    v_exp_f32 v75, v75
    v_exp_f32 v76, v76
    v_exp_f32 v77, v77
    v_exp_f32 v78, v78
    v_exp_f32 v79, v79
    ds_read2st64_b32 v[136:137], v239 offset0:0 offset1:1
    ds_read2st64_b32 v[138:139], v239 offset0:2 offset1:3
    v_add_u32 v239, 18432, v239
    v_cvt_pk_bf16_f32 v124, v72, v73
    v_cvt_pk_bf16_f32 v125, v74, v75
    v_cvt_pk_bf16_f32 v126, v76, v77
    v_cvt_pk_bf16_f32 v127, v78, v79
    s_setprio 0
    v_exp_f32 v80, v80
    v_exp_f32 v81, v81
    v_exp_f32 v82, v82
    s_waitcnt lgkmcnt(4)
    v_mfma_f32_32x32x16_bf16 v[32:47], v[156:159], v[124:127], v[32:47]
    s_mov_b64 exec, s[28:29]
    ds_read_b128 v[156:159], v235 offset:54720
    s_mov_b64 exec, -1
    v_exp_f32 v83, v83
    v_exp_f32 v84, v84
    v_exp_f32 v85, v85
    v_exp_f32 v86, v86
    v_exp_f32 v87, v87
    v_mfma_f32_32x32x16_bf16 v[48:63], v[128:131], v[4:7], v[16:31]
    ds_read_b128 v[128:131], v232 offset:57344
    v_cvt_pk_bf16_f32 v112, v80, v81
    v_cvt_pk_bf16_f32 v113, v82, v83
    v_cvt_pk_bf16_f32 v114, v84, v85
    v_cvt_pk_bf16_f32 v115, v86, v87
    v_exp_f32 v88, v88
    v_exp_f32 v89, v89
    v_exp_f32 v90, v90
    s_waitcnt lgkmcnt(4)
    v_mfma_f32_32x32x16_bf16 v[32:47], v[144:147], v[112:115], v[32:47]
    s_mov_b64 exec, s[28:29]
    ds_read_b128 v[144:147], v235 offset:64512
    s_mov_b64 exec, -1
    v_exp_f32 v91, v91
    v_exp_f32 v92, v92
    v_exp_f32 v93, v93
    v_exp_f32 v94, v94
    v_exp_f32 v95, v95
    v_mfma_f32_32x32x16_bf16 v[64:79], v[132:135], v[4:7], v[16:31]
    ds_read_b128 v[132:135], v232 offset:58368
    buffer_store_dwordx4 v[200:203], v3, s[16:19], s39 offen sc1
    s_add_u32 s39, s39, 1024
    v_cvt_pk_bf16_f32 v116, v88, v89
    v_cvt_pk_bf16_f32 v117, v90, v91
    v_cvt_pk_bf16_f32 v118, v92, v93
    v_cvt_pk_bf16_f32 v119, v94, v95
    v_exp_f32 v96, v96
    v_exp_f32 v97, v97
    s_waitcnt lgkmcnt(4)
    v_mfma_f32_32x32x16_bf16 v[32:47], v[148:151], v[116:119], v[32:47]
    s_mov_b64 exec, s[28:29]
    ds_read_b128 v[148:151], v235 offset:65088
    s_mov_b64 exec, -1
    v_exp_f32 v98, v98
    v_exp_f32 v99, v99
    v_exp_f32 v100, v100
    v_mfma_f32_32x32x4_2b_bf16 v[48:79], v[136:137], v[8:9], v[48:79]
    v_exp_f32 v101, v101
    v_exp_f32 v102, v102
    v_exp_f32 v103, v103
    v_cvt_pk_bf16_f32 v120, v96, v97
    v_cvt_pk_bf16_f32 v121, v98, v99
    v_cvt_pk_bf16_f32 v122, v100, v101
    v_cvt_pk_bf16_f32 v123, v102, v103
    v_exp_f32 v104, v104
    v_exp_f32 v105, v105
    v_exp_f32 v106, v106
    s_waitcnt lgkmcnt(4)
    v_mfma_f32_32x32x16_bf16 v[32:47], v[152:155], v[120:123], v[32:47]
    s_mov_b64 exec, s[28:29]
    ds_read_b128 v[152:155], v236 offset:128
    s_mov_b64 exec, -1
    v_exp_f32 v107, v107
    v_exp_f32 v108, v108
    v_exp_f32 v109, v109
    v_exp_f32 v110, v110
    v_exp_f32 v111, v111
    buffer_load_dwordx4 v[176:179], v12, s[20:23], s44 offen nt
    v_cvt_pk_bf16_f32 v124, v104, v105
    v_cvt_pk_bf16_f32 v125, v106, v107
    v_cvt_pk_bf16_f32 v126, v108, v109
    v_cvt_pk_bf16_f32 v127, v110, v111
    s_waitcnt vmcnt(8)
    s_barrier
    s_setprio 3
    v_exp_f32 v48, v48
    v_exp_f32 v49, v49
    v_exp_f32 v50, v50
    s_waitcnt lgkmcnt(4)
    v_mfma_f32_32x32x16_bf16 v[32:47], v[156:159], v[124:127], v[32:47]
    s_mov_b64 exec, s[28:29]
    ds_read_b128 v[156:159], v236 offset:704
    s_mov_b64 exec, -1
    v_exp_f32 v51, v51
    v_exp_f32 v52, v52
    v_exp_f32 v53, v53
    v_exp_f32 v54, v54
    v_exp_f32 v55, v55
    v_mfma_f32_32x32x16_bf16 v[80:95], v[128:131], v[4:7], v[16:31]
    ds_read_b128 v[128:131], v232 offset:59392
    v_cvt_pk_bf16_f32 v112, v48, v49
    v_cvt_pk_bf16_f32 v113, v50, v51
    v_cvt_pk_bf16_f32 v114, v52, v53
    v_cvt_pk_bf16_f32 v115, v54, v55
    v_exp_f32 v56, v56
    v_exp_f32 v57, v57
    v_exp_f32 v58, v58
    s_waitcnt lgkmcnt(4)
    v_mfma_f32_32x32x16_bf16 v[32:47], v[144:147], v[112:115], v[32:47]
    s_mov_b64 exec, s[28:29]
    ds_read_b128 v[144:147], v236 offset:1280
    s_mov_b64 exec, -1
    v_exp_f32 v59, v59
    v_exp_f32 v60, v60
    v_exp_f32 v61, v61
    v_exp_f32 v62, v62
    v_exp_f32 v63, v63
    v_mfma_f32_32x32x16_bf16 v[96:111], v[132:135], v[4:7], v[16:31]
    ds_read_b128 v[132:135], v232 offset:60416
    v_cvt_pk_bf16_f32 v116, v56, v57
    v_cvt_pk_bf16_f32 v117, v58, v59
    v_cvt_pk_bf16_f32 v118, v60, v61
    v_cvt_pk_bf16_f32 v119, v62, v63
    v_exp_f32 v64, v64
    v_exp_f32 v65, v65
    s_waitcnt lgkmcnt(4)
    v_mfma_f32_32x32x16_bf16 v[32:47], v[148:151], v[116:119], v[32:47]
    s_mov_b64 exec, s[28:29]
    ds_read_b128 v[148:151], v236 offset:1856
    s_mov_b64 exec, -1
    v_exp_f32 v66, v66
    v_exp_f32 v67, v67
    v_exp_f32 v68, v68
    v_mfma_f32_32x32x4_2b_bf16 v[80:111], v[136:137], v[10:11], v[80:111]
    v_exp_f32 v69, v69
    v_exp_f32 v70, v70
    v_exp_f32 v71, v71
    v_cvt_pk_bf16_f32 v120, v64, v65
    v_cvt_pk_bf16_f32 v121, v66, v67
    v_cvt_pk_bf16_f32 v122, v68, v69
    v_cvt_pk_bf16_f32 v123, v70, v71
    v_exp_f32 v72, v72
    v_exp_f32 v73, v73
    v_exp_f32 v74, v74
    s_waitcnt lgkmcnt(4)
    v_mfma_f32_32x32x16_bf16 v[32:47], v[152:155], v[120:123], v[32:47]
    s_mov_b64 exec, s[28:29]
    ds_read_b128 v[152:155], v236 offset:2432
    s_mov_b64 exec, -1
    v_exp_f32 v75, v75
    v_exp_f32 v76, v76
    v_exp_f32 v77, v77
    v_exp_f32 v78, v78
    v_exp_f32 v79, v79
    v_cvt_pk_bf16_f32 v124, v72, v73
    v_cvt_pk_bf16_f32 v125, v74, v75
    v_cvt_pk_bf16_f32 v126, v76, v77
    v_cvt_pk_bf16_f32 v127, v78, v79
    v_exp_f32 v80, v80
    v_exp_f32 v81, v81
    v_exp_f32 v82, v82
    s_waitcnt lgkmcnt(4)
    v_mfma_f32_32x32x16_bf16 v[32:47], v[156:159], v[124:127], v[32:47]
    s_mov_b64 exec, s[28:29]
    ds_read_b128 v[156:159], v236 offset:3008
    s_mov_b64 exec, -1
    v_exp_f32 v83, v83
    v_exp_f32 v84, v84
    v_exp_f32 v85, v85
    v_exp_f32 v86, v86
    v_exp_f32 v87, v87
    v_mfma_f32_32x32x16_bf16 v[48:63], v[128:131], v[4:7], v[16:31]
    ds_read_b128 v[128:131], v232 offset:61440
    v_cvt_pk_bf16_f32 v112, v80, v81
    v_cvt_pk_bf16_f32 v113, v82, v83
    v_cvt_pk_bf16_f32 v114, v84, v85
    v_cvt_pk_bf16_f32 v115, v86, v87
    v_exp_f32 v88, v88
    v_exp_f32 v89, v89
    v_exp_f32 v90, v90
    s_waitcnt lgkmcnt(4)
    v_mfma_f32_32x32x16_bf16 v[32:47], v[144:147], v[112:115], v[32:47]
    s_mov_b64 exec, s[28:29]
    ds_read_b128 v[144:147], v236 offset:3584
    s_mov_b64 exec, -1
    v_exp_f32 v91, v91
    v_exp_f32 v92, v92
    v_exp_f32 v93, v93
    v_exp_f32 v94, v94
    v_exp_f32 v95, v95
    v_mfma_f32_32x32x16_bf16 v[64:79], v[132:135], v[4:7], v[16:31]
    ds_read_b128 v[132:135], v232 offset:62464
    s_cmp_lt_u32 s61, 576
    s_cbranch_scc0 fused_kernel_mi13
    s_mov_b32 s33, 0
    buffer_load_ushort v224, v13, s[48:51], s33 offen
    s_mov_b32 s33, 9216
    buffer_load_ushort v225, v13, s[48:51], s33 offen
fused_kernel_mi13:
    v_cvt_pk_bf16_f32 v116, v88, v89
    v_cvt_pk_bf16_f32 v117, v90, v91
    v_cvt_pk_bf16_f32 v118, v92, v93
    v_cvt_pk_bf16_f32 v119, v94, v95
    v_exp_f32 v96, v96
    v_exp_f32 v97, v97
    s_waitcnt lgkmcnt(4)
    v_mfma_f32_32x32x16_bf16 v[32:47], v[148:151], v[116:119], v[32:47]
    s_mov_b64 exec, s[28:29]
    ds_read_b128 v[148:151], v236 offset:4160
    s_mov_b64 exec, -1
    v_exp_f32 v98, v98
    v_exp_f32 v99, v99
    v_exp_f32 v100, v100
    v_mfma_f32_32x32x4_2b_bf16 v[48:79], v[138:139], v[8:9], v[48:79]
    v_exp_f32 v101, v101
    v_exp_f32 v102, v102
    v_exp_f32 v103, v103
    v_cvt_pk_bf16_f32 v120, v96, v97
    v_cvt_pk_bf16_f32 v121, v98, v99
    v_cvt_pk_bf16_f32 v122, v100, v101
    v_cvt_pk_bf16_f32 v123, v102, v103
    v_exp_f32 v104, v104
    v_exp_f32 v105, v105
    v_exp_f32 v106, v106
    s_waitcnt lgkmcnt(4)
    v_mfma_f32_32x32x16_bf16 v[32:47], v[152:155], v[120:123], v[32:47]
    s_mov_b64 exec, s[28:29]
    ds_read_b128 v[152:155], v236 offset:4736
    s_mov_b64 exec, -1
    v_exp_f32 v107, v107
    v_exp_f32 v108, v108
    v_exp_f32 v109, v109
    v_exp_f32 v110, v110
    v_exp_f32 v111, v111
    buffer_load_dwordx4 v[180:183], v12, s[20:23], s45 offen nt
    v_cvt_pk_bf16_f32 v124, v104, v105
    v_cvt_pk_bf16_f32 v125, v106, v107
    v_cvt_pk_bf16_f32 v126, v108, v109
    v_cvt_pk_bf16_f32 v127, v110, v111
    v_exp_f32 v48, v48
    v_exp_f32 v49, v49
    v_exp_f32 v50, v50
    s_waitcnt lgkmcnt(4)
    v_mfma_f32_32x32x16_bf16 v[32:47], v[156:159], v[124:127], v[32:47]
    s_mov_b64 exec, s[28:29]
    ds_read_b128 v[156:159], v236 offset:5312
    s_mov_b64 exec, -1
    v_exp_f32 v51, v51
    v_exp_f32 v52, v52
    v_exp_f32 v53, v53
    v_exp_f32 v54, v54
    v_exp_f32 v55, v55
    v_mfma_f32_32x32x16_bf16 v[80:95], v[128:131], v[4:7], v[16:31]
    ds_read_b128 v[128:131], v233 offset:8192
    v_cvt_pk_bf16_f32 v112, v48, v49
    v_cvt_pk_bf16_f32 v113, v50, v51
    v_cvt_pk_bf16_f32 v114, v52, v53
    v_cvt_pk_bf16_f32 v115, v54, v55
    v_exp_f32 v56, v56
    v_exp_f32 v57, v57
    v_exp_f32 v58, v58
    s_waitcnt lgkmcnt(4)
    v_mfma_f32_32x32x16_bf16 v[32:47], v[144:147], v[112:115], v[32:47]
    s_mov_b64 exec, s[28:29]
    ds_read_b128 v[144:147], v236 offset:5888
    s_mov_b64 exec, -1
    v_exp_f32 v59, v59
    v_exp_f32 v60, v60
    v_exp_f32 v61, v61
    v_exp_f32 v62, v62
    v_exp_f32 v63, v63
    v_mfma_f32_32x32x16_bf16 v[96:111], v[132:135], v[4:7], v[16:31]
    ds_read_b128 v[132:135], v233 offset:9216
    s_cmp_lt_u32 s61, 576
    s_cbranch_scc0 fused_kernel_mi14
    s_mov_b32 s33, 18432
    buffer_load_ushort v226, v13, s[48:51], s33 offen
    s_mov_b32 s33, 27648
    buffer_load_ushort v227, v13, s[48:51], s33 offen
fused_kernel_mi14:
    v_cvt_pk_bf16_f32 v116, v56, v57
    v_cvt_pk_bf16_f32 v117, v58, v59
    v_cvt_pk_bf16_f32 v118, v60, v61
    v_cvt_pk_bf16_f32 v119, v62, v63
    v_exp_f32 v64, v64
    v_exp_f32 v65, v65
    s_waitcnt lgkmcnt(4)
    v_mfma_f32_32x32x16_bf16 v[32:47], v[148:151], v[116:119], v[32:47]
    s_mov_b64 exec, s[28:29]
    ds_read_b128 v[148:151], v236 offset:6464
    s_mov_b64 exec, -1
    v_exp_f32 v66, v66
    v_exp_f32 v67, v67
    v_exp_f32 v68, v68
    v_mfma_f32_32x32x4_2b_bf16 v[80:111], v[138:139], v[10:11], v[80:111]
    v_exp_f32 v69, v69
    v_exp_f32 v70, v70
    v_exp_f32 v71, v71
    v_cvt_pk_bf16_f32 v120, v64, v65
    v_cvt_pk_bf16_f32 v121, v66, v67
    v_cvt_pk_bf16_f32 v122, v68, v69
    v_cvt_pk_bf16_f32 v123, v70, v71
    v_exp_f32 v72, v72
    v_exp_f32 v73, v73
    v_exp_f32 v74, v74
    s_waitcnt lgkmcnt(4)
    v_mfma_f32_32x32x16_bf16 v[32:47], v[152:155], v[120:123], v[32:47]
    s_mov_b64 exec, s[28:29]
    ds_read_b128 v[152:155], v236 offset:7040
    s_mov_b64 exec, -1
    v_exp_f32 v75, v75
    v_exp_f32 v76, v76
    v_exp_f32 v77, v77
    v_exp_f32 v78, v78
    v_exp_f32 v79, v79
    ds_read2st64_b32 v[136:137], v239 offset0:0 offset1:1
    ds_read2st64_b32 v[138:139], v239 offset0:2 offset1:3
    v_add_u32 v239, 18432, v239
    v_cvt_pk_bf16_f32 v124, v72, v73
    v_cvt_pk_bf16_f32 v125, v74, v75
    v_cvt_pk_bf16_f32 v126, v76, v77
    v_cvt_pk_bf16_f32 v127, v78, v79
    v_exp_f32 v80, v80
    v_exp_f32 v81, v81
    v_exp_f32 v82, v82
    s_waitcnt lgkmcnt(4)
    v_mfma_f32_32x32x16_bf16 v[32:47], v[156:159], v[124:127], v[32:47]
    s_mov_b64 exec, s[28:29]
    ds_read_b128 v[156:159], v236 offset:7616
    s_mov_b64 exec, -1
    v_exp_f32 v83, v83
    v_exp_f32 v84, v84
    v_exp_f32 v85, v85
    v_exp_f32 v86, v86
    v_exp_f32 v87, v87
    v_mfma_f32_32x32x16_bf16 v[48:63], v[128:131], v[4:7], v[16:31]
    ds_read_b128 v[128:131], v233 offset:10240
    v_cvt_pk_bf16_f32 v112, v80, v81
    v_cvt_pk_bf16_f32 v113, v82, v83
    v_cvt_pk_bf16_f32 v114, v84, v85
    v_cvt_pk_bf16_f32 v115, v86, v87
    v_exp_f32 v88, v88
    v_exp_f32 v89, v89
    v_exp_f32 v90, v90
    s_waitcnt lgkmcnt(4)
    v_mfma_f32_32x32x16_bf16 v[32:47], v[144:147], v[112:115], v[32:47]
    s_mov_b64 exec, s[28:29]
    ds_read_b128 v[144:147], v236 offset:17408
    s_mov_b64 exec, -1
    v_exp_f32 v91, v91
    v_exp_f32 v92, v92
    v_exp_f32 v93, v93
    v_exp_f32 v94, v94
    v_exp_f32 v95, v95
    v_mfma_f32_32x32x16_bf16 v[64:79], v[132:135], v[4:7], v[16:31]
    ds_read_b128 v[132:135], v233 offset:11264
    s_cmp_lt_u32 s61, 576
    s_cbranch_scc0 fused_kernel_mi15
    s_add_u32 s33, s5, 0
    buffer_load_ushort v228, v13, s[48:51], s33 offen
    s_add_u32 s33, s5, 9216
    buffer_load_ushort v229, v13, s[48:51], s33 offen
fused_kernel_mi15:
    v_cvt_pk_bf16_f32 v116, v88, v89
    v_cvt_pk_bf16_f32 v117, v90, v91
    v_cvt_pk_bf16_f32 v118, v92, v93
    v_cvt_pk_bf16_f32 v119, v94, v95
    v_exp_f32 v96, v96
    v_exp_f32 v97, v97
    s_waitcnt lgkmcnt(4)
    v_mfma_f32_32x32x16_bf16 v[32:47], v[148:151], v[116:119], v[32:47]
    s_mov_b64 exec, s[28:29]
    ds_read_b128 v[148:151], v236 offset:17984
    s_mov_b64 exec, -1
    v_exp_f32 v98, v98
    v_exp_f32 v99, v99
    v_exp_f32 v100, v100
    v_mfma_f32_32x32x4_2b_bf16 v[48:79], v[136:137], v[8:9], v[48:79]
    v_exp_f32 v101, v101
    v_exp_f32 v102, v102
    v_exp_f32 v103, v103
    v_cvt_pk_bf16_f32 v120, v96, v97
    v_cvt_pk_bf16_f32 v121, v98, v99
    v_cvt_pk_bf16_f32 v122, v100, v101
    v_cvt_pk_bf16_f32 v123, v102, v103
    v_exp_f32 v104, v104
    v_exp_f32 v105, v105
    v_exp_f32 v106, v106
    s_waitcnt lgkmcnt(4)
    v_mfma_f32_32x32x16_bf16 v[32:47], v[152:155], v[120:123], v[32:47]
    s_mov_b64 exec, s[28:29]
    ds_read_b128 v[152:155], v236 offset:18560
    s_mov_b64 exec, -1
    v_exp_f32 v107, v107
    v_exp_f32 v108, v108
    v_exp_f32 v109, v109
    v_exp_f32 v110, v110
    v_exp_f32 v111, v111
    buffer_load_dwordx4 v[184:187], v12, s[20:23], s46 offen nt
    v_cvt_pk_bf16_f32 v124, v104, v105
    v_cvt_pk_bf16_f32 v125, v106, v107
    v_cvt_pk_bf16_f32 v126, v108, v109
    v_cvt_pk_bf16_f32 v127, v110, v111
    s_lshl_b32 s39, s2, 7
    s_add_u32 s39, s39, 68321280
    v_mov_b32 v241, 0
    buffer_load_dword v242, v241, s[16:19], s39 offen sc1
    v_exp_f32 v48, v48
    v_exp_f32 v49, v49
    v_exp_f32 v50, v50
    s_waitcnt lgkmcnt(4)
    v_mfma_f32_32x32x16_bf16 v[32:47], v[156:159], v[124:127], v[32:47]
    s_mov_b64 exec, s[28:29]
    ds_read_b128 v[156:159], v236 offset:19136
    s_mov_b64 exec, -1
    v_exp_f32 v51, v51
    v_exp_f32 v52, v52
    v_exp_f32 v53, v53
    v_exp_f32 v54, v54
    v_exp_f32 v55, v55
    v_mfma_f32_32x32x16_bf16 v[80:95], v[128:131], v[4:7], v[16:31]
    ds_read_b128 v[128:131], v233 offset:12288
    v_cvt_pk_bf16_f32 v112, v48, v49
    v_cvt_pk_bf16_f32 v113, v50, v51
    v_cvt_pk_bf16_f32 v114, v52, v53
    v_cvt_pk_bf16_f32 v115, v54, v55
    v_exp_f32 v56, v56
    v_exp_f32 v57, v57
    v_exp_f32 v58, v58
    s_waitcnt lgkmcnt(4)
    v_mfma_f32_32x32x16_bf16 v[32:47], v[144:147], v[112:115], v[32:47]
    s_mov_b64 exec, s[28:29]
    ds_read_b128 v[144:147], v236 offset:19712
    s_mov_b64 exec, -1
    v_exp_f32 v59, v59
    v_exp_f32 v60, v60
    v_exp_f32 v61, v61
    v_exp_f32 v62, v62
    v_exp_f32 v63, v63
    v_mfma_f32_32x32x16_bf16 v[96:111], v[132:135], v[4:7], v[16:31]
    ds_read_b128 v[132:135], v233 offset:13312
    s_cmp_lt_u32 s61, 576
    s_cbranch_scc0 fused_kernel_mi16
    s_add_u32 s33, s5, 18432
    buffer_load_ushort v230, v13, s[48:51], s33 offen
    s_add_u32 s33, s5, 27648
    buffer_load_ushort v231, v13, s[48:51], s33 offen
fused_kernel_mi16:
    v_cvt_pk_bf16_f32 v116, v56, v57
    v_cvt_pk_bf16_f32 v117, v58, v59
    v_cvt_pk_bf16_f32 v118, v60, v61
    v_cvt_pk_bf16_f32 v119, v62, v63
    v_exp_f32 v64, v64
    v_exp_f32 v65, v65
    s_waitcnt lgkmcnt(4)
    v_mfma_f32_32x32x16_bf16 v[32:47], v[148:151], v[116:119], v[32:47]
    s_mov_b64 exec, s[28:29]
    ds_read_b128 v[148:151], v236 offset:20288
    s_mov_b64 exec, -1
    v_exp_f32 v66, v66
    v_exp_f32 v67, v67
    v_exp_f32 v68, v68
    v_mfma_f32_32x32x4_2b_bf16 v[80:111], v[136:137], v[10:11], v[80:111]
    v_exp_f32 v69, v69
    v_exp_f32 v70, v70
    v_exp_f32 v71, v71
    v_cvt_pk_bf16_f32 v120, v64, v65
    v_cvt_pk_bf16_f32 v121, v66, v67
    v_cvt_pk_bf16_f32 v122, v68, v69
    v_cvt_pk_bf16_f32 v123, v70, v71
    v_exp_f32 v72, v72
    v_exp_f32 v73, v73
    v_exp_f32 v74, v74
    s_waitcnt lgkmcnt(4)
    v_mfma_f32_32x32x16_bf16 v[32:47], v[152:155], v[120:123], v[32:47]
    s_mov_b64 exec, s[28:29]
    ds_read_b128 v[152:155], v236 offset:20864
    s_mov_b64 exec, -1
    v_exp_f32 v75, v75
    v_exp_f32 v76, v76
    v_exp_f32 v77, v77
    v_exp_f32 v78, v78
    v_exp_f32 v79, v79
    v_cvt_pk_bf16_f32 v124, v72, v73
    v_cvt_pk_bf16_f32 v125, v74, v75
    v_cvt_pk_bf16_f32 v126, v76, v77
    v_cvt_pk_bf16_f32 v127, v78, v79
    v_exp_f32 v80, v80
    v_exp_f32 v81, v81
    v_exp_f32 v82, v82
    s_waitcnt lgkmcnt(4)
    v_mfma_f32_32x32x16_bf16 v[32:47], v[156:159], v[124:127], v[32:47]
    s_mov_b64 exec, s[28:29]
    ds_read_b128 v[156:159], v236 offset:21440
    s_mov_b64 exec, -1
    v_exp_f32 v83, v83
    v_exp_f32 v84, v84
    v_exp_f32 v85, v85
    v_exp_f32 v86, v86
    v_exp_f32 v87, v87
    v_mfma_f32_32x32x16_bf16 v[48:63], v[128:131], v[4:7], v[16:31]
    ds_read_b128 v[128:131], v233 offset:14336
    v_cvt_pk_bf16_f32 v112, v80, v81
    v_cvt_pk_bf16_f32 v113, v82, v83
    v_cvt_pk_bf16_f32 v114, v84, v85
    v_cvt_pk_bf16_f32 v115, v86, v87
    v_exp_f32 v88, v88
    v_exp_f32 v89, v89
    v_exp_f32 v90, v90
    s_waitcnt lgkmcnt(4)
    v_mfma_f32_32x32x16_bf16 v[32:47], v[144:147], v[112:115], v[32:47]
    s_mov_b64 exec, s[28:29]
    ds_read_b128 v[144:147], v236 offset:22016
    s_mov_b64 exec, -1
    v_exp_f32 v91, v91
    v_exp_f32 v92, v92
    v_exp_f32 v93, v93
    v_exp_f32 v94, v94
    v_exp_f32 v95, v95
    v_mfma_f32_32x32x16_bf16 v[64:79], v[132:135], v[4:7], v[16:31]
    ds_read_b128 v[132:135], v233 offset:15360
    v_cvt_pk_bf16_f32 v116, v88, v89
    v_cvt_pk_bf16_f32 v117, v90, v91
    v_cvt_pk_bf16_f32 v118, v92, v93
    v_cvt_pk_bf16_f32 v119, v94, v95
    v_exp_f32 v96, v96
    v_exp_f32 v97, v97
    s_waitcnt lgkmcnt(4)
    v_mfma_f32_32x32x16_bf16 v[32:47], v[148:151], v[116:119], v[32:47]
    s_mov_b64 exec, s[28:29]
    ds_read_b128 v[148:151], v236 offset:22592
    s_mov_b64 exec, -1
    v_exp_f32 v98, v98
    v_exp_f32 v99, v99
    v_exp_f32 v100, v100
    v_mfma_f32_32x32x4_2b_bf16 v[48:79], v[138:139], v[8:9], v[48:79]
    v_exp_f32 v101, v101
    v_exp_f32 v102, v102
    v_exp_f32 v103, v103
    v_cvt_pk_bf16_f32 v120, v96, v97
    v_cvt_pk_bf16_f32 v121, v98, v99
    v_cvt_pk_bf16_f32 v122, v100, v101
    v_cvt_pk_bf16_f32 v123, v102, v103
    v_exp_f32 v104, v104
    v_exp_f32 v105, v105
    v_exp_f32 v106, v106
    s_waitcnt lgkmcnt(4)
    v_mfma_f32_32x32x16_bf16 v[32:47], v[152:155], v[120:123], v[32:47]
    s_mov_b64 exec, s[28:29]
    ds_read_b128 v[152:155], v236 offset:23168
    s_mov_b64 exec, -1
    v_exp_f32 v107, v107
    v_exp_f32 v108, v108
    v_exp_f32 v109, v109
    v_exp_f32 v110, v110
    v_exp_f32 v111, v111
    buffer_load_dwordx4 v[188:191], v12, s[20:23], s47 offen nt
    v_cvt_pk_bf16_f32 v124, v104, v105
    v_cvt_pk_bf16_f32 v125, v106, v107
    v_cvt_pk_bf16_f32 v126, v108, v109
    v_cvt_pk_bf16_f32 v127, v110, v111
    v_exp_f32 v48, v48
    v_exp_f32 v49, v49
    v_exp_f32 v50, v50
    s_waitcnt lgkmcnt(4)
    v_mfma_f32_32x32x16_bf16 v[32:47], v[156:159], v[124:127], v[32:47]
    s_mov_b64 exec, s[28:29]
    ds_read_b128 v[156:159], v236 offset:23744
    s_mov_b64 exec, -1
    v_exp_f32 v51, v51
    v_exp_f32 v52, v52
    v_exp_f32 v53, v53
    v_exp_f32 v54, v54
    v_exp_f32 v55, v55
    v_mfma_f32_32x32x16_bf16 v[80:95], v[128:131], v[4:7], v[16:31]
    ds_read_b128 v[128:131], v233 offset:26624
    v_cvt_pk_bf16_f32 v112, v48, v49
    v_cvt_pk_bf16_f32 v113, v50, v51
    v_cvt_pk_bf16_f32 v114, v52, v53
    v_cvt_pk_bf16_f32 v115, v54, v55
    v_exp_f32 v56, v56
    v_exp_f32 v57, v57
    v_exp_f32 v58, v58
    s_waitcnt lgkmcnt(4)
    v_mfma_f32_32x32x16_bf16 v[32:47], v[144:147], v[112:115], v[32:47]
    s_mov_b64 exec, s[28:29]
    ds_read_b128 v[144:147], v236 offset:24320
    s_mov_b64 exec, -1
    v_exp_f32 v59, v59
    v_exp_f32 v60, v60
    v_exp_f32 v61, v61
    v_exp_f32 v62, v62
    v_exp_f32 v63, v63
    v_mfma_f32_32x32x16_bf16 v[96:111], v[132:135], v[4:7], v[16:31]
    ds_read_b128 v[132:135], v233 offset:27648
    v_cvt_pk_bf16_f32 v116, v56, v57
    v_cvt_pk_bf16_f32 v117, v58, v59
    v_cvt_pk_bf16_f32 v118, v60, v61
    v_cvt_pk_bf16_f32 v119, v62, v63
    v_exp_f32 v64, v64
    v_exp_f32 v65, v65
    s_waitcnt lgkmcnt(4)
    v_mfma_f32_32x32x16_bf16 v[32:47], v[148:151], v[116:119], v[32:47]
    s_mov_b64 exec, s[28:29]
    ds_read_b128 v[148:151], v236 offset:24896
    s_mov_b64 exec, -1
    v_exp_f32 v66, v66
    v_exp_f32 v67, v67
    v_exp_f32 v68, v68
    v_mfma_f32_32x32x4_2b_bf16 v[80:111], v[138:139], v[10:11], v[80:111]
    v_exp_f32 v69, v69
    v_exp_f32 v70, v70
    v_exp_f32 v71, v71
    v_cvt_pk_bf16_f32 v120, v64, v65
    v_cvt_pk_bf16_f32 v121, v66, v67
    v_cvt_pk_bf16_f32 v122, v68, v69
    v_cvt_pk_bf16_f32 v123, v70, v71
    v_exp_f32 v72, v72
    v_exp_f32 v73, v73
    v_exp_f32 v74, v74
    s_waitcnt lgkmcnt(4)
    v_mfma_f32_32x32x16_bf16 v[32:47], v[152:155], v[120:123], v[32:47]
    s_mov_b64 exec, s[28:29]
    ds_read_b128 v[152:155], v236 offset:25472
    s_mov_b64 exec, -1
    v_exp_f32 v75, v75
    v_exp_f32 v76, v76
    v_exp_f32 v77, v77
    v_exp_f32 v78, v78
    v_exp_f32 v79, v79
    ds_read2st64_b32 v[136:137], v239 offset0:0 offset1:1
    ds_read2st64_b32 v[138:139], v239 offset0:2 offset1:3
    v_add_u32 v239, 18432, v239
    v_cvt_pk_bf16_f32 v124, v72, v73
    v_cvt_pk_bf16_f32 v125, v74, v75
    v_cvt_pk_bf16_f32 v126, v76, v77
    v_cvt_pk_bf16_f32 v127, v78, v79
    s_setprio 2
    v_exp_f32 v80, v80
    v_exp_f32 v81, v81
    v_exp_f32 v82, v82
    s_waitcnt lgkmcnt(4)
    v_mfma_f32_32x32x16_bf16 v[32:47], v[156:159], v[124:127], v[32:47]
    s_mov_b64 exec, s[28:29]
    ds_read_b128 v[156:159], v236 offset:26048
    s_mov_b64 exec, -1
    v_exp_f32 v83, v83
    v_exp_f32 v84, v84
    v_exp_f32 v85, v85
    v_exp_f32 v86, v86
    v_exp_f32 v87, v87
    v_mfma_f32_32x32x16_bf16 v[48:63], v[128:131], v[4:7], v[16:31]
    ds_read_b128 v[128:131], v233 offset:28672
    v_cvt_pk_bf16_f32 v112, v80, v81
    v_cvt_pk_bf16_f32 v113, v82, v83
    v_cvt_pk_bf16_f32 v114, v84, v85
    v_cvt_pk_bf16_f32 v115, v86, v87
    v_exp_f32 v88, v88
    v_exp_f32 v89, v89
    v_exp_f32 v90, v90
    s_waitcnt lgkmcnt(4)
    v_mfma_f32_32x32x16_bf16 v[32:47], v[144:147], v[112:115], v[32:47]
    s_mov_b64 exec, s[28:29]
    ds_read_b128 v[144:147], v236 offset:35840
    s_mov_b64 exec, -1
    v_exp_f32 v91, v91
    v_exp_f32 v92, v92
    v_exp_f32 v93, v93
    v_exp_f32 v94, v94
    v_exp_f32 v95, v95
    v_mfma_f32_32x32x16_bf16 v[64:79], v[132:135], v[4:7], v[16:31]
    ds_read_b128 v[132:135], v233 offset:29696
    v_cvt_pk_bf16_f32 v116, v88, v89
    v_cvt_pk_bf16_f32 v117, v90, v91
    v_cvt_pk_bf16_f32 v118, v92, v93
    v_cvt_pk_bf16_f32 v119, v94, v95
    v_exp_f32 v96, v96
    v_exp_f32 v97, v97
    s_waitcnt lgkmcnt(4)
    v_mfma_f32_32x32x16_bf16 v[32:47], v[148:151], v[116:119], v[32:47]
    s_mov_b64 exec, s[28:29]
    ds_read_b128 v[148:151], v236 offset:36416
    s_mov_b64 exec, -1
    v_exp_f32 v98, v98
    v_exp_f32 v99, v99
    v_exp_f32 v100, v100
    v_mfma_f32_32x32x4_2b_bf16 v[48:79], v[136:137], v[8:9], v[48:79]
    v_exp_f32 v101, v101
    v_exp_f32 v102, v102
    v_exp_f32 v103, v103
    v_cvt_pk_bf16_f32 v120, v96, v97
    v_cvt_pk_bf16_f32 v121, v98, v99
    v_cvt_pk_bf16_f32 v122, v100, v101
    v_cvt_pk_bf16_f32 v123, v102, v103
    v_exp_f32 v104, v104
    v_exp_f32 v105, v105
    v_exp_f32 v106, v106
    s_waitcnt lgkmcnt(4)
    v_mfma_f32_32x32x16_bf16 v[32:47], v[152:155], v[120:123], v[32:47]
    s_mov_b64 exec, s[28:29]
    ds_read_b128 v[152:155], v236 offset:36992
    s_mov_b64 exec, -1
    v_exp_f32 v107, v107
    v_exp_f32 v108, v108
    v_exp_f32 v109, v109
    v_exp_f32 v110, v110
    v_exp_f32 v111, v111
    v_cvt_pk_bf16_f32 v124, v104, v105
    v_cvt_pk_bf16_f32 v125, v106, v107
    v_cvt_pk_bf16_f32 v126, v108, v109
    v_cvt_pk_bf16_f32 v127, v110, v111
    v_exp_f32 v48, v48
    v_exp_f32 v49, v49
    v_exp_f32 v50, v50
    s_waitcnt lgkmcnt(4)
    v_mfma_f32_32x32x16_bf16 v[32:47], v[156:159], v[124:127], v[32:47]
    s_mov_b64 exec, s[28:29]
    ds_read_b128 v[156:159], v236 offset:37568
    s_mov_b64 exec, -1
    v_exp_f32 v51, v51
    v_exp_f32 v52, v52
    v_exp_f32 v53, v53
    v_exp_f32 v54, v54
    v_exp_f32 v55, v55
    v_mfma_f32_32x32x16_bf16 v[80:95], v[128:131], v[4:7], v[16:31]
    ds_read_b128 v[128:131], v233 offset:30720
    v_cvt_pk_bf16_f32 v112, v48, v49
    v_cvt_pk_bf16_f32 v113, v50, v51
    v_cvt_pk_bf16_f32 v114, v52, v53
    v_cvt_pk_bf16_f32 v115, v54, v55
    v_exp_f32 v56, v56
    v_exp_f32 v57, v57
    v_exp_f32 v58, v58
    s_waitcnt lgkmcnt(4)
    v_mfma_f32_32x32x16_bf16 v[32:47], v[144:147], v[112:115], v[32:47]
    s_mov_b64 exec, s[28:29]
    ds_read_b128 v[144:147], v236 offset:38144
    s_mov_b64 exec, -1
    v_exp_f32 v59, v59
    v_exp_f32 v60, v60
    v_exp_f32 v61, v61
    v_exp_f32 v62, v62
    v_exp_f32 v63, v63
    v_mfma_f32_32x32x16_bf16 v[96:111], v[132:135], v[4:7], v[16:31]
    ds_read_b128 v[132:135], v233 offset:31744
    v_cvt_pk_bf16_f32 v116, v56, v57
    v_cvt_pk_bf16_f32 v117, v58, v59
    v_cvt_pk_bf16_f32 v118, v60, v61
    v_cvt_pk_bf16_f32 v119, v62, v63
    v_exp_f32 v64, v64
    v_exp_f32 v65, v65
    s_waitcnt lgkmcnt(4)
    v_mfma_f32_32x32x16_bf16 v[32:47], v[148:151], v[116:119], v[32:47]
    s_mov_b64 exec, s[28:29]
    ds_read_b128 v[148:151], v236 offset:38720
    s_mov_b64 exec, -1
    v_exp_f32 v66, v66
    v_exp_f32 v67, v67
    v_exp_f32 v68, v68
    v_mfma_f32_32x32x4_2b_bf16 v[80:111], v[136:137], v[10:11], v[80:111]
    v_exp_f32 v69, v69
    v_exp_f32 v70, v70
    v_exp_f32 v71, v71
    v_cvt_pk_bf16_f32 v120, v64, v65
    v_cvt_pk_bf16_f32 v121, v66, v67
    v_cvt_pk_bf16_f32 v122, v68, v69
    v_cvt_pk_bf16_f32 v123, v70, v71
    v_exp_f32 v72, v72
    v_exp_f32 v73, v73
    v_exp_f32 v74, v74
    s_waitcnt lgkmcnt(4)
    v_mfma_f32_32x32x16_bf16 v[32:47], v[152:155], v[120:123], v[32:47]
    s_mov_b64 exec, s[28:29]
    ds_read_b128 v[152:155], v236 offset:39296
    s_mov_b64 exec, -1
    v_exp_f32 v75, v75
    v_exp_f32 v76, v76
    v_exp_f32 v77, v77
    v_exp_f32 v78, v78
    v_exp_f32 v79, v79
    v_cvt_pk_bf16_f32 v124, v72, v73
    v_cvt_pk_bf16_f32 v125, v74, v75
    v_cvt_pk_bf16_f32 v126, v76, v77
    v_cvt_pk_bf16_f32 v127, v78, v79
    v_exp_f32 v80, v80
    v_exp_f32 v81, v81
    v_exp_f32 v82, v82
    s_waitcnt lgkmcnt(4)
    v_mfma_f32_32x32x16_bf16 v[32:47], v[156:159], v[124:127], v[32:47]
    s_mov_b64 exec, s[28:29]
    ds_read_b128 v[156:159], v236 offset:39872
    s_mov_b64 exec, -1
    v_exp_f32 v83, v83
    v_exp_f32 v84, v84
    v_exp_f32 v85, v85
    v_exp_f32 v86, v86
    v_exp_f32 v87, v87
    v_mfma_f32_32x32x16_bf16 v[48:63], v[128:131], v[4:7], v[16:31]
    ds_read_b128 v[128:131], v233 offset:32768
    v_cvt_pk_bf16_f32 v112, v80, v81
    v_cvt_pk_bf16_f32 v113, v82, v83
    v_cvt_pk_bf16_f32 v114, v84, v85
    v_cvt_pk_bf16_f32 v115, v86, v87
    v_exp_f32 v88, v88
    v_exp_f32 v89, v89
    v_exp_f32 v90, v90
    s_waitcnt lgkmcnt(4)
    v_mfma_f32_32x32x16_bf16 v[32:47], v[144:147], v[112:115], v[32:47]
    s_mov_b64 exec, s[28:29]
    ds_read_b128 v[144:147], v236 offset:40448
    s_mov_b64 exec, -1
    v_exp_f32 v91, v91
    v_exp_f32 v92, v92
    v_exp_f32 v93, v93
    v_exp_f32 v94, v94
    v_exp_f32 v95, v95
    v_mfma_f32_32x32x16_bf16 v[64:79], v[132:135], v[4:7], v[16:31]
    ds_read_b128 v[132:135], v233 offset:33792
    v_cvt_pk_bf16_f32 v116, v88, v89
    v_cvt_pk_bf16_f32 v117, v90, v91
    v_cvt_pk_bf16_f32 v118, v92, v93
    v_cvt_pk_bf16_f32 v119, v94, v95
    v_exp_f32 v96, v96
    v_exp_f32 v97, v97
    s_waitcnt lgkmcnt(4)
    v_mfma_f32_32x32x16_bf16 v[32:47], v[148:151], v[116:119], v[32:47]
    s_mov_b64 exec, s[28:29]
    ds_read_b128 v[148:151], v236 offset:41024
    s_mov_b64 exec, -1
    v_exp_f32 v98, v98
    v_exp_f32 v99, v99
    v_exp_f32 v100, v100
    v_mfma_f32_32x32x4_2b_bf16 v[48:79], v[138:139], v[8:9], v[48:79]
    v_exp_f32 v101, v101
    v_exp_f32 v102, v102
    v_exp_f32 v103, v103
    v_cvt_pk_bf16_f32 v120, v96, v97
    v_cvt_pk_bf16_f32 v121, v98, v99
    v_cvt_pk_bf16_f32 v122, v100, v101
    v_cvt_pk_bf16_f32 v123, v102, v103
    v_exp_f32 v104, v104
    v_exp_f32 v105, v105
    v_exp_f32 v106, v106
    s_waitcnt lgkmcnt(4)
    v_mfma_f32_32x32x16_bf16 v[32:47], v[152:155], v[120:123], v[32:47]
    s_mov_b64 exec, s[28:29]
    ds_read_b128 v[152:155], v236 offset:41600
    s_mov_b64 exec, -1
    v_exp_f32 v107, v107
    v_exp_f32 v108, v108
    v_exp_f32 v109, v109
    v_exp_f32 v110, v110
    v_exp_f32 v111, v111
    s_waitcnt vmcnt(0)
    v_perm_b32 v192, v164, v160, s37
    v_perm_b32 v193, v172, v168, s37
    v_perm_b32 v194, v180, v176, s37
    v_perm_b32 v195, v188, v184, s37
    s_mul_i32 s33, s63, 0
    buffer_store_dwordx4 v[192:195], v14, s[16:19], s33 offen sc1
    v_mfma_f32_16x16x32_bf16 v[208:211], v[140:143], v[192:195], 0
    v_cvt_pk_bf16_f32 v124, v104, v105
    v_cvt_pk_bf16_f32 v125, v106, v107
    v_cvt_pk_bf16_f32 v126, v108, v109
    v_cvt_pk_bf16_f32 v127, v110, v111
    v_cmp_ne_u32 vcc, 1, v242
    s_nop 0
    s_cbranch_vccz fused_kernel_g2
    s_mov_b32 s57, 0
fused_kernel_g2p:
    buffer_load_dword v242, v241, s[16:19], s39 offen sc1
    s_add_u32 s57, s57, 1
    s_waitcnt vmcnt(0)
    v_cmp_ne_u32 vcc, 1, v242
    s_cmp_gt_u32 s57, 0x40000
    s_cbranch_scc1 fused_kernel_g2q
    s_cbranch_vccz fused_kernel_g2q
    s_sleep 3
    s_branch fused_kernel_g2p
fused_kernel_g2q:
fused_kernel_g2:
    v_exp_f32 v48, v48
    v_exp_f32 v49, v49
    v_exp_f32 v50, v50
    s_waitcnt lgkmcnt(4)
    v_mfma_f32_32x32x16_bf16 v[32:47], v[156:159], v[124:127], v[32:47]
    s_mov_b64 exec, s[28:29]
    ds_read_b128 v[156:159], v236 offset:42176
    s_mov_b64 exec, -1
    v_exp_f32 v51, v51
    v_exp_f32 v52, v52
    v_exp_f32 v53, v53
    v_exp_f32 v54, v54
    v_exp_f32 v55, v55
    v_mfma_f32_32x32x16_bf16 v[80:95], v[128:131], v[4:7], v[16:31]
    ds_read_b128 v[128:131], v233 offset:45056
    v_cvt_pk_bf16_f32 v112, v48, v49
    v_cvt_pk_bf16_f32 v113, v50, v51
    v_cvt_pk_bf16_f32 v114, v52, v53
    v_cvt_pk_bf16_f32 v115, v54, v55
    v_exp_f32 v56, v56
    v_exp_f32 v57, v57
    v_exp_f32 v58, v58
    s_waitcnt lgkmcnt(4)
    v_mfma_f32_32x32x16_bf16 v[32:47], v[144:147], v[112:115], v[32:47]
    s_mov_b64 exec, s[28:29]
    ds_read_b128 v[144:147], v236 offset:42752
    s_mov_b64 exec, -1
    v_exp_f32 v59, v59
    v_exp_f32 v60, v60
    v_exp_f32 v61, v61
    v_exp_f32 v62, v62
    v_exp_f32 v63, v63
    v_mfma_f32_32x32x16_bf16 v[96:111], v[132:135], v[4:7], v[16:31]
    ds_read_b128 v[132:135], v233 offset:46080
    v_cvt_pk_bf16_f32 v116, v56, v57
    v_cvt_pk_bf16_f32 v117, v58, v59
    v_cvt_pk_bf16_f32 v118, v60, v61
    v_cvt_pk_bf16_f32 v119, v62, v63
    v_exp_f32 v64, v64
    v_exp_f32 v65, v65
    s_waitcnt lgkmcnt(4)
    v_mfma_f32_32x32x16_bf16 v[32:47], v[148:151], v[116:119], v[32:47]
    s_mov_b64 exec, s[28:29]
    ds_read_b128 v[148:151], v236 offset:43328
    s_mov_b64 exec, -1
    v_exp_f32 v66, v66
    v_exp_f32 v67, v67
    v_exp_f32 v68, v68
    v_mfma_f32_32x32x4_2b_bf16 v[80:111], v[138:139], v[10:11], v[80:111]
    v_exp_f32 v69, v69
    v_exp_f32 v70, v70
    v_exp_f32 v71, v71
    v_cvt_pk_bf16_f32 v120, v64, v65
    v_cvt_pk_bf16_f32 v121, v66, v67
    v_cvt_pk_bf16_f32 v122, v68, v69
    v_cvt_pk_bf16_f32 v123, v70, v71
    v_exp_f32 v72, v72
    v_exp_f32 v73, v73
    v_exp_f32 v74, v74
    s_waitcnt lgkmcnt(4)
    v_mfma_f32_32x32x16_bf16 v[32:47], v[152:155], v[120:123], v[32:47]
    s_mov_b64 exec, s[28:29]
    ds_read_b128 v[152:155], v236 offset:43904
    s_mov_b64 exec, -1
    v_exp_f32 v75, v75
    v_exp_f32 v76, v76
    v_exp_f32 v77, v77
    v_exp_f32 v78, v78
    v_exp_f32 v79, v79
    ds_read2st64_b32 v[136:137], v239 offset0:0 offset1:1
    ds_read2st64_b32 v[138:139], v239 offset0:2 offset1:3
    v_add_u32 v239, 18432, v239
    v_perm_b32 v196, v164, v160, s38
    v_perm_b32 v197, v172, v168, s38
    v_perm_b32 v198, v180, v176, s38
    v_perm_b32 v199, v188, v184, s38
    s_mul_i32 s33, s63, 1
    buffer_store_dwordx4 v[196:199], v14, s[16:19], s33 offen sc1
    v_mfma_f32_16x16x32_bf16 v[208:211], v[248:251], v[196:199], v[208:211]
    v_cvt_pk_bf16_f32 v124, v72, v73
    v_cvt_pk_bf16_f32 v125, v74, v75
    v_cvt_pk_bf16_f32 v126, v76, v77
    v_cvt_pk_bf16_f32 v127, v78, v79
    v_exp_f32 v80, v80
    v_exp_f32 v81, v81
    v_exp_f32 v82, v82
    s_waitcnt lgkmcnt(4)
    v_mfma_f32_32x32x16_bf16 v[32:47], v[156:159], v[124:127], v[32:47]
    s_mov_b64 exec, s[28:29]
    ds_read_b128 v[156:159], v236 offset:44480
    s_mov_b64 exec, -1
    v_exp_f32 v83, v83
    v_exp_f32 v84, v84
    v_exp_f32 v85, v85
    v_exp_f32 v86, v86
    v_exp_f32 v87, v87
    v_mfma_f32_32x32x16_bf16 v[48:63], v[128:131], v[4:7], v[16:31]
    ds_read_b128 v[128:131], v233 offset:47104
    v_cvt_pk_bf16_f32 v112, v80, v81
    v_cvt_pk_bf16_f32 v113, v82, v83
    v_cvt_pk_bf16_f32 v114, v84, v85
    v_cvt_pk_bf16_f32 v115, v86, v87
    v_exp_f32 v88, v88
    v_exp_f32 v89, v89
    v_exp_f32 v90, v90
    s_waitcnt lgkmcnt(4)
    v_mfma_f32_32x32x16_bf16 v[32:47], v[144:147], v[112:115], v[32:47]
    s_mov_b64 exec, s[28:29]
    ds_read_b128 v[144:147], v236 offset:54272
    s_mov_b64 exec, -1
    v_exp_f32 v91, v91
    v_exp_f32 v92, v92
    v_exp_f32 v93, v93
    v_exp_f32 v94, v94
    v_exp_f32 v95, v95
    v_mfma_f32_32x32x16_bf16 v[64:79], v[132:135], v[4:7], v[16:31]
    ds_read_b128 v[132:135], v233 offset:48128
    buffer_atomic_add_f32 v208, v238, s[16:19], 0 offen offset:0
    v_cvt_pk_bf16_f32 v116, v88, v89
    v_cvt_pk_bf16_f32 v117, v90, v91
    v_cvt_pk_bf16_f32 v118, v92, v93
    v_cvt_pk_bf16_f32 v119, v94, v95
    v_exp_f32 v96, v96
    v_exp_f32 v97, v97
    s_waitcnt lgkmcnt(4)
    v_mfma_f32_32x32x16_bf16 v[32:47], v[148:151], v[116:119], v[32:47]
    s_mov_b64 exec, s[28:29]
    ds_read_b128 v[148:151], v236 offset:54848
    s_mov_b64 exec, -1
    v_exp_f32 v98, v98
    v_exp_f32 v99, v99
    v_exp_f32 v100, v100
    v_mfma_f32_32x32x4_2b_bf16 v[48:79], v[136:137], v[8:9], v[48:79]
    v_exp_f32 v101, v101
    v_exp_f32 v102, v102
    v_exp_f32 v103, v103
    v_cvt_pk_bf16_f32 v120, v96, v97
    v_cvt_pk_bf16_f32 v121, v98, v99
    v_cvt_pk_bf16_f32 v122, v100, v101
    v_cvt_pk_bf16_f32 v123, v102, v103
    v_exp_f32 v104, v104
    v_exp_f32 v105, v105
    v_exp_f32 v106, v106
    s_waitcnt lgkmcnt(4)
    v_mfma_f32_32x32x16_bf16 v[32:47], v[152:155], v[120:123], v[32:47]
    s_mov_b64 exec, s[28:29]
    ds_read_b128 v[152:155], v236 offset:55424
    s_mov_b64 exec, -1
    v_exp_f32 v107, v107
    v_exp_f32 v108, v108
    v_exp_f32 v109, v109
    v_exp_f32 v110, v110
    v_exp_f32 v111, v111
    v_perm_b32 v192, v165, v161, s37
    v_perm_b32 v193, v173, v169, s37
    v_perm_b32 v194, v181, v177, s37
    v_perm_b32 v195, v189, v185, s37
    s_mul_i32 s33, s63, 2
    buffer_store_dwordx4 v[192:195], v14, s[16:19], s33 offen sc1
    v_mfma_f32_16x16x32_bf16 v[208:211], v[140:143], v[192:195], 0
    v_cvt_pk_bf16_f32 v124, v104, v105
    v_cvt_pk_bf16_f32 v125, v106, v107
    v_cvt_pk_bf16_f32 v126, v108, v109
    v_cvt_pk_bf16_f32 v127, v110, v111
    v_exp_f32 v48, v48
    v_exp_f32 v49, v49
    v_exp_f32 v50, v50
    s_waitcnt lgkmcnt(4)
    v_mfma_f32_32x32x16_bf16 v[32:47], v[156:159], v[124:127], v[32:47]
    s_mov_b64 exec, s[28:29]
    ds_read_b128 v[156:159], v236 offset:56000
    s_mov_b64 exec, -1
    v_exp_f32 v51, v51
    v_exp_f32 v52, v52
    v_exp_f32 v53, v53
    v_exp_f32 v54, v54
    v_exp_f32 v55, v55
    v_mfma_f32_32x32x16_bf16 v[80:95], v[128:131], v[4:7], v[16:31]
    ds_read_b128 v[128:131], v233 offset:49152
    s_mov_b32 s20, s10
    s_and_b32 s21, s11, 0xffff
    s_mov_b32 s22, 2359296
    s_mov_b32 s23, 0x20000
    s_and_b32 s40, s2, 7
    s_mul_i32 s40, s40, 25
    s_lshr_b32 s41, s2, 3
    s_add_u32 s40, s40, s41
    s_cmp_ge_u32 s41, 25
    s_cselect_b32 s40, 255, s40
    s_mul_i32 s42, s40, 7282
    s_lshr_b32 s42, s42, 16
    s_mul_i32 s41, s42, 9
    s_sub_u32 s41, s40, s41
    s_mul_i32 s43, s41, 72
    s_mul_i32 s44, s24, 9
    s_add_u32 s43, s43, s44
    s_lshl_b32 s43, s43, 10
    s_add_u32 s43, s43, 12582912
    s_mul_i32 s44, s42, 12
    s_add_u32 s44, s44, s24
    s_mul_i32 s44, s44, 9216
    s_lshl_b32 s45, s41, 7
    s_add_u32 s44, s44, s45
    s_cmp_ge_u32 s40, 198
    s_cselect_b32 s43, 0x7ff00000, s43
    s_cselect_b32 s44, 0x7ff00000, s44
    s_add_u32 s45, s44, 73728
    s_and_b32 s46, s24, 1
    s_lshl_b32 s46, s46, 2
    v_lshrrev_b32 v12, 3, v2
    v_mul_u32_u24 v12, 1152, v12
    v_lshrrev_b32 v240, 4, v2
    v_xor_b32 v240, s46, v240
    v_and_b32 v241, 7, v2
    v_xor_b32 v240, v240, v241
    v_lshl_add_u32 v12, v240, 4, v12
    s_lshl_b32 s46, s24, 10
    s_add_u32 m0, s46, 147456
    s_nop 0
    buffer_load_dwordx4 v12, s[20:23], s44 offen lds
    v_cvt_pk_bf16_f32 v112, v48, v49
    v_cvt_pk_bf16_f32 v113, v50, v51
    v_cvt_pk_bf16_f32 v114, v52, v53
    v_cvt_pk_bf16_f32 v115, v54, v55
    v_exp_f32 v56, v56
    v_exp_f32 v57, v57
    v_exp_f32 v58, v58
    s_waitcnt lgkmcnt(4)
    v_mfma_f32_32x32x16_bf16 v[32:47], v[144:147], v[112:115], v[32:47]
    s_mov_b64 exec, s[28:29]
    ds_read_b128 v[144:147], v236 offset:56576
    s_mov_b64 exec, -1
    v_exp_f32 v59, v59
    v_exp_f32 v60, v60
    v_exp_f32 v61, v61
    v_exp_f32 v62, v62
    v_exp_f32 v63, v63
    v_mfma_f32_32x32x16_bf16 v[96:111], v[132:135], v[4:7], v[16:31]
    ds_read_b128 v[132:135], v233 offset:50176
    v_cvt_pk_bf16_f32 v116, v56, v57
    v_cvt_pk_bf16_f32 v117, v58, v59
    v_cvt_pk_bf16_f32 v118, v60, v61
    v_cvt_pk_bf16_f32 v119, v62, v63
    v_exp_f32 v64, v64
    v_exp_f32 v65, v65
    s_waitcnt lgkmcnt(4)
    v_mfma_f32_32x32x16_bf16 v[32:47], v[148:151], v[116:119], v[32:47]
    s_mov_b64 exec, s[28:29]
    ds_read_b128 v[148:151], v236 offset:57152
    s_mov_b64 exec, -1
    v_exp_f32 v66, v66
    v_exp_f32 v67, v67
    v_exp_f32 v68, v68
    v_mfma_f32_32x32x4_2b_bf16 v[80:111], v[136:137], v[10:11], v[80:111]
    v_exp_f32 v69, v69
    v_exp_f32 v70, v70
    v_exp_f32 v71, v71
    v_cvt_pk_bf16_f32 v120, v64, v65
    v_cvt_pk_bf16_f32 v121, v66, v67
    v_cvt_pk_bf16_f32 v122, v68, v69
    v_cvt_pk_bf16_f32 v123, v70, v71
    v_exp_f32 v72, v72
    v_exp_f32 v73, v73
    v_exp_f32 v74, v74
    s_waitcnt lgkmcnt(4)
    v_mfma_f32_32x32x16_bf16 v[32:47], v[152:155], v[120:123], v[32:47]
    s_mov_b64 exec, s[28:29]
    ds_read_b128 v[152:155], v236 offset:57728
    s_mov_b64 exec, -1
    v_exp_f32 v75, v75
    v_exp_f32 v76, v76
    v_exp_f32 v77, v77
    v_exp_f32 v78, v78
    v_exp_f32 v79, v79
    v_perm_b32 v196, v165, v161, s38
    v_perm_b32 v197, v173, v169, s38
    v_perm_b32 v198, v181, v177, s38
    v_perm_b32 v199, v189, v185, s38
    s_mul_i32 s33, s63, 3
    buffer_store_dwordx4 v[196:199], v14, s[16:19], s33 offen sc1
    v_mfma_f32_16x16x32_bf16 v[208:211], v[248:251], v[196:199], v[208:211]
    v_cvt_pk_bf16_f32 v124, v72, v73
    v_cvt_pk_bf16_f32 v125, v74, v75
    v_cvt_pk_bf16_f32 v126, v76, v77
    v_cvt_pk_bf16_f32 v127, v78, v79
    v_exp_f32 v80, v80
    v_exp_f32 v81, v81
    v_exp_f32 v82, v82
    s_waitcnt lgkmcnt(4)
    v_mfma_f32_32x32x16_bf16 v[32:47], v[156:159], v[124:127], v[32:47]
    s_mov_b64 exec, s[28:29]
    ds_read_b128 v[156:159], v236 offset:58304
    s_mov_b64 exec, -1
    v_exp_f32 v83, v83
    v_exp_f32 v84, v84
    v_exp_f32 v85, v85
    v_exp_f32 v86, v86
    v_exp_f32 v87, v87
    v_mfma_f32_32x32x16_bf16 v[48:63], v[128:131], v[4:7], v[16:31]
    ds_read_b128 v[128:131], v233 offset:51200
    s_cmp_lt_u32 s24, 4
    s_cbranch_scc0 fused_kernel_px
    s_add_u32 m0, s46, 155648
    s_nop 0
    buffer_load_dwordx4 v12, s[20:23], s45 offen lds
fused_kernel_px:
    v_cvt_pk_bf16_f32 v112, v80, v81
    v_cvt_pk_bf16_f32 v113, v82, v83
    v_cvt_pk_bf16_f32 v114, v84, v85
    v_cvt_pk_bf16_f32 v115, v86, v87
    v_exp_f32 v88, v88
    v_exp_f32 v89, v89
    v_exp_f32 v90, v90
    s_waitcnt lgkmcnt(4)
    v_mfma_f32_32x32x16_bf16 v[32:47], v[144:147], v[112:115], v[32:47]
    s_mov_b64 exec, s[28:29]
    ds_read_b128 v[144:147], v236 offset:58880
    s_mov_b64 exec, -1
    v_exp_f32 v91, v91
    v_exp_f32 v92, v92
    v_exp_f32 v93, v93
    v_exp_f32 v94, v94
    v_exp_f32 v95, v95
    v_mfma_f32_32x32x16_bf16 v[64:79], v[132:135], v[4:7], v[16:31]
    ds_read_b128 v[132:135], v233 offset:52224
    buffer_atomic_add_f32 v208, v238, s[16:19], 0 offen offset:256
    v_cvt_pk_bf16_f32 v116, v88, v89
    v_cvt_pk_bf16_f32 v117, v90, v91
    v_cvt_pk_bf16_f32 v118, v92, v93
    v_cvt_pk_bf16_f32 v119, v94, v95
    v_exp_f32 v96, v96
    v_exp_f32 v97, v97
    s_waitcnt lgkmcnt(4)
    v_mfma_f32_32x32x16_bf16 v[32:47], v[148:151], v[116:119], v[32:47]
    s_mov_b64 exec, s[28:29]
    ds_read_b128 v[148:151], v236 offset:59456
    s_mov_b64 exec, -1
    v_exp_f32 v98, v98
    v_exp_f32 v99, v99
    v_exp_f32 v100, v100
    v_mfma_f32_32x32x4_2b_bf16 v[48:79], v[138:139], v[8:9], v[48:79]
    v_exp_f32 v101, v101
    v_exp_f32 v102, v102
    v_exp_f32 v103, v103
    v_cvt_pk_bf16_f32 v120, v96, v97
    v_cvt_pk_bf16_f32 v121, v98, v99
    v_cvt_pk_bf16_f32 v122, v100, v101
    v_cvt_pk_bf16_f32 v123, v102, v103
    v_exp_f32 v104, v104
    v_exp_f32 v105, v105
    v_exp_f32 v106, v106
    s_waitcnt lgkmcnt(4)
    v_mfma_f32_32x32x16_bf16 v[32:47], v[152:155], v[120:123], v[32:47]
    s_mov_b64 exec, s[28:29]
    ds_read_b128 v[152:155], v236 offset:60032
    s_mov_b64 exec, -1
    v_exp_f32 v107, v107
    v_exp_f32 v108, v108
    v_exp_f32 v109, v109
    v_exp_f32 v110, v110
    v_exp_f32 v111, v111
    v_perm_b32 v192, v166, v162, s37
    v_perm_b32 v193, v174, v170, s37
    v_perm_b32 v194, v182, v178, s37
    v_perm_b32 v195, v190, v186, s37
    s_mul_i32 s33, s63, 0
    s_add_u32 s33, s33, s58
    buffer_store_dwordx4 v[192:195], v14, s[16:19], s33 offen sc1
    v_mfma_f32_16x16x32_bf16 v[208:211], v[140:143], v[192:195], 0
    v_cvt_pk_bf16_f32 v124, v104, v105
    v_cvt_pk_bf16_f32 v125, v106, v107
    v_cvt_pk_bf16_f32 v126, v108, v109
    v_cvt_pk_bf16_f32 v127, v110, v111
    s_setprio 1
    v_exp_f32 v48, v48
    v_exp_f32 v49, v49
    v_exp_f32 v50, v50
    s_waitcnt lgkmcnt(4)
    v_mfma_f32_32x32x16_bf16 v[32:47], v[156:159], v[124:127], v[32:47]
    s_mov_b64 exec, s[28:29]
    ds_read_b128 v[156:159], v236 offset:60608
    s_mov_b64 exec, -1
    v_exp_f32 v51, v51
    v_exp_f32 v52, v52
    v_exp_f32 v53, v53
    v_exp_f32 v54, v54
    v_exp_f32 v55, v55
    v_mfma_f32_32x32x16_bf16 v[80:95], v[128:131], v[4:7], v[16:31]
    ds_read_b128 v[128:131], v233 offset:63488
    s_getpc_b64 s[34:35]
L_pf5:
    s_add_u32 s34, s34, (fused_kernel_fin-L_pf5)&0xffffffff
    s_addc_u32 s35, s35, ((fused_kernel_fin-L_pf5)>>32)&0xffffffff
    v_lshlrev_b32 v204, 7, v0
    v_min_u32 v204, code_end-fused_kernel_fin, v204
    global_load_dword v205, v204, s[34:35]
    v_cvt_pk_bf16_f32 v112, v48, v49
    v_cvt_pk_bf16_f32 v113, v50, v51
    v_cvt_pk_bf16_f32 v114, v52, v53
    v_cvt_pk_bf16_f32 v115, v54, v55
    v_exp_f32 v56, v56
    v_exp_f32 v57, v57
    v_exp_f32 v58, v58
    s_waitcnt lgkmcnt(4)
    v_mfma_f32_32x32x16_bf16 v[32:47], v[144:147], v[112:115], v[32:47]
    s_mov_b64 exec, s[28:29]
    ds_read_b128 v[144:147], v236 offset:61184
    s_mov_b64 exec, -1
    v_exp_f32 v59, v59
    v_exp_f32 v60, v60
    v_exp_f32 v61, v61
    v_exp_f32 v62, v62
    v_exp_f32 v63, v63
    v_mfma_f32_32x32x16_bf16 v[96:111], v[132:135], v[4:7], v[16:31]
    ds_read_b128 v[132:135], v233 offset:64512
    v_cvt_pk_bf16_f32 v116, v56, v57
    v_cvt_pk_bf16_f32 v117, v58, v59
    v_cvt_pk_bf16_f32 v118, v60, v61
    v_cvt_pk_bf16_f32 v119, v62, v63
    v_exp_f32 v64, v64
    v_exp_f32 v65, v65
    s_waitcnt lgkmcnt(4)
    v_mfma_f32_32x32x16_bf16 v[32:47], v[148:151], v[116:119], v[32:47]
    s_mov_b64 exec, s[28:29]
    ds_read_b128 v[148:151], v236 offset:61760
    s_mov_b64 exec, -1
    v_exp_f32 v66, v66
    v_exp_f32 v67, v67
    v_exp_f32 v68, v68
    v_mfma_f32_32x32x4_2b_bf16 v[80:111], v[138:139], v[10:11], v[80:111]
    v_exp_f32 v69, v69
    v_exp_f32 v70, v70
    v_exp_f32 v71, v71
    v_cvt_pk_bf16_f32 v120, v64, v65
    v_cvt_pk_bf16_f32 v121, v66, v67
    v_cvt_pk_bf16_f32 v122, v68, v69
    v_cvt_pk_bf16_f32 v123, v70, v71
    v_exp_f32 v72, v72
    v_exp_f32 v73, v73
    v_exp_f32 v74, v74
    s_waitcnt lgkmcnt(4)
    v_mfma_f32_32x32x16_bf16 v[32:47], v[152:155], v[120:123], v[32:47]
    s_mov_b64 exec, s[28:29]
    ds_read_b128 v[152:155], v236 offset:62336
    s_mov_b64 exec, -1
    v_exp_f32 v75, v75
    v_exp_f32 v76, v76
    v_exp_f32 v77, v77
    v_exp_f32 v78, v78
    v_exp_f32 v79, v79
    ds_read2st64_b32 v[136:137], v239 offset0:0 offset1:1
    ds_read2st64_b32 v[138:139], v239 offset0:2 offset1:3
    v_add_u32 v239, 18432, v239
    v_perm_b32 v196, v166, v162, s38
    v_perm_b32 v197, v174, v170, s38
    v_perm_b32 v198, v182, v178, s38
    v_perm_b32 v199, v190, v186, s38
    s_mul_i32 s33, s63, 1
    s_add_u32 s33, s33, s58
    buffer_store_dwordx4 v[196:199], v14, s[16:19], s33 offen sc1
    v_mfma_f32_16x16x32_bf16 v[208:211], v[248:251], v[196:199], v[208:211]
    v_cvt_pk_bf16_f32 v124, v72, v73
    v_cvt_pk_bf16_f32 v125, v74, v75
    v_cvt_pk_bf16_f32 v126, v76, v77
    v_cvt_pk_bf16_f32 v127, v78, v79
    v_exp_f32 v80, v80
    v_exp_f32 v81, v81
    v_exp_f32 v82, v82
    s_waitcnt lgkmcnt(4)
    v_mfma_f32_32x32x16_bf16 v[32:47], v[156:159], v[124:127], v[32:47]
    s_mov_b64 exec, s[28:29]
    ds_read_b128 v[156:159], v236 offset:62912
    s_mov_b64 exec, -1
    v_exp_f32 v83, v83
    v_exp_f32 v84, v84
    v_exp_f32 v85, v85
    v_exp_f32 v86, v86
    v_exp_f32 v87, v87
    v_mfma_f32_32x32x16_bf16 v[48:63], v[128:131], v[4:7], v[16:31]
    ds_read_b128 v[128:131], v234 offset:0
    v_cvt_pk_bf16_f32 v112, v80, v81
    v_cvt_pk_bf16_f32 v113, v82, v83
    v_cvt_pk_bf16_f32 v114, v84, v85
    v_cvt_pk_bf16_f32 v115, v86, v87
    v_exp_f32 v88, v88
    v_exp_f32 v89, v89
    v_exp_f32 v90, v90
    s_waitcnt lgkmcnt(4)
    v_mfma_f32_32x32x16_bf16 v[32:47], v[144:147], v[112:115], v[32:47]
    s_mov_b64 exec, s[28:29]
    ds_read_b128 v[144:147], v237 offset:7168
    s_mov_b64 exec, -1
    v_exp_f32 v91, v91
    v_exp_f32 v92, v92
    v_exp_f32 v93, v93
    v_exp_f32 v94, v94
    v_exp_f32 v95, v95
    v_mfma_f32_32x32x16_bf16 v[64:79], v[132:135], v[4:7], v[16:31]
    ds_read_b128 v[132:135], v234 offset:1024
    buffer_atomic_add_f32 v208, v238, s[16:19], 0 offen offset:512
    v_cvt_pk_bf16_f32 v116, v88, v89
    v_cvt_pk_bf16_f32 v117, v90, v91
    v_cvt_pk_bf16_f32 v118, v92, v93
    v_cvt_pk_bf16_f32 v119, v94, v95
    v_exp_f32 v96, v96
    v_exp_f32 v97, v97
    s_waitcnt lgkmcnt(4)
    v_mfma_f32_32x32x16_bf16 v[32:47], v[148:151], v[116:119], v[32:47]
    s_mov_b64 exec, s[28:29]
    ds_read_b128 v[148:151], v237 offset:7744
    s_mov_b64 exec, -1
    v_exp_f32 v98, v98
    v_exp_f32 v99, v99
    v_exp_f32 v100, v100
    v_mfma_f32_32x32x4_2b_bf16 v[48:79], v[136:137], v[8:9], v[48:79]
    v_exp_f32 v101, v101
    v_exp_f32 v102, v102
    v_exp_f32 v103, v103
    v_cvt_pk_bf16_f32 v120, v96, v97
    v_cvt_pk_bf16_f32 v121, v98, v99
    v_cvt_pk_bf16_f32 v122, v100, v101
    v_cvt_pk_bf16_f32 v123, v102, v103
    v_exp_f32 v104, v104
    v_exp_f32 v105, v105
    v_exp_f32 v106, v106
    s_waitcnt lgkmcnt(4)
    v_mfma_f32_32x32x16_bf16 v[32:47], v[152:155], v[120:123], v[32:47]
    s_mov_b64 exec, s[28:29]
    ds_read_b128 v[152:155], v237 offset:8320
    s_mov_b64 exec, -1
    v_exp_f32 v107, v107
    v_exp_f32 v108, v108
    v_exp_f32 v109, v109
    v_exp_f32 v110, v110
    v_exp_f32 v111, v111
    v_perm_b32 v192, v167, v163, s37
    v_perm_b32 v193, v175, v171, s37
    v_perm_b32 v194, v183, v179, s37
    v_perm_b32 v195, v191, v187, s37
    s_mul_i32 s33, s63, 2
    s_add_u32 s33, s33, s58
    buffer_store_dwordx4 v[192:195], v14, s[16:19], s33 offen sc1
    v_mfma_f32_16x16x32_bf16 v[208:211], v[140:143], v[192:195], 0
    v_cvt_pk_bf16_f32 v124, v104, v105
    v_cvt_pk_bf16_f32 v125, v106, v107
    v_cvt_pk_bf16_f32 v126, v108, v109
    v_cvt_pk_bf16_f32 v127, v110, v111
    v_exp_f32 v48, v48
    v_exp_f32 v49, v49
    v_exp_f32 v50, v50
    s_waitcnt lgkmcnt(4)
    v_mfma_f32_32x32x16_bf16 v[32:47], v[156:159], v[124:127], v[32:47]
    s_mov_b64 exec, s[28:29]
    ds_read_b128 v[156:159], v237 offset:8896
    s_mov_b64 exec, -1
    v_exp_f32 v51, v51
    v_exp_f32 v52, v52
    v_exp_f32 v53, v53
    v_exp_f32 v54, v54
    v_exp_f32 v55, v55
    v_mfma_f32_32x32x16_bf16 v[80:95], v[128:131], v[4:7], v[16:31]
    ds_read_b128 v[128:131], v234 offset:2048
    v_cvt_pk_bf16_f32 v112, v48, v49
    v_cvt_pk_bf16_f32 v113, v50, v51
    v_cvt_pk_bf16_f32 v114, v52, v53
    v_cvt_pk_bf16_f32 v115, v54, v55
    v_exp_f32 v56, v56
    v_exp_f32 v57, v57
    v_exp_f32 v58, v58
    s_waitcnt lgkmcnt(4)
    v_mfma_f32_32x32x16_bf16 v[32:47], v[144:147], v[112:115], v[32:47]
    s_mov_b64 exec, s[28:29]
    ds_read_b128 v[144:147], v237 offset:9472
    s_mov_b64 exec, -1
    v_exp_f32 v59, v59
    v_exp_f32 v60, v60
    v_exp_f32 v61, v61
    v_exp_f32 v62, v62
    v_exp_f32 v63, v63
    v_mfma_f32_32x32x16_bf16 v[96:111], v[132:135], v[4:7], v[16:31]
    ds_read_b128 v[132:135], v234 offset:3072
    v_cvt_pk_bf16_f32 v116, v56, v57
    v_cvt_pk_bf16_f32 v117, v58, v59
    v_cvt_pk_bf16_f32 v118, v60, v61
    v_cvt_pk_bf16_f32 v119, v62, v63
    v_exp_f32 v64, v64
    v_exp_f32 v65, v65
    s_waitcnt lgkmcnt(4)
    v_mfma_f32_32x32x16_bf16 v[32:47], v[148:151], v[116:119], v[32:47]
    s_mov_b64 exec, s[28:29]
    ds_read_b128 v[148:151], v237 offset:10048
    s_mov_b64 exec, -1
    v_exp_f32 v66, v66
    v_exp_f32 v67, v67
    v_exp_f32 v68, v68
    v_mfma_f32_32x32x4_2b_bf16 v[80:111], v[136:137], v[10:11], v[80:111]
    v_exp_f32 v69, v69
    v_exp_f32 v70, v70
    v_exp_f32 v71, v71
    v_cvt_pk_bf16_f32 v120, v64, v65
    v_cvt_pk_bf16_f32 v121, v66, v67
    v_cvt_pk_bf16_f32 v122, v68, v69
    v_cvt_pk_bf16_f32 v123, v70, v71
    v_exp_f32 v72, v72
    v_exp_f32 v73, v73
    v_exp_f32 v74, v74
    s_waitcnt lgkmcnt(4)
    v_mfma_f32_32x32x16_bf16 v[32:47], v[152:155], v[120:123], v[32:47]
    s_mov_b64 exec, s[28:29]
    ds_read_b128 v[152:155], v237 offset:10624
    s_mov_b64 exec, -1
    v_exp_f32 v75, v75
    v_exp_f32 v76, v76
    v_exp_f32 v77, v77
    v_exp_f32 v78, v78
    v_exp_f32 v79, v79
    v_perm_b32 v196, v167, v163, s38
    v_perm_b32 v197, v175, v171, s38
    v_perm_b32 v198, v183, v179, s38
    v_perm_b32 v199, v191, v187, s38
    s_mul_i32 s33, s63, 3
    s_add_u32 s33, s33, s58
    buffer_store_dwordx4 v[196:199], v14, s[16:19], s33 offen sc1
    v_mfma_f32_16x16x32_bf16 v[208:211], v[248:251], v[196:199], v[208:211]
    v_cvt_pk_bf16_f32 v124, v72, v73
    v_cvt_pk_bf16_f32 v125, v74, v75
    v_cvt_pk_bf16_f32 v126, v76, v77
    v_cvt_pk_bf16_f32 v127, v78, v79
    v_exp_f32 v80, v80
    v_exp_f32 v81, v81
    v_exp_f32 v82, v82
    s_waitcnt lgkmcnt(4)
    v_mfma_f32_32x32x16_bf16 v[32:47], v[156:159], v[124:127], v[32:47]
    s_mov_b64 exec, s[28:29]
    ds_read_b128 v[156:159], v237 offset:11200
    s_mov_b64 exec, -1
    v_exp_f32 v83, v83
    v_exp_f32 v84, v84
    v_exp_f32 v85, v85
    v_exp_f32 v86, v86
    v_exp_f32 v87, v87
    v_mfma_f32_32x32x16_bf16 v[48:63], v[128:131], v[4:7], v[16:31]
    ds_read_b128 v[128:131], v234 offset:4096
    s_add_u32 s47, s43, 0
    buffer_load_dwordx4 v[160:163], v3, s[16:19], s47 offen offset:0 sc1
    v_cvt_pk_bf16_f32 v112, v80, v81
    v_cvt_pk_bf16_f32 v113, v82, v83
    v_cvt_pk_bf16_f32 v114, v84, v85
    v_cvt_pk_bf16_f32 v115, v86, v87
    v_exp_f32 v88, v88
    v_exp_f32 v89, v89
    v_exp_f32 v90, v90
    s_waitcnt lgkmcnt(4)
    v_mfma_f32_32x32x16_bf16 v[32:47], v[144:147], v[112:115], v[32:47]
    s_mov_b64 exec, s[28:29]
    ds_read_b128 v[144:147], v237 offset:11776
    s_mov_b64 exec, -1
    v_exp_f32 v91, v91
    v_exp_f32 v92, v92
    v_exp_f32 v93, v93
    v_exp_f32 v94, v94
    v_exp_f32 v95, v95
    v_mfma_f32_32x32x16_bf16 v[64:79], v[132:135], v[4:7], v[16:31]
    ds_read_b128 v[132:135], v234 offset:5120
    buffer_atomic_add_f32 v208, v238, s[16:19], 0 offen offset:768
    s_add_u32 s47, s43, 0
    buffer_load_dwordx4 v[164:167], v3, s[16:19], s47 offen offset:1024 sc1
    v_cvt_pk_bf16_f32 v116, v88, v89
    v_cvt_pk_bf16_f32 v117, v90, v91
    v_cvt_pk_bf16_f32 v118, v92, v93
    v_cvt_pk_bf16_f32 v119, v94, v95
    v_exp_f32 v96, v96
    v_exp_f32 v97, v97
    s_waitcnt lgkmcnt(4)
    v_mfma_f32_32x32x16_bf16 v[32:47], v[148:151], v[116:119], v[32:47]
    s_mov_b64 exec, s[28:29]
    ds_read_b128 v[148:151], v237 offset:12352
    s_mov_b64 exec, -1
    v_exp_f32 v98, v98
    v_exp_f32 v99, v99
    v_exp_f32 v100, v100
    v_mfma_f32_32x32x4_2b_bf16 v[48:79], v[138:139], v[8:9], v[48:79]
    v_exp_f32 v101, v101
    v_exp_f32 v102, v102
    v_exp_f32 v103, v103
    v_cvt_pk_bf16_f32 v120, v96, v97
    v_cvt_pk_bf16_f32 v121, v98, v99
    v_cvt_pk_bf16_f32 v122, v100, v101
    v_cvt_pk_bf16_f32 v123, v102, v103
    v_exp_f32 v104, v104
    v_exp_f32 v105, v105
    v_exp_f32 v106, v106
    s_waitcnt lgkmcnt(4)
    v_mfma_f32_32x32x16_bf16 v[32:47], v[152:155], v[120:123], v[32:47]
    s_mov_b64 exec, s[28:29]
    ds_read_b128 v[152:155], v237 offset:12928
    s_mov_b64 exec, -1
    v_exp_f32 v107, v107
    v_exp_f32 v108, v108
    v_exp_f32 v109, v109
    v_exp_f32 v110, v110
    v_exp_f32 v111, v111
    s_add_u32 s47, s43, 0
    buffer_load_dwordx4 v[168:171], v3, s[16:19], s47 offen offset:2048 sc1
    s_cmp_lt_u32 s61, 576
    s_cbranch_scc0 fused_kernel_ms
    v_lshl_or_b32 v224, v225, 16, v224
    v_lshl_or_b32 v225, v227, 16, v226
    v_lshl_or_b32 v226, v229, 16, v228
    v_lshl_or_b32 v227, v231, 16, v230
    buffer_store_dwordx4 v[224:227], v15, s[16:19], 0 offen sc1
fused_kernel_ms:
    v_cvt_pk_bf16_f32 v124, v104, v105
    v_cvt_pk_bf16_f32 v125, v106, v107
    v_cvt_pk_bf16_f32 v126, v108, v109
    v_cvt_pk_bf16_f32 v127, v110, v111
    s_setprio 0
    v_exp_f32 v48, v48
    v_exp_f32 v49, v49
    v_exp_f32 v50, v50
    s_waitcnt lgkmcnt(0)
    v_mfma_f32_32x32x16_bf16 v[32:47], v[156:159], v[124:127], v[32:47]
    s_mov_b64 exec, s[28:29]
    ds_read_b128 v[156:159], v237 offset:13504
    s_mov_b64 exec, -1
    v_exp_f32 v51, v51
    v_exp_f32 v52, v52
    v_exp_f32 v53, v53
    v_exp_f32 v54, v54
    v_exp_f32 v55, v55
    v_mfma_f32_32x32x16_bf16 v[80:95], v[128:131], v[4:7], v[16:31]
    s_add_u32 s47, s43, 0
    buffer_load_dwordx4 v[172:175], v3, s[16:19], s47 offen offset:3072 sc1
    v_cvt_pk_bf16_f32 v112, v48, v49
    v_cvt_pk_bf16_f32 v113, v50, v51
    v_cvt_pk_bf16_f32 v114, v52, v53
    v_cvt_pk_bf16_f32 v115, v54, v55
    v_exp_f32 v56, v56
    v_exp_f32 v57, v57
    v_exp_f32 v58, v58
    s_waitcnt lgkmcnt(0)
    v_mfma_f32_32x32x16_bf16 v[32:47], v[144:147], v[112:115], v[32:47]
    s_mov_b64 exec, s[28:29]
    ds_read_b128 v[144:147], v237 offset:14080
    s_mov_b64 exec, -1
    v_exp_f32 v59, v59
    v_exp_f32 v60, v60
    v_exp_f32 v61, v61
    v_exp_f32 v62, v62
    v_exp_f32 v63, v63
    v_mfma_f32_32x32x16_bf16 v[96:111], v[132:135], v[4:7], v[16:31]
    s_add_u32 s47, s43, 4096
    buffer_load_dwordx4 v[176:179], v3, s[16:19], s47 offen offset:0 sc1
    v_cvt_pk_bf16_f32 v116, v56, v57
    v_cvt_pk_bf16_f32 v117, v58, v59
    v_cvt_pk_bf16_f32 v118, v60, v61
    v_cvt_pk_bf16_f32 v119, v62, v63
    v_exp_f32 v64, v64
    v_exp_f32 v65, v65
    s_waitcnt lgkmcnt(0)
    v_mfma_f32_32x32x16_bf16 v[32:47], v[148:151], v[116:119], v[32:47]
    s_mov_b64 exec, s[28:29]
    ds_read_b128 v[148:151], v237 offset:14656
    s_mov_b64 exec, -1
    v_exp_f32 v66, v66
    v_exp_f32 v67, v67
    v_exp_f32 v68, v68
    v_mfma_f32_32x32x4_2b_bf16 v[80:111], v[138:139], v[10:11], v[80:111]
    v_exp_f32 v69, v69
    v_exp_f32 v70, v70
    v_exp_f32 v71, v71
    v_cvt_pk_bf16_f32 v120, v64, v65
    v_cvt_pk_bf16_f32 v121, v66, v67
    v_cvt_pk_bf16_f32 v122, v68, v69
    v_cvt_pk_bf16_f32 v123, v70, v71
    v_exp_f32 v72, v72
    v_exp_f32 v73, v73
    v_exp_f32 v74, v74
    s_waitcnt lgkmcnt(0)
    v_mfma_f32_32x32x16_bf16 v[32:47], v[152:155], v[120:123], v[32:47]
    s_mov_b64 exec, s[28:29]
    ds_read_b128 v[152:155], v237 offset:15232
    s_mov_b64 exec, -1
    v_exp_f32 v75, v75
    v_exp_f32 v76, v76
    v_exp_f32 v77, v77
    v_exp_f32 v78, v78
    v_exp_f32 v79, v79
    s_add_u32 s47, s43, 4096
    buffer_load_dwordx4 v[180:183], v3, s[16:19], s47 offen offset:1024 sc1
    v_cvt_pk_bf16_f32 v124, v72, v73
    v_cvt_pk_bf16_f32 v125, v74, v75
    v_cvt_pk_bf16_f32 v126, v76, v77
    v_cvt_pk_bf16_f32 v127, v78, v79
    v_exp_f32 v80, v80
    v_exp_f32 v81, v81
    v_exp_f32 v82, v82
    s_waitcnt lgkmcnt(0)
    v_mfma_f32_32x32x16_bf16 v[32:47], v[156:159], v[124:127], v[32:47]
    s_mov_b64 exec, s[28:29]
    ds_read_b128 v[156:159], v237 offset:15808
    s_mov_b64 exec, -1
    v_exp_f32 v83, v83
    v_exp_f32 v84, v84
    v_exp_f32 v85, v85
    v_exp_f32 v86, v86
    v_exp_f32 v87, v87
    s_add_u32 s47, s43, 4096
    buffer_load_dwordx4 v[184:187], v3, s[16:19], s47 offen offset:2048 sc1
    v_cvt_pk_bf16_f32 v112, v80, v81
    v_cvt_pk_bf16_f32 v113, v82, v83
    v_cvt_pk_bf16_f32 v114, v84, v85
    v_cvt_pk_bf16_f32 v115, v86, v87
    v_exp_f32 v88, v88
    v_exp_f32 v89, v89
    v_exp_f32 v90, v90
    s_waitcnt lgkmcnt(0)
    v_mfma_f32_32x32x16_bf16 v[32:47], v[144:147], v[112:115], v[32:47]
    v_exp_f32 v91, v91
    v_exp_f32 v92, v92
    v_exp_f32 v93, v93
    v_exp_f32 v94, v94
    v_exp_f32 v95, v95
    s_add_u32 s47, s43, 4096
    buffer_load_dwordx4 v[188:191], v3, s[16:19], s47 offen offset:3072 sc1
    v_cvt_pk_bf16_f32 v116, v88, v89
    v_cvt_pk_bf16_f32 v117, v90, v91
    v_cvt_pk_bf16_f32 v118, v92, v93
    v_cvt_pk_bf16_f32 v119, v94, v95
    v_exp_f32 v96, v96
    v_exp_f32 v97, v97
    s_waitcnt lgkmcnt(0)
    v_mfma_f32_32x32x16_bf16 v[32:47], v[148:151], v[116:119], v[32:47]
    v_exp_f32 v98, v98
    v_exp_f32 v99, v99
    v_exp_f32 v100, v100
    v_exp_f32 v101, v101
    v_exp_f32 v102, v102
    v_exp_f32 v103, v103
    v_cvt_pk_bf16_f32 v120, v96, v97
    v_cvt_pk_bf16_f32 v121, v98, v99
    v_cvt_pk_bf16_f32 v122, v100, v101
    v_cvt_pk_bf16_f32 v123, v102, v103
    v_exp_f32 v104, v104
    v_exp_f32 v105, v105
    v_exp_f32 v106, v106
    s_waitcnt lgkmcnt(0)
    v_mfma_f32_32x32x16_bf16 v[32:47], v[152:155], v[120:123], v[32:47]
    v_exp_f32 v107, v107
    v_exp_f32 v108, v108
    v_exp_f32 v109, v109
    v_exp_f32 v110, v110
    v_exp_f32 v111, v111
    s_add_u32 s47, s43, 8192
    buffer_load_dwordx4 v[244:247], v3, s[16:19], s47 offen offset:0 sc1
    v_cvt_pk_bf16_f32 v124, v104, v105
    v_cvt_pk_bf16_f32 v125, v106, v107
    v_cvt_pk_bf16_f32 v126, v108, v109
    v_cvt_pk_bf16_f32 v127, v110, v111
    s_waitcnt lgkmcnt(0)
    s_nop 0
    v_mfma_f32_32x32x16_bf16 v[32:47], v[156:159], v[124:127], v[32:47]
    v_cmp_gt_u32 vcc, 32, v2
    s_nop 10
    v_cndmask_b32 v16, v42, v42, vcc
    v_mov_b32 v17, 0x4e800000
    v_mov_b32 v18, 0x30800000
    v_cmp_nlt_f32 vcc, v16, v17
    v_cmp_ngt_f32 s[34:35], v16, v18
    s_nop 0
    s_or_b64 vcc, vcc, s[34:35]
    s_cbranch_scc1 fused_kernel_slow
fused_kernel_fin:
    v_cmp_gt_u32 vcc, 32, v2
    s_nop 1
    v_cndmask_b32 v16, v42, v42, vcc
    v_rcp_f32 v16, v16
    s_mul_i32 s27, s26, 36864
    s_add_u32 s27, s27, 7340032
    s_lshl_b32 s28, s25, 10
    s_add_u32 s28, s28, s27
    s_lshl_b32 s29, s25, 7
    s_add_u32 s27, s27, s29
    s_add_u32 s27, s27, 32768
    v_lshlrev_b32 v18, 2, v2
    v_mul_f32 v32, v32, v16
    v_mul_f32 v33, v33, v16
    v_mul_f32 v34, v34, v16
    v_mul_f32 v35, v35, v16
    v_mul_f32 v36, v36, v16
    v_mul_f32 v37, v37, v16
    v_mul_f32 v38, v38, v16
    v_mul_f32 v39, v39, v16
    v_mul_f32 v40, v40, v16
    v_mul_f32 v41, v41, v16
    v_cvt_pk_bf16_f32 v112, v32, v33
    v_cvt_pk_bf16_f32 v113, v34, v35
    v_cvt_pk_bf16_f32 v114, v36, v37
    v_cvt_pk_bf16_f32 v115, v38, v39
    v_cvt_pk_bf16_f32 v116, v40, v41
    buffer_store_dwordx4 v[112:115], v3, s[16:19], s28 offen sc1
    s_and_saveexec_b64 s[34:35], vcc
    buffer_store_dword v116, v18, s[16:19], s27 offen sc1
    s_mov_b64 exec, -1
    s_and_b32 s25, s2, 7
    s_mul_i32 s25, s25, 25
    s_lshr_b32 s26, s2, 3
    s_add_u32 s25, s25, s26
    s_cmp_ge_u32 s26, 25
    s_cselect_b32 s25, 255, s25
    s_mul_i32 s27, s25, 7282
    s_lshr_b32 s27, s27, 16
    s_mul_i32 s26, s27, 9
    s_sub_u32 s26, s25, s26
    s_bfe_u32 s44, s2, 0x20001
    s_lshl_b32 s44, s44, 3
    s_bfe_u32 s45, s2, 0x30003
    s_add_u32 s44, s44, s45
    s_and_b32 s45, s2, 1
    s_lshl_b32 s45, s45, 2
    s_lshr_b32 s46, s2, 6
    s_add_u32 s45, s45, s46
    s_mul_i32 s28, s44, 331776
    s_add_u32 s28, s28, 13631488
    s_waitcnt lgkmcnt(0)
    s_mov_b32 s12, s8
    s_and_b32 s13, s9, 0xffff
    s_mov_b32 s14, 71303168
    s_mov_b32 s15, 0x20000
    s_mov_b32 s20, s10
    s_and_b32 s21, s11, 0xffff
    s_mov_b32 s22, 2359296
    s_mov_b32 s23, 0x20000
    s_add_u32 s16, s8, s28
    s_addc_u32 s17, s9, 0
    s_and_b32 s17, s17, 0xffff
    s_mov_b32 s18, 331776
    s_mov_b32 s19, 0x20000
    v_mov_b32 v8, 1
    s_lshl_b32 s33, s2, 7
    s_add_u32 s33, s33, 68288512
    s_cmp_eq_u32 s24, 0
    s_cselect_b32 s33, s33, 2146435072
    v_mov_b32 v9, 0
    s_waitcnt vmcnt(0)
    s_barrier
    s_mov_b64 exec, 1
    buffer_store_dword v8, v9, s[12:15], s33 offen sc1
    s_mov_b64 exec, -1
    s_mul_i32 s33, s24, 9216
    s_add_u32 s33, s33, 65536
    v_add_u32 v10, s33, v3
    ds_write_b128 v10, v[160:163] offset:0
    ds_write_b128 v10, v[164:167] offset:1024
    ds_write_b128 v10, v[168:171] offset:2048
    ds_write_b128 v10, v[172:175] offset:3072
    ds_write_b128 v10, v[176:179] offset:4096
    ds_write_b128 v10, v[180:183] offset:5120
    ds_write_b128 v10, v[184:187] offset:6144
    ds_write_b128 v10, v[188:191] offset:7168
    ds_write_b128 v10, v[244:247] offset:8192
    s_waitcnt lgkmcnt(0)
    s_cmp_ge_u32 s24, 3
    s_cbranch_scc1 fused_kernel_f_xi
    v_bfe_u32 v4, v2, 1, 3
    v_lshrrev_b32 v5, 5, v2
    v_lshlrev_b32 v5, 2, v5
    v_xor_b32 v4, v4, v5
    v_lshlrev_b32 v4, 4, v4
    v_lshl_add_u32 v4, v1, 7, v4
    s_lshl_b32 s33, s24, 12
    s_add_u32 s33, s33, 147456
    v_add_u32 v4, s33, v4
    s_mov_b32 s39, 0xffff0000
    v_xor_b32 v5, 0, v4
    ds_read_b128 v[208:211], v5
    v_xor_b32 v5, 16, v4
    ds_read_b128 v[212:215], v5
    v_xor_b32 v5, 32, v4
    ds_read_b128 v[216:219], v5
    v_xor_b32 v5, 48, v4
    ds_read_b128 v[220:223], v5
    s_waitcnt lgkmcnt(3)
    v_lshlrev_b32 v176, 16, v208
    v_and_b32 v180, s39, v208
    v_lshlrev_b32 v184, 16, v209
    v_and_b32 v188, s39, v209
    v_lshlrev_b32 v192, 16, v210
    v_and_b32 v196, s39, v210
    v_lshlrev_b32 v200, 16, v211
    v_and_b32 v204, s39, v211
    s_waitcnt lgkmcnt(2)
    v_lshlrev_b32 v177, 16, v212
    v_and_b32 v181, s39, v212
    v_lshlrev_b32 v185, 16, v213
    v_and_b32 v189, s39, v213
    v_lshlrev_b32 v193, 16, v214
    v_and_b32 v197, s39, v214
    v_lshlrev_b32 v201, 16, v215
    v_and_b32 v205, s39, v215
    s_waitcnt lgkmcnt(1)
    v_lshlrev_b32 v178, 16, v216
    v_and_b32 v182, s39, v216
    v_lshlrev_b32 v186, 16, v217
    v_and_b32 v190, s39, v217
    v_lshlrev_b32 v194, 16, v218
    v_and_b32 v198, s39, v218
    v_lshlrev_b32 v202, 16, v219
    v_and_b32 v206, s39, v219
    s_waitcnt lgkmcnt(0)
    v_lshlrev_b32 v179, 16, v220
    v_and_b32 v183, s39, v220
    v_lshlrev_b32 v187, 16, v221
    v_and_b32 v191, s39, v221
    v_lshlrev_b32 v195, 16, v222
    v_and_b32 v199, s39, v222
    v_lshlrev_b32 v203, 16, v223
    v_and_b32 v207, s39, v223
fused_kernel_f_xi:
    s_cmp_lt_u32 s2, 248
    s_cbranch_scc1 fused_kernel_f_nm
    s_cmp_lg_u32 s24, 1
    s_cbranch_scc1 fused_kernel_f_nm
    v_lshlrev_b32 v14, 7, v2
    s_mov_b32 s57, 0
fused_kernel_f_gp:
    s_mov_b32 s33, 68288512
    buffer_load_dword v8, v14, s[12:15], s33 offen sc1
    s_add_u32 s33, s33, 8192
    buffer_load_dword v9, v14, s[12:15], s33 offen sc1
    s_add_u32 s33, s33, 8192
    buffer_load_dword v10, v14, s[12:15], s33 offen sc1
    s_add_u32 s33, s33, 8192
    buffer_load_dword v11, v14, s[12:15], s33 offen sc1
    s_add_u32 s57, s57, 1
    s_waitcnt vmcnt(0)
    v_and_b32 v8, v8, v9
    v_and_b32 v10, v10, v11
    v_and_b32 v8, v8, v10
    v_cmp_ne_u32 vcc, 1, v8
    s_cmp_gt_u32 s57, 0x40000
    s_cbranch_scc1 fused_kernel_f_gq
    s_cbranch_vccnz fused_kernel_f_gp
fused_kernel_f_gq:
    s_and_b32 s33, s2, 7
    s_lshl_b32 s33, s33, 7
    s_add_u32 s33, s33, 68222976
    v_lshlrev_b32 v14, 10, v1
    v_mov_b32 v15, 1
    buffer_store_dword v15, v14, s[12:15], s33 offen sc1
fused_kernel_f_nm:
    s_cmp_lg_u32 s24, 3
    s_cbranch_scc1 fused_kernel_f_n0
    s_lshl_b32 s33, s2, 7
    s_add_u32 s33, s33, 68222976
    v_mov_b32 v14, 0
    s_cmp_ge_u32 s25, 198
    s_cbranch_scc1 fused_kernel_f_h1
    s_mul_i32 s34, s27, 3
    s_add_u32 s35, s34, 2
    s_min_u32 s35, s35, 63
    s_lshr_b32 s34, s34, 3
    s_lshr_b32 s35, s35, 3
    s_sub_u32 s35, s35, s34
    s_lshl_b32 s35, s35, 5
    s_add_u32 s35, s35, 31
    v_and_b32 v14, s35, v2
    v_lshlrev_b32 v14, 7, v14
    s_lshl_b32 s33, s34, 12
    s_add_u32 s33, s33, 68288512
fused_kernel_f_h1:
    s_mov_b32 s57, 0
fused_kernel_f_op:
    buffer_load_dword v15, v14, s[12:15], s33 offen sc1
    s_add_u32 s57, s57, 1
    s_waitcnt vmcnt(0)
    v_cmp_ne_u32 vcc, 1, v15
    s_cmp_gt_u32 s57, 0x40000
    s_cbranch_scc1 fused_kernel_f_oq
    s_cbranch_vccz fused_kernel_f_oq
    s_sleep 3
    s_branch fused_kernel_f_op
fused_kernel_f_oq:
fused_kernel_f_n0:
    s_cmp_lt_u32 s25, 198
    s_cbranch_scc1 fused_kernel_f_at
    s_barrier
    s_branch fused_kernel_f_apost
fused_kernel_f_at:
    s_cmp_ge_u32 s25, 198
    s_cbranch_scc1 fused_kernel_f_apost
    s_cmp_ge_u32 s24, 3
    s_cbranch_scc1 fused_kernel_f_aload
    s_mul_i32 s29, s27, 3
    s_add_u32 s29, s29, s24
    s_mul_i32 s30, s29, 36864
    s_cmp_ge_u32 s29, 64
    s_cselect_b32 s30, 2146435072, s30
    s_add_u32 s31, s30, 7340032
    s_add_u32 s32, s31, 32768
    s_and_b32 s34, s26, 0
    s_lshl_b32 s34, s34, 12
    s_add_u32 s31, s31, s34
    v_add_u32 v6, 65536, v3
    v_add_u32 v7, 102400, v3
    v_lshrrev_b32 v9, 5, v2
    v_lshlrev_b32 v9, 9, v9
    v_lshl_add_u32 v9, v1, 2, v9
    s_barrier
    buffer_load_dword v160, v9, s[12:15], s32 offen offset:0 sc1
    buffer_load_dword v161, v9, s[12:15], s32 offen offset:128 sc1
    buffer_load_dword v162, v9, s[12:15], s32 offen offset:256 sc1
    buffer_load_dword v163, v9, s[12:15], s32 offen offset:384 sc1
    buffer_load_dword v164, v9, s[12:15], s32 offen offset:1024 sc1
    buffer_load_dword v165, v9, s[12:15], s32 offen offset:1152 sc1
    buffer_load_dword v166, v9, s[12:15], s32 offen offset:1280 sc1
    buffer_load_dword v167, v9, s[12:15], s32 offen offset:1408 sc1
    buffer_load_dword v168, v9, s[12:15], s32 offen offset:2048 sc1
    buffer_load_dword v169, v9, s[12:15], s32 offen offset:2176 sc1
    buffer_load_dword v170, v9, s[12:15], s32 offen offset:2304 sc1
    buffer_load_dword v171, v9, s[12:15], s32 offen offset:2432 sc1
    buffer_load_dword v172, v9, s[12:15], s32 offen offset:3072 sc1
    buffer_load_dword v173, v9, s[12:15], s32 offen offset:3200 sc1
    buffer_load_dword v174, v9, s[12:15], s32 offen offset:3328 sc1
    buffer_load_dword v175, v9, s[12:15], s32 offen offset:3456 sc1
    buffer_load_dwordx4 v[32:35], v3, s[12:15], s31 offen offset:0 sc1
    buffer_load_dwordx4 v[36:39], v3, s[12:15], s31 offen offset:1024 sc1
    buffer_load_dwordx4 v[40:43], v3, s[12:15], s31 offen offset:2048 sc1
    buffer_load_dwordx4 v[44:47], v3, s[12:15], s31 offen offset:3072 sc1
    s_add_u32 s31, s31, 4096
    s_cmp_ge_u32 s31, s32
    s_cselect_b32 s34, 32768, 0
    s_sub_u32 s31, s31, s34
    buffer_load_dwordx4 v[48:51], v3, s[12:15], s31 offen offset:0 sc1
    buffer_load_dwordx4 v[52:55], v3, s[12:15], s31 offen offset:1024 sc1
    buffer_load_dwordx4 v[56:59], v3, s[12:15], s31 offen offset:2048 sc1
    buffer_load_dwordx4 v[60:63], v3, s[12:15], s31 offen offset:3072 sc1
    s_add_u32 s31, s31, 4096
    s_cmp_ge_u32 s31, s32
    s_cselect_b32 s34, 32768, 0
    s_sub_u32 s31, s31, s34
    buffer_load_dwordx4 v[64:67], v3, s[12:15], s31 offen offset:0 sc1
    buffer_load_dwordx4 v[68:71], v3, s[12:15], s31 offen offset:1024 sc1
    v_bfe_u32 v4, v2, 1, 3
    v_lshrrev_b32 v5, 5, v2
    v_lshlrev_b32 v5, 2, v5
    v_xor_b32 v4, v4, v5
    v_lshlrev_b32 v4, 4, v4
    v_lshl_add_u32 v4, v1, 7, v4
    s_lshl_b32 s33, s24, 12
    s_add_u32 s33, s33, 147456
    v_add_u32 v4, s33, v4
    ds_read_b128 v[224:227], v7 offset:28672
    ds_read_b128 v[228:231], v7 offset:29696
    ds_read_b128 v[232:235], v7 offset:30720
    ds_read_b128 v[236:239], v7 offset:31744
    ds_read_b128 v[240:243], v7 offset:32768
    ds_read_b128 v[244:247], v7 offset:33792
    s_waitcnt vmcnt(22)
    s_waitcnt lgkmcnt(5)
    v_mfma_f32_32x32x16_bf16 v[176:191], v[224:227], v[160:163], v[176:191]
    ds_read_b128 v[248:251], v7 offset:34816
    buffer_load_dwordx4 v[72:75], v3, s[12:15], s31 offen offset:2048 sc1
    s_waitcnt lgkmcnt(5)
    v_mfma_f32_32x32x16_bf16 v[192:207], v[228:231], v[160:163], v[192:207]
    ds_read_b128 v[252:255], v7 offset:35840
    s_waitcnt vmcnt(19)
    s_waitcnt lgkmcnt(5)
    v_mfma_f32_32x32x16_bf16 v[176:191], v[232:235], v[164:167], v[176:191]
    ds_read_b128 v[224:227], v6 offset:0
    buffer_load_dwordx4 v[76:79], v3, s[12:15], s31 offen offset:3072 sc1
    s_add_u32 s31, s31, 4096
    s_cmp_ge_u32 s31, s32
    s_cselect_b32 s34, 32768, 0
    s_sub_u32 s31, s31, s34
    s_waitcnt lgkmcnt(5)
    v_mfma_f32_32x32x16_bf16 v[192:207], v[236:239], v[164:167], v[192:207]
    ds_read_b128 v[228:231], v6 offset:1024
    s_waitcnt vmcnt(16)
    s_waitcnt lgkmcnt(5)
    v_mfma_f32_32x32x16_bf16 v[176:191], v[240:243], v[168:171], v[176:191]
    ds_read_b128 v[232:235], v6 offset:2048
    buffer_load_dwordx4 v[80:83], v3, s[12:15], s31 offen offset:0 sc1
    s_waitcnt lgkmcnt(5)
    v_mfma_f32_32x32x16_bf16 v[192:207], v[244:247], v[168:171], v[192:207]
    ds_read_b128 v[236:239], v6 offset:3072
    s_waitcnt vmcnt(13)
    s_waitcnt lgkmcnt(5)
    v_mfma_f32_32x32x16_bf16 v[176:191], v[248:251], v[172:175], v[176:191]
    ds_read_b128 v[240:243], v6 offset:4096
    buffer_load_dwordx4 v[84:87], v3, s[12:15], s31 offen offset:1024 sc1
    s_waitcnt lgkmcnt(5)
    v_mfma_f32_32x32x16_bf16 v[192:207], v[252:255], v[172:175], v[192:207]
    ds_read_b128 v[244:247], v6 offset:5120
    s_waitcnt vmcnt(13)
    s_waitcnt lgkmcnt(5)
    v_mfma_f32_32x32x16_bf16 v[176:191], v[224:227], v[32:35], v[176:191]
    ds_read_b128 v[248:251], v6 offset:6144
    buffer_load_dwordx4 v[88:91], v3, s[12:15], s31 offen offset:2048 sc1
    s_waitcnt lgkmcnt(5)
    v_mfma_f32_32x32x16_bf16 v[192:207], v[228:231], v[32:35], v[192:207]
    ds_read_b128 v[252:255], v6 offset:7168
    s_waitcnt vmcnt(13)
    s_waitcnt lgkmcnt(5)
    v_mfma_f32_32x32x16_bf16 v[176:191], v[232:235], v[36:39], v[176:191]
    ds_read_b128 v[224:227], v6 offset:8192
    buffer_load_dwordx4 v[92:95], v3, s[12:15], s31 offen offset:3072 sc1
    s_add_u32 s31, s31, 4096
    s_cmp_ge_u32 s31, s32
    s_cselect_b32 s34, 32768, 0
    s_sub_u32 s31, s31, s34
    s_waitcnt lgkmcnt(5)
    v_mfma_f32_32x32x16_bf16 v[192:207], v[236:239], v[36:39], v[192:207]
    ds_read_b128 v[228:231], v6 offset:9216
    s_waitcnt vmcnt(13)
    s_waitcnt lgkmcnt(5)
    v_mfma_f32_32x32x16_bf16 v[176:191], v[240:243], v[40:43], v[176:191]
    ds_read_b128 v[232:235], v6 offset:10240
    buffer_load_dwordx4 v[96:99], v3, s[12:15], s31 offen offset:0 sc1
    s_waitcnt lgkmcnt(5)
    v_mfma_f32_32x32x16_bf16 v[192:207], v[244:247], v[40:43], v[192:207]
    ds_read_b128 v[236:239], v6 offset:11264
    s_waitcnt vmcnt(13)
    s_waitcnt lgkmcnt(5)
    v_mfma_f32_32x32x16_bf16 v[176:191], v[248:251], v[44:47], v[176:191]
    ds_read_b128 v[240:243], v6 offset:12288
    buffer_load_dwordx4 v[100:103], v3, s[12:15], s31 offen offset:1024 sc1
    s_waitcnt lgkmcnt(5)
    v_mfma_f32_32x32x16_bf16 v[192:207], v[252:255], v[44:47], v[192:207]
    ds_read_b128 v[244:247], v6 offset:13312
    s_waitcnt vmcnt(13)
    s_waitcnt lgkmcnt(5)
    v_mfma_f32_32x32x16_bf16 v[176:191], v[224:227], v[48:51], v[176:191]
    ds_read_b128 v[248:251], v6 offset:14336
    buffer_load_dwordx4 v[104:107], v3, s[12:15], s31 offen offset:2048 sc1
    s_waitcnt lgkmcnt(5)
    v_mfma_f32_32x32x16_bf16 v[192:207], v[228:231], v[48:51], v[192:207]
    ds_read_b128 v[252:255], v6 offset:15360
    s_waitcnt vmcnt(13)
    s_waitcnt lgkmcnt(5)
    v_mfma_f32_32x32x16_bf16 v[176:191], v[232:235], v[52:55], v[176:191]
    ds_read_b128 v[224:227], v6 offset:16384
    buffer_load_dwordx4 v[108:111], v3, s[12:15], s31 offen offset:3072 sc1
    s_add_u32 s31, s31, 4096
    s_cmp_ge_u32 s31, s32
    s_cselect_b32 s34, 32768, 0
    s_sub_u32 s31, s31, s34
    s_waitcnt lgkmcnt(5)
    v_mfma_f32_32x32x16_bf16 v[192:207], v[236:239], v[52:55], v[192:207]
    ds_read_b128 v[228:231], v6 offset:17408
    s_waitcnt vmcnt(13)
    s_waitcnt lgkmcnt(5)
    v_mfma_f32_32x32x16_bf16 v[176:191], v[240:243], v[56:59], v[176:191]
    ds_read_b128 v[232:235], v6 offset:18432
    buffer_load_dwordx4 v[112:115], v3, s[12:15], s31 offen offset:0 sc1
    s_waitcnt lgkmcnt(5)
    v_mfma_f32_32x32x16_bf16 v[192:207], v[244:247], v[56:59], v[192:207]
    ds_read_b128 v[236:239], v6 offset:19456
    s_waitcnt vmcnt(13)
    s_waitcnt lgkmcnt(5)
    v_mfma_f32_32x32x16_bf16 v[176:191], v[248:251], v[60:63], v[176:191]
    ds_read_b128 v[240:243], v6 offset:20480
    buffer_load_dwordx4 v[116:119], v3, s[12:15], s31 offen offset:1024 sc1
    s_waitcnt lgkmcnt(5)
    v_mfma_f32_32x32x16_bf16 v[192:207], v[252:255], v[60:63], v[192:207]
    ds_read_b128 v[244:247], v6 offset:21504
    s_waitcnt vmcnt(13)
    s_waitcnt lgkmcnt(5)
    v_mfma_f32_32x32x16_bf16 v[176:191], v[224:227], v[64:67], v[176:191]
    ds_read_b128 v[248:251], v6 offset:22528
    buffer_load_dwordx4 v[120:123], v3, s[12:15], s31 offen offset:2048 sc1
    s_waitcnt lgkmcnt(5)
    v_mfma_f32_32x32x16_bf16 v[192:207], v[228:231], v[64:67], v[192:207]
    ds_read_b128 v[252:255], v6 offset:23552
    s_waitcnt vmcnt(13)
    s_waitcnt lgkmcnt(5)
    v_mfma_f32_32x32x16_bf16 v[176:191], v[232:235], v[68:71], v[176:191]
    ds_read_b128 v[224:227], v6 offset:24576
    buffer_load_dwordx4 v[124:127], v3, s[12:15], s31 offen offset:3072 sc1
    s_add_u32 s31, s31, 4096
    s_cmp_ge_u32 s31, s32
    s_cselect_b32 s34, 32768, 0
    s_sub_u32 s31, s31, s34
    s_waitcnt lgkmcnt(5)
    v_mfma_f32_32x32x16_bf16 v[192:207], v[236:239], v[68:71], v[192:207]
    ds_read_b128 v[228:231], v6 offset:25600
    s_waitcnt vmcnt(13)
    s_waitcnt lgkmcnt(5)
    v_mfma_f32_32x32x16_bf16 v[176:191], v[240:243], v[72:75], v[176:191]
    ds_read_b128 v[232:235], v6 offset:26624
    buffer_load_dwordx4 v[128:131], v3, s[12:15], s31 offen offset:0 sc1
    s_waitcnt lgkmcnt(5)
    v_mfma_f32_32x32x16_bf16 v[192:207], v[244:247], v[72:75], v[192:207]
    ds_read_b128 v[236:239], v6 offset:27648
    s_waitcnt vmcnt(13)
    s_waitcnt lgkmcnt(5)
    v_mfma_f32_32x32x16_bf16 v[176:191], v[248:251], v[76:79], v[176:191]
    ds_read_b128 v[240:243], v6 offset:28672
    buffer_load_dwordx4 v[132:135], v3, s[12:15], s31 offen offset:1024 sc1
    s_waitcnt lgkmcnt(5)
    v_mfma_f32_32x32x16_bf16 v[192:207], v[252:255], v[76:79], v[192:207]
    ds_read_b128 v[244:247], v6 offset:29696
    s_waitcnt vmcnt(13)
    s_waitcnt lgkmcnt(5)
    v_mfma_f32_32x32x16_bf16 v[176:191], v[224:227], v[80:83], v[176:191]
    ds_read_b128 v[248:251], v6 offset:30720
    buffer_load_dwordx4 v[136:139], v3, s[12:15], s31 offen offset:2048 sc1
    s_waitcnt lgkmcnt(5)
    v_mfma_f32_32x32x16_bf16 v[192:207], v[228:231], v[80:83], v[192:207]
    ds_read_b128 v[252:255], v6 offset:31744
    s_waitcnt vmcnt(13)
    s_waitcnt lgkmcnt(5)
    v_mfma_f32_32x32x16_bf16 v[176:191], v[232:235], v[84:87], v[176:191]
    ds_read_b128 v[224:227], v6 offset:32768
    buffer_load_dwordx4 v[140:143], v3, s[12:15], s31 offen offset:3072 sc1
    s_add_u32 s31, s31, 4096
    s_cmp_ge_u32 s31, s32
    s_cselect_b32 s34, 32768, 0
    s_sub_u32 s31, s31, s34
    s_waitcnt lgkmcnt(5)
    v_mfma_f32_32x32x16_bf16 v[192:207], v[236:239], v[84:87], v[192:207]
    ds_read_b128 v[228:231], v6 offset:33792
    s_waitcnt vmcnt(13)
    s_waitcnt lgkmcnt(5)
    v_mfma_f32_32x32x16_bf16 v[176:191], v[240:243], v[88:91], v[176:191]
    ds_read_b128 v[232:235], v6 offset:34816
    buffer_load_dwordx4 v[144:147], v3, s[12:15], s31 offen offset:0 sc1
    s_waitcnt lgkmcnt(5)
    v_mfma_f32_32x32x16_bf16 v[192:207], v[244:247], v[88:91], v[192:207]
    ds_read_b128 v[236:239], v6 offset:35840
    s_waitcnt vmcnt(13)
    s_waitcnt lgkmcnt(5)
    v_mfma_f32_32x32x16_bf16 v[176:191], v[248:251], v[92:95], v[176:191]
    ds_read_b128 v[240:243], v7 offset:0
    buffer_load_dwordx4 v[148:151], v3, s[12:15], s31 offen offset:1024 sc1
    s_waitcnt lgkmcnt(5)
    v_mfma_f32_32x32x16_bf16 v[192:207], v[252:255], v[92:95], v[192:207]
    ds_read_b128 v[244:247], v7 offset:1024
    s_waitcnt vmcnt(13)
    s_waitcnt lgkmcnt(5)
    v_mfma_f32_32x32x16_bf16 v[176:191], v[224:227], v[96:99], v[176:191]
    ds_read_b128 v[248:251], v7 offset:2048
    buffer_load_dwordx4 v[152:155], v3, s[12:15], s31 offen offset:2048 sc1
    s_waitcnt lgkmcnt(5)
    v_mfma_f32_32x32x16_bf16 v[192:207], v[228:231], v[96:99], v[192:207]
    ds_read_b128 v[252:255], v7 offset:3072
    s_waitcnt vmcnt(13)
    s_waitcnt lgkmcnt(5)
    v_mfma_f32_32x32x16_bf16 v[176:191], v[232:235], v[100:103], v[176:191]
    ds_read_b128 v[224:227], v7 offset:4096
    buffer_load_dwordx4 v[156:159], v3, s[12:15], s31 offen offset:3072 sc1
    s_add_u32 s31, s31, 4096
    s_cmp_ge_u32 s31, s32
    s_cselect_b32 s34, 32768, 0
    s_sub_u32 s31, s31, s34
    s_waitcnt lgkmcnt(5)
    v_mfma_f32_32x32x16_bf16 v[192:207], v[236:239], v[100:103], v[192:207]
    ds_read_b128 v[228:231], v7 offset:5120
    s_waitcnt vmcnt(13)
    s_waitcnt lgkmcnt(5)
    v_mfma_f32_32x32x16_bf16 v[176:191], v[240:243], v[104:107], v[176:191]
    ds_read_b128 v[232:235], v7 offset:6144
    s_waitcnt lgkmcnt(5)
    v_mfma_f32_32x32x16_bf16 v[192:207], v[244:247], v[104:107], v[192:207]
    ds_read_b128 v[236:239], v7 offset:7168
    s_waitcnt vmcnt(12)
    s_waitcnt lgkmcnt(5)
    v_mfma_f32_32x32x16_bf16 v[176:191], v[248:251], v[108:111], v[176:191]
    ds_read_b128 v[240:243], v7 offset:8192
    s_waitcnt lgkmcnt(5)
    v_mfma_f32_32x32x16_bf16 v[192:207], v[252:255], v[108:111], v[192:207]
    ds_read_b128 v[244:247], v7 offset:9216
    s_waitcnt vmcnt(11)
    s_waitcnt lgkmcnt(5)
    v_mfma_f32_32x32x16_bf16 v[176:191], v[224:227], v[112:115], v[176:191]
    ds_read_b128 v[248:251], v7 offset:10240
    s_waitcnt lgkmcnt(5)
    v_mfma_f32_32x32x16_bf16 v[192:207], v[228:231], v[112:115], v[192:207]
    ds_read_b128 v[252:255], v7 offset:11264
    s_waitcnt vmcnt(10)
    s_waitcnt lgkmcnt(5)
    v_mfma_f32_32x32x16_bf16 v[176:191], v[232:235], v[116:119], v[176:191]
    ds_read_b128 v[224:227], v7 offset:12288
    s_waitcnt lgkmcnt(5)
    v_mfma_f32_32x32x16_bf16 v[192:207], v[236:239], v[116:119], v[192:207]
    ds_read_b128 v[228:231], v7 offset:13312
    s_waitcnt vmcnt(9)
    s_waitcnt lgkmcnt(5)
    v_mfma_f32_32x32x16_bf16 v[176:191], v[240:243], v[120:123], v[176:191]
    ds_read_b128 v[232:235], v7 offset:14336
    s_waitcnt lgkmcnt(5)
    v_mfma_f32_32x32x16_bf16 v[192:207], v[244:247], v[120:123], v[192:207]
    ds_read_b128 v[236:239], v7 offset:15360
    s_waitcnt vmcnt(8)
    s_waitcnt lgkmcnt(5)
    v_mfma_f32_32x32x16_bf16 v[176:191], v[248:251], v[124:127], v[176:191]
    ds_read_b128 v[240:243], v7 offset:16384
    s_waitcnt lgkmcnt(5)
    v_mfma_f32_32x32x16_bf16 v[192:207], v[252:255], v[124:127], v[192:207]
    ds_read_b128 v[244:247], v7 offset:17408
    s_waitcnt vmcnt(7)
    s_waitcnt lgkmcnt(5)
    v_mfma_f32_32x32x16_bf16 v[176:191], v[224:227], v[128:131], v[176:191]
    ds_read_b128 v[248:251], v7 offset:18432
    s_waitcnt lgkmcnt(5)
    v_mfma_f32_32x32x16_bf16 v[192:207], v[228:231], v[128:131], v[192:207]
    ds_read_b128 v[252:255], v7 offset:19456
    s_waitcnt vmcnt(6)
    s_waitcnt lgkmcnt(5)
    v_mfma_f32_32x32x16_bf16 v[176:191], v[232:235], v[132:135], v[176:191]
    ds_read_b128 v[224:227], v7 offset:20480
    s_waitcnt lgkmcnt(5)
    v_mfma_f32_32x32x16_bf16 v[192:207], v[236:239], v[132:135], v[192:207]
    ds_read_b128 v[228:231], v7 offset:21504
    s_waitcnt vmcnt(5)
    s_waitcnt lgkmcnt(5)
    v_mfma_f32_32x32x16_bf16 v[176:191], v[240:243], v[136:139], v[176:191]
    ds_read_b128 v[232:235], v7 offset:22528
    s_waitcnt lgkmcnt(5)
    v_mfma_f32_32x32x16_bf16 v[192:207], v[244:247], v[136:139], v[192:207]
    ds_read_b128 v[236:239], v7 offset:23552
    s_waitcnt vmcnt(4)
    s_waitcnt lgkmcnt(5)
    v_mfma_f32_32x32x16_bf16 v[176:191], v[248:251], v[140:143], v[176:191]
    ds_read_b128 v[240:243], v7 offset:24576
    s_waitcnt lgkmcnt(5)
    v_mfma_f32_32x32x16_bf16 v[192:207], v[252:255], v[140:143], v[192:207]
    ds_read_b128 v[244:247], v7 offset:25600
    s_waitcnt vmcnt(3)
    s_waitcnt lgkmcnt(5)
    v_mfma_f32_32x32x16_bf16 v[176:191], v[224:227], v[144:147], v[176:191]
    ds_read_b128 v[248:251], v7 offset:26624
    s_waitcnt lgkmcnt(5)
    v_mfma_f32_32x32x16_bf16 v[192:207], v[228:231], v[144:147], v[192:207]
    ds_read_b128 v[252:255], v7 offset:27648
    s_waitcnt vmcnt(2)
    s_waitcnt lgkmcnt(5)
    v_mfma_f32_32x32x16_bf16 v[176:191], v[232:235], v[148:151], v[176:191]
    s_waitcnt lgkmcnt(4)
    v_mfma_f32_32x32x16_bf16 v[192:207], v[236:239], v[148:151], v[192:207]
    s_waitcnt vmcnt(1)
    s_waitcnt lgkmcnt(3)
    v_mfma_f32_32x32x16_bf16 v[176:191], v[240:243], v[152:155], v[176:191]
    s_waitcnt lgkmcnt(2)
    v_mfma_f32_32x32x16_bf16 v[192:207], v[244:247], v[152:155], v[192:207]
    s_waitcnt vmcnt(0)
    s_waitcnt lgkmcnt(1)
    v_mfma_f32_32x32x16_bf16 v[176:191], v[248:251], v[156:159], v[176:191]
    s_waitcnt lgkmcnt(0)
    v_mfma_f32_32x32x16_bf16 v[192:207], v[252:255], v[156:159], v[192:207]
    s_mov_b32 s38, 0x3f803f80
    s_mov_b32 s39, 0x00003f80
    s_mov_b32 s40, 0x3f800000
    s_lshl_b32 s36, s26, 12
    s_add_u32 s36, s36, s30
    s_add_u32 s36, s36, 9699328
    v_mov_b32 v10, 0
    v_mov_b32 v11, 0
    s_nop 1
    v_cvt_pk_bf16_f32 v32, v176, v180
    v_cvt_pk_bf16_f32 v33, v184, v188
    v_cvt_pk_bf16_f32 v34, v192, v196
    v_cvt_pk_bf16_f32 v35, v200, v204
    buffer_store_dwordx4 v[32:35], v3, s[12:15], s36 offen offset:0 sc1
    v_cvt_pk_bf16_f32 v36, v177, v181
    v_cvt_pk_bf16_f32 v37, v185, v189
    v_cvt_pk_bf16_f32 v38, v193, v197
    v_cvt_pk_bf16_f32 v39, v201, v205
    buffer_store_dwordx4 v[36:39], v3, s[12:15], s36 offen offset:1024 sc1
    v_cvt_pk_bf16_f32 v40, v178, v182
    v_cvt_pk_bf16_f32 v41, v186, v190
    v_cvt_pk_bf16_f32 v42, v194, v198
    v_cvt_pk_bf16_f32 v43, v202, v206
    buffer_store_dwordx4 v[40:43], v3, s[12:15], s36 offen offset:2048 sc1
    v_cvt_pk_bf16_f32 v44, v179, v183
    v_cvt_pk_bf16_f32 v45, v187, v191
    v_cvt_pk_bf16_f32 v46, v195, v199
    v_cvt_pk_bf16_f32 v47, v203, v207
    buffer_store_dwordx4 v[44:47], v3, s[12:15], s36 offen offset:3072 sc1
    v_dot2c_f32_bf16 v10, s38, v32
    v_dot2c_f32_bf16 v11, v32, v32
    v_dot2c_f32_bf16 v10, s38, v33
    v_dot2c_f32_bf16 v11, v33, v33
    v_dot2c_f32_bf16 v10, s38, v34
    v_dot2c_f32_bf16 v11, v34, v34
    v_dot2c_f32_bf16 v10, s38, v35
    v_dot2c_f32_bf16 v11, v35, v35
    v_dot2c_f32_bf16 v10, s38, v36
    v_dot2c_f32_bf16 v11, v36, v36
    v_dot2c_f32_bf16 v10, s38, v37
    v_dot2c_f32_bf16 v11, v37, v37
    v_dot2c_f32_bf16 v10, s38, v38
    v_dot2c_f32_bf16 v11, v38, v38
    v_dot2c_f32_bf16 v10, s38, v39
    v_dot2c_f32_bf16 v11, v39, v39
    v_dot2c_f32_bf16 v10, s38, v40
    v_dot2c_f32_bf16 v11, v40, v40
    v_dot2c_f32_bf16 v10, s38, v41
    v_dot2c_f32_bf16 v11, v41, v41
    v_dot2c_f32_bf16 v10, s38, v42
    v_dot2c_f32_bf16 v11, v42, v42
    v_dot2c_f32_bf16 v10, s38, v43
    v_dot2c_f32_bf16 v11, v43, v43
    v_dot2c_f32_bf16 v10, s38, v44
    v_dot2c_f32_bf16 v11, v44, v44
    v_dot2c_f32_bf16 v10, s38, v45
    v_dot2c_f32_bf16 v11, v45, v45
    v_dot2c_f32_bf16 v10, s38, v46
    v_dot2c_f32_bf16 v11, v46, v46
    v_dot2c_f32_bf16 v10, s38, v47
    v_dot2c_f32_bf16 v11, v47, v47
    s_lshl_b32 s36, s26, 14
    s_lshl_b32 s37, s29, 8
    s_add_u32 s36, s36, s37
    s_add_u32 s36, s36, 12058624
    s_mul_i32 s37, s29, 9
    s_add_u32 s37, s37, s26
    s_lshl_b32 s37, s37, 7
    s_add_u32 s37, s37, 68255744
    s_cmp_ge_u32 s29, 64
    s_cselect_b32 s36, 2146435072, s36
    s_cselect_b32 s37, 2146435072, s37
    v_permlane32_swap_b32 v10, v11
    v_lshlrev_b32 v4, 2, v2
    v_mov_b32 v14, 0
    v_add_f32 v10, v10, v11
    v_mov_b32 v15, 1
    buffer_store_dword v10, v4, s[12:15], s36 offen sc1
    s_waitcnt vmcnt(0)
    s_lshl_b32 s37, s25, 7
    s_add_u32 s37, s37, 68255744
    s_cmp_eq_u32 s24, 0
    s_cselect_b32 s37, s37, 2146435072
    s_barrier
    s_mov_b64 exec, 1
    buffer_store_dword v15, v14, s[12:15], s37 offen sc1
    s_mov_b64 exec, -1
    s_branch fused_kernel_f_ajoin
fused_kernel_f_aload:
    s_cmp_eq_u32 s24, 3
    s_cbranch_scc1 fused_kernel_f_ax
    s_mul_i32 s32, s26, 73728
    s_lshl_b32 s33, s24, 10
    s_add_u32 s32, s32, s33
    s_add_u32 s32, s32, 12578816
    s_add_u32 s33, s33, 61440
    s_add_u32 s36, s32, 65536
    s_and_b32 s34, s26, 0
    s_lshl_b32 s34, s34, 13
    s_add_u32 s32, s32, s34
    s_waitcnt vmcnt(0)
    s_barrier
    s_barrier
    s_branch fused_kernel_f_apost
fused_kernel_f_ax:
    s_mul_i32 s30, s27, 96
    v_lshrrev_b32 v4, 3, v2
    v_add_u32 v4, s30, v4
    v_mul_u32_u24 v4, 1152, v4
    v_lshrrev_b32 v5, 4, v2
    v_and_b32 v6, 7, v2
    v_xor_b32 v5, v5, v6
    v_lshl_add_u32 v4, v5, 4, v4
    v_xor_b32 v5, 64, v4
    s_lshl_b32 s35, s26, 7
    s_waitcnt vmcnt(0)
    s_barrier
fused_kernel_f_ae:
    s_lshl_b32 s33, s2, 7
    s_add_u32 s33, s33, 68222976
    v_mov_b32 v14, 0
    s_mov_b32 s57, 0
fused_kernel_f_xp:
    buffer_load_dword v15, v14, s[12:15], s33 offen sc1
    s_add_u32 s57, s57, 1
    s_waitcnt vmcnt(0)
    v_cmp_ne_u32 vcc, 1, v15
    s_cmp_gt_u32 s57, 0x40000
    s_cbranch_scc1 fused_kernel_f_xq
    s_cbranch_vccz fused_kernel_f_xq
    s_sleep 8
    s_branch fused_kernel_f_xp
fused_kernel_f_xq:
    s_barrier
fused_kernel_f_apost:
    s_cmp_lt_u32 s24, 3
    s_cbranch_scc1 fused_kernel_f_ajoin
    s_and_b32 s36, s44, 1
    s_cmp_eq_u32 s24, 3
    s_cbranch_scc1 fused_kernel_f_ac
    s_sub_u32 s33, s24, 4
    s_add_u32 s34, s33, s36
    s_mul_i32 s34, s34, 36864
    s_lshl_b32 s33, s33, 12
    s_add_u32 m0, s33, 0
    s_add_u32 s35, s34, 0
    buffer_load_dwordx4 v3, s[16:19], s35 offen sc1 lds
    s_add_u32 m0, s33, 1024
    s_add_u32 s35, s34, 1024
    buffer_load_dwordx4 v3, s[16:19], s35 offen sc1 lds
    s_add_u32 m0, s33, 2048
    s_add_u32 s35, s34, 18432
    buffer_load_dwordx4 v3, s[16:19], s35 offen sc1 lds
    s_add_u32 m0, s33, 3072
    s_add_u32 s35, s34, 19456
    buffer_load_dwordx4 v3, s[16:19], s35 offen sc1 lds
    s_add_u32 m0, s33, 16384
    s_add_u32 s35, s34, 2048
    buffer_load_dwordx4 v3, s[16:19], s35 offen sc1 lds
    s_add_u32 m0, s33, 17408
    s_add_u32 s35, s34, 3072
    buffer_load_dwordx4 v3, s[16:19], s35 offen sc1 lds
    s_add_u32 m0, s33, 18432
    s_add_u32 s35, s34, 20480
    buffer_load_dwordx4 v3, s[16:19], s35 offen sc1 lds
    s_add_u32 m0, s33, 19456
    s_add_u32 s35, s34, 21504
    buffer_load_dwordx4 v3, s[16:19], s35 offen sc1 lds
    s_add_u32 m0, s33, 32768
    s_add_u32 s35, s34, 4096
    buffer_load_dwordx4 v3, s[16:19], s35 offen sc1 lds
    s_add_u32 m0, s33, 33792
    s_add_u32 s35, s34, 5120
    buffer_load_dwordx4 v3, s[16:19], s35 offen sc1 lds
    s_add_u32 m0, s33, 34816
    s_add_u32 s35, s34, 22528
    buffer_load_dwordx4 v3, s[16:19], s35 offen sc1 lds
    s_add_u32 m0, s33, 35840
    s_add_u32 s35, s34, 23552
    buffer_load_dwordx4 v3, s[16:19], s35 offen sc1 lds
    s_add_u32 m0, s33, 49152
    s_add_u32 s35, s34, 6144
    buffer_load_dwordx4 v3, s[16:19], s35 offen sc1 lds
    s_add_u32 m0, s33, 50176
    s_add_u32 s35, s34, 7168
    buffer_load_dwordx4 v3, s[16:19], s35 offen sc1 lds
    s_add_u32 m0, s33, 51200
    s_add_u32 s35, s34, 24576
    buffer_load_dwordx4 v3, s[16:19], s35 offen sc1 lds
    s_add_u32 m0, s33, 52224
    s_add_u32 s35, s34, 25600
    buffer_load_dwordx4 v3, s[16:19], s35 offen sc1 lds
    s_branch fused_kernel_f_ad
fused_kernel_f_ac:
    s_mul_i32 s35, s44, 9
    s_add_u32 s34, s35, s36
    s_lshl_b32 s34, s34, 7
    s_add_u32 s34, s34, 67108864
    s_mov_b32 m0, 159744
    s_xor_b32 s36, s36, 1
    buffer_load_dwordx4 v3, s[12:15], s34 offen sc1 lds
    s_lshl_b32 s36, s36, 3
    s_add_u32 s34, s35, s36
    s_lshl_b32 s34, s34, 7
    s_add_u32 s34, s34, 67108864
    s_mov_b32 m0, 160768
    s_nop 0
    buffer_load_dwordx4 v3, s[12:15], s34 offen sc1 lds
fused_kernel_f_ad:
    s_waitcnt vmcnt(0) lgkmcnt(0)
fused_kernel_f_ajoin:
    s_lshl_b32 s26, s45, 3
    s_add_u32 s26, s26, s24
    s_mul_i32 s31, s26, 36864
    s_add_u32 s31, s31, 9699328
    s_and_b32 s39, s44, 1
    s_lshl_b32 s32, s24, 10
    s_lshr_b32 s37, s24, 2
    s_add_u32 s37, s37, s39
    s_mul_i32 s37, s37, 36
    s_bfe_u32 s38, s24, 0x10001
    s_mul_i32 s38, s38, 18
    s_add_u32 s37, s37, s38
    s_and_b32 s38, s24, 1
    s_add_u32 s37, s37, s38
    s_lshl_b32 s37, s37, 10
    s_mul_i32 s38, s39, 36864
    s_add_u32 s38, s38, s32
    s_mul_i32 s41, s39, 294912
    s_sub_u32 s41, s32, s41
    v_mov_b32 v4, v3
    v_add_u32 v5, 65536, v3
    v_add_u32 v6, 131072, v3
    v_lshrrev_b32 v96, 4, v2
    v_and_b32 v97, 15, v2
    v_lshlrev_b32 v7, 9, v96
    v_lshl_add_u32 v7, v97, 4, v7
    v_lshlrev_b32 v0, 4, v96
    v_add_u32 v0, 159744, v0
    s_mul_i32 s35, s26, 294912
    s_mul_i32 s36, s44, 9
    s_lshr_b32 s27, s36, 1
    s_add_u32 s36, s36, 1
    s_lshr_b32 s36, s36, 1
    s_lshl_b32 s36, s36, 10
    s_add_u32 s35, s35, 31457280
    s_xor_b32 s28, s39, 1
    s_lshl_b32 s28, s28, 2
    s_add_u32 s27, s27, s28
    s_lshl_b32 s27, s27, 10
    s_lshl_b32 s28, s39, 9
    s_add_u32 s27, s27, s28
    s_add_u32 s27, s27, s35
    s_add_u32 s35, s35, s36
    s_add_u32 s36, s35, 147456
    v_lshlrev_b32 v1, 2, v2
    s_lshl_b32 s40, s26, 8
    s_add_u32 s40, s40, 12058624
    s_cmp_lg_u32 s24, 0
    s_cbranch_scc1 fused_kernel_f_b0
    s_mul_i32 s34, s45, 9216
    s_add_u32 s34, s34, 68255744
    v_lshlrev_b32 v14, 7, v2
    v_and_b32 v12, 7, v2
    v_lshlrev_b32 v12, 7, v12
    v_add_u32 v12, 8192, v12
    s_lshl_b32 s33, s45, 3
    s_mul_i32 s34, s33, 21846
    s_lshr_b32 s34, s34, 16
    s_add_u32 s33, s33, 7
    s_mul_i32 s33, s33, 21846
    s_lshr_b32 s33, s33, 16
    s_sub_u32 s33, s33, s34
    s_mul_i32 s33, s33, 9
    s_add_u32 s33, s33, 8
    v_min_u32 v14, s33, v2
    v_lshlrev_b32 v14, 7, v14
    s_mul_i32 s34, s34, 1152
    s_add_u32 s34, s34, 68255744
    s_mov_b32 s57, 0
fused_kernel_f_ap:
    buffer_load_dword v15, v14, s[12:15], s34 offen sc1
    s_add_u32 s57, s57, 1
    s_waitcnt vmcnt(0)
    v_cmp_ne_u32 vcc, 1, v15
    s_cmp_gt_u32 s57, 0x40000
    s_cbranch_scc1 fused_kernel_f_aq
    s_cbranch_vccz fused_kernel_f_aq
    s_sleep 2
    s_branch fused_kernel_f_ap
fused_kernel_f_aq:
fused_kernel_f_b0:
    s_barrier
    buffer_load_dwordx4 v[112:115], v7, s[12:15], s31 offen offset:0 sc1
    buffer_load_dwordx4 v[116:119], v7, s[12:15], s31 offen offset:256 sc1
    buffer_load_dwordx4 v[120:123], v7, s[12:15], s31 offen offset:2048 sc1
    buffer_load_dwordx4 v[124:127], v7, s[12:15], s31 offen offset:2304 sc1
    s_add_u32 s31, s31, 4096
    ds_read_b128 v[12:15], v4 offset:0
    ds_read_b128 v[16:19], v4 offset:1024
    ds_read_b128 v[20:23], v4 offset:2048
    ds_read_b128 v[24:27], v4 offset:3072
    ds_read_b128 v[28:31], v4 offset:4096
    s_waitcnt vmcnt(0)
    s_waitcnt lgkmcnt(3)
    v_mfma_f32_16x16x32_bf16 v[32:35], v[12:15], v[112:115], 0
    s_setprio 1
    v_mfma_f32_16x16x32_bf16 v[32:35], v[16:19], v[120:123], v[32:35]
    v_mfma_f32_16x16x32_bf16 v[36:39], v[12:15], v[116:119], 0
    v_mfma_f32_16x16x32_bf16 v[36:39], v[16:19], v[124:127], v[36:39]
    s_setprio 0
    ds_read_b128 v[12:15], v4 offset:5120
    ds_read_b128 v[16:19], v4 offset:6144
    buffer_load_dwordx4 v[128:131], v7, s[12:15], s31 offen offset:0 sc1
    s_waitcnt lgkmcnt(3)
    v_mfma_f32_16x16x32_bf16 v[40:43], v[20:23], v[112:115], 0
    s_setprio 1
    v_mfma_f32_16x16x32_bf16 v[40:43], v[24:27], v[120:123], v[40:43]
    v_mfma_f32_16x16x32_bf16 v[44:47], v[20:23], v[116:119], 0
    v_mfma_f32_16x16x32_bf16 v[44:47], v[24:27], v[124:127], v[44:47]
    s_setprio 0
    ds_read_b128 v[20:23], v4 offset:7168
    ds_read_b128 v[24:27], v4 offset:8192
    buffer_load_dwordx4 v[132:135], v7, s[12:15], s31 offen offset:256 sc1
    s_waitcnt lgkmcnt(3)
    v_mfma_f32_16x16x32_bf16 v[48:51], v[28:31], v[112:115], 0
    s_setprio 1
    v_mfma_f32_16x16x32_bf16 v[48:51], v[12:15], v[120:123], v[48:51]
    v_mfma_f32_16x16x32_bf16 v[52:55], v[28:31], v[116:119], 0
    v_mfma_f32_16x16x32_bf16 v[52:55], v[12:15], v[124:127], v[52:55]
    s_setprio 0
    ds_read_b128 v[28:31], v4 offset:9216
    ds_read_b128 v[12:15], v4 offset:10240
    buffer_load_dwordx4 v[136:139], v7, s[12:15], s31 offen offset:2048 sc1
    s_waitcnt lgkmcnt(3)
    v_mfma_f32_16x16x32_bf16 v[56:59], v[16:19], v[112:115], 0
    s_setprio 1
    v_mfma_f32_16x16x32_bf16 v[56:59], v[20:23], v[120:123], v[56:59]
    v_mfma_f32_16x16x32_bf16 v[60:63], v[16:19], v[116:119], 0
    v_mfma_f32_16x16x32_bf16 v[60:63], v[20:23], v[124:127], v[60:63]
    s_setprio 0
    ds_read_b128 v[16:19], v4 offset:11264
    ds_read_b128 v[20:23], v4 offset:12288
    buffer_load_dwordx4 v[140:143], v7, s[12:15], s31 offen offset:2304 sc1
    s_add_u32 s31, s31, 4096
    s_waitcnt lgkmcnt(3)
    v_mfma_f32_16x16x32_bf16 v[64:67], v[24:27], v[112:115], 0
    s_setprio 1
    v_mfma_f32_16x16x32_bf16 v[64:67], v[28:31], v[120:123], v[64:67]
    v_mfma_f32_16x16x32_bf16 v[68:71], v[24:27], v[116:119], 0
    v_mfma_f32_16x16x32_bf16 v[68:71], v[28:31], v[124:127], v[68:71]
    s_setprio 0
    ds_read_b128 v[24:27], v4 offset:13312
    ds_read_b128 v[28:31], v4 offset:14336
    buffer_load_dwordx4 v[144:147], v7, s[12:15], s31 offen offset:0 sc1
    s_waitcnt lgkmcnt(3)
    v_mfma_f32_16x16x32_bf16 v[72:75], v[12:15], v[112:115], 0
    s_setprio 1
    v_mfma_f32_16x16x32_bf16 v[72:75], v[16:19], v[120:123], v[72:75]
    v_mfma_f32_16x16x32_bf16 v[76:79], v[12:15], v[116:119], 0
    v_mfma_f32_16x16x32_bf16 v[76:79], v[16:19], v[124:127], v[76:79]
    s_setprio 0
    ds_read_b128 v[12:15], v4 offset:15360
    ds_read_b128 v[16:19], v4 offset:16384
    buffer_load_dwordx4 v[148:151], v7, s[12:15], s31 offen offset:256 sc1
    s_add_u32 s34, s37, 8192
    s_add_u32 m0, s32, 65536
    s_nop 0
    buffer_load_dwordx4 v3, s[16:19], s34 offen sc1 lds
    s_waitcnt lgkmcnt(3)
    v_mfma_f32_16x16x32_bf16 v[80:83], v[20:23], v[112:115], 0
    s_setprio 1
    v_mfma_f32_16x16x32_bf16 v[80:83], v[24:27], v[120:123], v[80:83]
    v_mfma_f32_16x16x32_bf16 v[84:87], v[20:23], v[116:119], 0
    v_mfma_f32_16x16x32_bf16 v[84:87], v[24:27], v[124:127], v[84:87]
    s_setprio 0
    ds_read_b128 v[20:23], v4 offset:17408
    ds_read_b128 v[24:27], v4 offset:18432
    buffer_load_dwordx4 v[152:155], v7, s[12:15], s31 offen offset:2048 sc1
    s_waitcnt lgkmcnt(3)
    v_mfma_f32_16x16x32_bf16 v[88:91], v[28:31], v[112:115], 0
    s_setprio 1
    v_mfma_f32_16x16x32_bf16 v[88:91], v[12:15], v[120:123], v[88:91]
    v_mfma_f32_16x16x32_bf16 v[92:95], v[28:31], v[116:119], 0
    v_mfma_f32_16x16x32_bf16 v[92:95], v[12:15], v[124:127], v[92:95]
    s_setprio 0
    ds_read_b128 v[28:31], v4 offset:19456
    ds_read_b128 v[12:15], v4 offset:20480
    s_add_u32 s34, s37, 81920
    s_add_u32 m0, s32, 73728
    s_nop 0
    buffer_load_dwordx4 v3, s[16:19], s34 offen sc1 lds
    s_waitcnt vmcnt(5)
    s_waitcnt lgkmcnt(3)
    v_mfma_f32_16x16x32_bf16 v[32:35], v[16:19], v[128:131], v[32:35]
    s_setprio 1
    v_mfma_f32_16x16x32_bf16 v[32:35], v[20:23], v[136:139], v[32:35]
    v_mfma_f32_16x16x32_bf16 v[36:39], v[16:19], v[132:135], v[36:39]
    v_mfma_f32_16x16x32_bf16 v[36:39], v[20:23], v[140:143], v[36:39]
    s_setprio 0
    ds_read_b128 v[16:19], v4 offset:21504
    ds_read_b128 v[20:23], v4 offset:22528
    buffer_load_dwordx4 v[156:159], v7, s[12:15], s31 offen offset:2304 sc1
    s_add_u32 s31, s31, 4096
    s_waitcnt lgkmcnt(3)
    v_mfma_f32_16x16x32_bf16 v[40:43], v[24:27], v[128:131], v[40:43]
    s_setprio 1
    v_mfma_f32_16x16x32_bf16 v[40:43], v[28:31], v[136:139], v[40:43]
    v_mfma_f32_16x16x32_bf16 v[44:47], v[24:27], v[132:135], v[44:47]
    v_mfma_f32_16x16x32_bf16 v[44:47], v[28:31], v[140:143], v[44:47]
    s_setprio 0
    ds_read_b128 v[24:27], v4 offset:23552
    ds_read_b128 v[28:31], v4 offset:24576
    buffer_load_dwordx4 v[160:163], v7, s[12:15], s31 offen offset:0 sc1
    s_waitcnt lgkmcnt(3)
    v_mfma_f32_16x16x32_bf16 v[48:51], v[12:15], v[128:131], v[48:51]
    s_setprio 1
    v_mfma_f32_16x16x32_bf16 v[48:51], v[16:19], v[136:139], v[48:51]
    v_mfma_f32_16x16x32_bf16 v[52:55], v[12:15], v[132:135], v[52:55]
    v_mfma_f32_16x16x32_bf16 v[52:55], v[16:19], v[140:143], v[52:55]
    s_setprio 0
    ds_read_b128 v[12:15], v4 offset:25600
    ds_read_b128 v[16:19], v4 offset:26624
    buffer_load_dwordx4 v[164:167], v7, s[12:15], s31 offen offset:256 sc1
    s_waitcnt lgkmcnt(3)
    v_mfma_f32_16x16x32_bf16 v[56:59], v[20:23], v[128:131], v[56:59]
    s_setprio 1
    v_mfma_f32_16x16x32_bf16 v[56:59], v[24:27], v[136:139], v[56:59]
    v_mfma_f32_16x16x32_bf16 v[60:63], v[20:23], v[132:135], v[60:63]
    v_mfma_f32_16x16x32_bf16 v[60:63], v[24:27], v[140:143], v[60:63]
    s_setprio 0
    ds_read_b128 v[20:23], v4 offset:27648
    ds_read_b128 v[24:27], v4 offset:28672
    s_waitcnt lgkmcnt(3)
    v_mfma_f32_16x16x32_bf16 v[64:67], v[28:31], v[128:131], v[64:67]
    s_setprio 1
    v_mfma_f32_16x16x32_bf16 v[64:67], v[12:15], v[136:139], v[64:67]
    v_mfma_f32_16x16x32_bf16 v[68:71], v[28:31], v[132:135], v[68:71]
    v_mfma_f32_16x16x32_bf16 v[68:71], v[12:15], v[140:143], v[68:71]
    s_setprio 0
    ds_read_b128 v[28:31], v4 offset:29696
    ds_read_b128 v[12:15], v4 offset:30720
    buffer_load_dwordx4 v[168:171], v7, s[12:15], s31 offen offset:2048 sc1
    s_waitcnt lgkmcnt(3)
    v_mfma_f32_16x16x32_bf16 v[72:75], v[16:19], v[128:131], v[72:75]
    s_setprio 1
    v_mfma_f32_16x16x32_bf16 v[72:75], v[20:23], v[136:139], v[72:75]
    v_mfma_f32_16x16x32_bf16 v[76:79], v[16:19], v[132:135], v[76:79]
    v_mfma_f32_16x16x32_bf16 v[76:79], v[20:23], v[140:143], v[76:79]
    s_setprio 0
    ds_read_b128 v[16:19], v4 offset:31744
    ds_read_b128 v[20:23], v4 offset:32768
    s_add_u32 s34, s37, 10240
    s_add_u32 m0, s32, 81920
    s_nop 0
    buffer_load_dwordx4 v3, s[16:19], s34 offen sc1 lds
    s_waitcnt lgkmcnt(3)
    v_mfma_f32_16x16x32_bf16 v[80:83], v[24:27], v[128:131], v[80:83]
    s_setprio 1
    v_mfma_f32_16x16x32_bf16 v[80:83], v[28:31], v[136:139], v[80:83]
    v_mfma_f32_16x16x32_bf16 v[84:87], v[24:27], v[132:135], v[84:87]
    v_mfma_f32_16x16x32_bf16 v[84:87], v[28:31], v[140:143], v[84:87]
    s_setprio 0
    ds_read_b128 v[24:27], v4 offset:33792
    ds_read_b128 v[28:31], v4 offset:34816
    buffer_load_dwordx4 v[172:175], v7, s[12:15], s31 offen offset:2304 sc1
    s_add_u32 s31, s31, 4096
    s_waitcnt lgkmcnt(3)
    v_mfma_f32_16x16x32_bf16 v[88:91], v[12:15], v[128:131], v[88:91]
    s_setprio 1
    v_mfma_f32_16x16x32_bf16 v[88:91], v[16:19], v[136:139], v[88:91]
    v_mfma_f32_16x16x32_bf16 v[92:95], v[12:15], v[132:135], v[92:95]
    v_mfma_f32_16x16x32_bf16 v[92:95], v[16:19], v[140:143], v[92:95]
    s_setprio 0
    ds_read_b128 v[12:15], v4 offset:35840
    ds_read_b128 v[16:19], v4 offset:36864
    s_add_u32 s34, s37, 83968
    s_add_u32 m0, s32, 90112
    s_nop 0
    buffer_load_dwordx4 v3, s[16:19], s34 offen sc1 lds
    s_waitcnt vmcnt(6)
    s_waitcnt lgkmcnt(3)
    v_mfma_f32_16x16x32_bf16 v[32:35], v[20:23], v[144:147], v[32:35]
    s_setprio 1
    v_mfma_f32_16x16x32_bf16 v[32:35], v[24:27], v[152:155], v[32:35]
    v_mfma_f32_16x16x32_bf16 v[36:39], v[20:23], v[148:151], v[36:39]
    v_mfma_f32_16x16x32_bf16 v[36:39], v[24:27], v[156:159], v[36:39]
    s_setprio 0
    ds_read_b128 v[20:23], v4 offset:37888
    ds_read_b128 v[24:27], v4 offset:38912
    buffer_load_dword v96, v1, s[12:15], s40 offen sc1
    s_add_u32 s40, s40, 16384
    buffer_load_dwordx4 v[176:179], v7, s[12:15], s31 offen offset:0 sc1
    s_waitcnt lgkmcnt(3)
    v_mfma_f32_16x16x32_bf16 v[40:43], v[28:31], v[144:147], v[40:43]
    s_setprio 1
    v_mfma_f32_16x16x32_bf16 v[40:43], v[12:15], v[152:155], v[40:43]
    v_mfma_f32_16x16x32_bf16 v[44:47], v[28:31], v[148:151], v[44:47]
    v_mfma_f32_16x16x32_bf16 v[44:47], v[12:15], v[156:159], v[44:47]
    s_setprio 0
    ds_read_b128 v[28:31], v4 offset:39936
    ds_read_b128 v[12:15], v4 offset:40960
    buffer_load_dwordx4 v[180:183], v7, s[12:15], s31 offen offset:256 sc1
    s_waitcnt lgkmcnt(3)
    v_mfma_f32_16x16x32_bf16 v[48:51], v[16:19], v[144:147], v[48:51]
    s_setprio 1
    v_mfma_f32_16x16x32_bf16 v[48:51], v[20:23], v[152:155], v[48:51]
    v_mfma_f32_16x16x32_bf16 v[52:55], v[16:19], v[148:151], v[52:55]
    v_mfma_f32_16x16x32_bf16 v[52:55], v[20:23], v[156:159], v[52:55]
    s_setprio 0
    ds_read_b128 v[16:19], v4 offset:41984
    ds_read_b128 v[20:23], v4 offset:43008
    buffer_load_dword v97, v1, s[12:15], s40 offen sc1
    s_add_u32 s40, s40, 16384
    buffer_load_dwordx4 v[184:187], v7, s[12:15], s31 offen offset:2048 sc1
    s_waitcnt lgkmcnt(3)
    v_mfma_f32_16x16x32_bf16 v[56:59], v[24:27], v[144:147], v[56:59]
    s_setprio 1
    v_mfma_f32_16x16x32_bf16 v[56:59], v[28:31], v[152:155], v[56:59]
    v_mfma_f32_16x16x32_bf16 v[60:63], v[24:27], v[148:151], v[60:63]
    v_mfma_f32_16x16x32_bf16 v[60:63], v[28:31], v[156:159], v[60:63]
    s_setprio 0
    ds_read_b128 v[24:27], v4 offset:44032
    ds_read_b128 v[28:31], v4 offset:45056
    s_waitcnt lgkmcnt(3)
    v_mfma_f32_16x16x32_bf16 v[64:67], v[12:15], v[144:147], v[64:67]
    s_setprio 1
    v_mfma_f32_16x16x32_bf16 v[64:67], v[16:19], v[152:155], v[64:67]
    v_mfma_f32_16x16x32_bf16 v[68:71], v[12:15], v[148:151], v[68:71]
    v_mfma_f32_16x16x32_bf16 v[68:71], v[16:19], v[156:159], v[68:71]
    s_setprio 0
    ds_read_b128 v[12:15], v4 offset:46080
    ds_read_b128 v[16:19], v4 offset:47104
    buffer_load_dword v98, v1, s[12:15], s40 offen sc1
    s_add_u32 s40, s40, 16384
    buffer_load_dwordx4 v[188:191], v7, s[12:15], s31 offen offset:2304 sc1
    s_add_u32 s31, s31, 4096
    s_waitcnt lgkmcnt(3)
    v_mfma_f32_16x16x32_bf16 v[72:75], v[20:23], v[144:147], v[72:75]
    s_setprio 1
    v_mfma_f32_16x16x32_bf16 v[72:75], v[24:27], v[152:155], v[72:75]
    v_mfma_f32_16x16x32_bf16 v[76:79], v[20:23], v[148:151], v[76:79]
    v_mfma_f32_16x16x32_bf16 v[76:79], v[24:27], v[156:159], v[76:79]
    s_setprio 0
    ds_read_b128 v[20:23], v4 offset:48128
    ds_read_b128 v[24:27], v4 offset:49152
    s_add_u32 s34, s37, 12288
    s_add_u32 m0, s32, 98304
    s_nop 0
    buffer_load_dwordx4 v3, s[16:19], s34 offen sc1 lds
    s_waitcnt lgkmcnt(3)
    v_mfma_f32_16x16x32_bf16 v[80:83], v[28:31], v[144:147], v[80:83]
    s_setprio 1
    v_mfma_f32_16x16x32_bf16 v[80:83], v[12:15], v[152:155], v[80:83]
    v_mfma_f32_16x16x32_bf16 v[84:87], v[28:31], v[148:151], v[84:87]
    v_mfma_f32_16x16x32_bf16 v[84:87], v[12:15], v[156:159], v[84:87]
    s_setprio 0
    ds_read_b128 v[28:31], v4 offset:50176
    ds_read_b128 v[12:15], v4 offset:51200
    buffer_load_dword v99, v1, s[12:15], s40 offen sc1
    s_add_u32 s40, s40, 16384
    buffer_load_dwordx4 v[192:195], v7, s[12:15], s31 offen offset:0 sc1
    s_waitcnt lgkmcnt(3)
    v_mfma_f32_16x16x32_bf16 v[88:91], v[16:19], v[144:147], v[88:91]
    s_setprio 1
    v_mfma_f32_16x16x32_bf16 v[88:91], v[20:23], v[152:155], v[88:91]
    v_mfma_f32_16x16x32_bf16 v[92:95], v[16:19], v[148:151], v[92:95]
    v_mfma_f32_16x16x32_bf16 v[92:95], v[20:23], v[156:159], v[92:95]
    s_setprio 0
    ds_read_b128 v[16:19], v4 offset:52224
    ds_read_b128 v[20:23], v4 offset:53248
    s_add_u32 s34, s37, 86016
    s_add_u32 m0, s32, 106496
    s_nop 0
    buffer_load_dwordx4 v3, s[16:19], s34 offen sc1 lds
    s_waitcnt vmcnt(12)
    s_waitcnt lgkmcnt(3)
    v_mfma_f32_16x16x32_bf16 v[32:35], v[24:27], v[160:163], v[32:35]
    s_setprio 1
    v_mfma_f32_16x16x32_bf16 v[32:35], v[28:31], v[168:171], v[32:35]
    v_mfma_f32_16x16x32_bf16 v[36:39], v[24:27], v[164:167], v[36:39]
    v_mfma_f32_16x16x32_bf16 v[36:39], v[28:31], v[172:175], v[36:39]
    s_setprio 0
    ds_read_b128 v[24:27], v4 offset:54272
    ds_read_b128 v[28:31], v4 offset:55296
    buffer_load_dword v100, v1, s[12:15], s40 offen sc1
    s_add_u32 s40, s40, 16384
    buffer_load_dwordx4 v[196:199], v7, s[12:15], s31 offen offset:256 sc1
    s_waitcnt lgkmcnt(3)
    v_mfma_f32_16x16x32_bf16 v[40:43], v[12:15], v[160:163], v[40:43]
    s_setprio 1
    v_mfma_f32_16x16x32_bf16 v[40:43], v[16:19], v[168:171], v[40:43]
    v_mfma_f32_16x16x32_bf16 v[44:47], v[12:15], v[164:167], v[44:47]
    v_mfma_f32_16x16x32_bf16 v[44:47], v[16:19], v[172:175], v[44:47]
    s_setprio 0
    ds_read_b128 v[12:15], v4 offset:56320
    ds_read_b128 v[16:19], v4 offset:57344
    s_waitcnt lgkmcnt(3)
    v_mfma_f32_16x16x32_bf16 v[48:51], v[20:23], v[160:163], v[48:51]
    s_setprio 1
    v_mfma_f32_16x16x32_bf16 v[48:51], v[24:27], v[168:171], v[48:51]
    v_mfma_f32_16x16x32_bf16 v[52:55], v[20:23], v[164:167], v[52:55]
    v_mfma_f32_16x16x32_bf16 v[52:55], v[24:27], v[172:175], v[52:55]
    s_setprio 0
    ds_read_b128 v[20:23], v4 offset:58368
    ds_read_b128 v[24:27], v4 offset:59392
    buffer_load_dword v101, v1, s[12:15], s40 offen sc1
    s_add_u32 s40, s40, 16384
    buffer_load_dwordx4 v[200:203], v7, s[12:15], s31 offen offset:2048 sc1
    s_waitcnt lgkmcnt(3)
    v_mfma_f32_16x16x32_bf16 v[56:59], v[28:31], v[160:163], v[56:59]
    s_setprio 1
    v_mfma_f32_16x16x32_bf16 v[56:59], v[12:15], v[168:171], v[56:59]
    v_mfma_f32_16x16x32_bf16 v[60:63], v[28:31], v[164:167], v[60:63]
    v_mfma_f32_16x16x32_bf16 v[60:63], v[12:15], v[172:175], v[60:63]
    s_setprio 0
    ds_read_b128 v[28:31], v4 offset:60416
    ds_read_b128 v[12:15], v4 offset:61440
    s_waitcnt lgkmcnt(3)
    v_mfma_f32_16x16x32_bf16 v[64:67], v[16:19], v[160:163], v[64:67]
    s_setprio 1
    v_mfma_f32_16x16x32_bf16 v[64:67], v[20:23], v[168:171], v[64:67]
    v_mfma_f32_16x16x32_bf16 v[68:71], v[16:19], v[164:167], v[68:71]
    v_mfma_f32_16x16x32_bf16 v[68:71], v[20:23], v[172:175], v[68:71]
    s_setprio 0
    ds_read_b128 v[16:19], v4 offset:62464
    ds_read_b128 v[20:23], v4 offset:63488
    buffer_load_dword v102, v1, s[12:15], s40 offen sc1
    s_add_u32 s40, s40, 16384
    buffer_load_dwordx4 v[204:207], v7, s[12:15], s31 offen offset:2304 sc1
    s_add_u32 s31, s31, 4096
    s_waitcnt lgkmcnt(3)
    v_mfma_f32_16x16x32_bf16 v[72:75], v[24:27], v[160:163], v[72:75]
    s_setprio 1
    v_mfma_f32_16x16x32_bf16 v[72:75], v[28:31], v[168:171], v[72:75]
    v_mfma_f32_16x16x32_bf16 v[76:79], v[24:27], v[164:167], v[76:79]
    v_mfma_f32_16x16x32_bf16 v[76:79], v[28:31], v[172:175], v[76:79]
    s_setprio 0
    ds_read_b128 v[24:27], v4 offset:64512
    s_barrier
    ds_read_b128 v[28:31], v5 offset:0
    s_add_u32 s34, s37, 14336
    s_add_u32 m0, s32, 114688
    s_nop 0
    buffer_load_dwordx4 v3, s[16:19], s34 offen sc1 lds
    s_waitcnt lgkmcnt(3)
    v_mfma_f32_16x16x32_bf16 v[80:83], v[12:15], v[160:163], v[80:83]
    s_setprio 1
    v_mfma_f32_16x16x32_bf16 v[80:83], v[16:19], v[168:171], v[80:83]
    v_mfma_f32_16x16x32_bf16 v[84:87], v[12:15], v[164:167], v[84:87]
    v_mfma_f32_16x16x32_bf16 v[84:87], v[16:19], v[172:175], v[84:87]
    s_setprio 0
    ds_read_b128 v[12:15], v5 offset:1024
    ds_read_b128 v[16:19], v5 offset:2048
    buffer_load_dword v103, v1, s[12:15], s40 offen sc1
    s_add_u32 s40, s40, 16384
    buffer_load_dwordx4 v[208:211], v7, s[12:15], s31 offen offset:0 sc1
    s_waitcnt lgkmcnt(3)
    v_mfma_f32_16x16x32_bf16 v[88:91], v[20:23], v[160:163], v[88:91]
    s_setprio 1
    v_mfma_f32_16x16x32_bf16 v[88:91], v[24:27], v[168:171], v[88:91]
    v_mfma_f32_16x16x32_bf16 v[92:95], v[20:23], v[164:167], v[92:95]
    v_mfma_f32_16x16x32_bf16 v[92:95], v[24:27], v[172:175], v[92:95]
    s_setprio 0
    ds_read_b128 v[20:23], v5 offset:3072
    ds_read_b128 v[24:27], v5 offset:4096
    s_add_u32 s34, s37, 88064
    s_add_u32 m0, s32, 122880
    s_nop 0
    buffer_load_dwordx4 v3, s[16:19], s34 offen sc1 lds
    s_waitcnt vmcnt(14)
    s_waitcnt lgkmcnt(3)
    v_mfma_f32_16x16x32_bf16 v[32:35], v[28:31], v[176:179], v[32:35]
    s_setprio 1
    v_mfma_f32_16x16x32_bf16 v[32:35], v[12:15], v[184:187], v[32:35]
    v_mfma_f32_16x16x32_bf16 v[36:39], v[28:31], v[180:183], v[36:39]
    v_mfma_f32_16x16x32_bf16 v[36:39], v[12:15], v[188:191], v[36:39]
    s_setprio 0
    ds_read_b128 v[28:31], v5 offset:5120
    ds_read_b128 v[12:15], v5 offset:6144
    buffer_load_dword v104, v1, s[12:15], s40 offen sc1
    s_add_u32 s40, s40, 16384
    buffer_load_dwordx4 v[212:215], v7, s[12:15], s31 offen offset:256 sc1
    s_waitcnt lgkmcnt(3)
    v_mfma_f32_16x16x32_bf16 v[40:43], v[16:19], v[176:179], v[40:43]
    s_setprio 1
    v_mfma_f32_16x16x32_bf16 v[40:43], v[20:23], v[184:187], v[40:43]
    v_mfma_f32_16x16x32_bf16 v[44:47], v[16:19], v[180:183], v[44:47]
    v_mfma_f32_16x16x32_bf16 v[44:47], v[20:23], v[188:191], v[44:47]
    s_setprio 0
    ds_read_b128 v[16:19], v5 offset:7168
    ds_read_b128 v[20:23], v5 offset:8192
    s_waitcnt lgkmcnt(3)
    v_mfma_f32_16x16x32_bf16 v[48:51], v[24:27], v[176:179], v[48:51]
    s_setprio 1
    v_mfma_f32_16x16x32_bf16 v[48:51], v[28:31], v[184:187], v[48:51]
    v_mfma_f32_16x16x32_bf16 v[52:55], v[24:27], v[180:183], v[52:55]
    v_mfma_f32_16x16x32_bf16 v[52:55], v[28:31], v[188:191], v[52:55]
    s_setprio 0
    ds_read_b128 v[24:27], v5 offset:9216
    ds_read_b128 v[28:31], v5 offset:10240
    buffer_load_dwordx4 v[216:219], v7, s[12:15], s31 offen offset:2048 sc1
    s_waitcnt lgkmcnt(3)
    v_mfma_f32_16x16x32_bf16 v[56:59], v[12:15], v[176:179], v[56:59]
    s_setprio 1
    v_mfma_f32_16x16x32_bf16 v[56:59], v[16:19], v[184:187], v[56:59]
    v_mfma_f32_16x16x32_bf16 v[60:63], v[12:15], v[180:183], v[60:63]
    v_mfma_f32_16x16x32_bf16 v[60:63], v[16:19], v[188:191], v[60:63]
    s_setprio 0
    ds_read_b128 v[12:15], v5 offset:11264
    ds_read_b128 v[16:19], v5 offset:12288
    s_waitcnt lgkmcnt(3)
    v_mfma_f32_16x16x32_bf16 v[64:67], v[20:23], v[176:179], v[64:67]
    s_setprio 1
    v_mfma_f32_16x16x32_bf16 v[64:67], v[24:27], v[184:187], v[64:67]
    v_mfma_f32_16x16x32_bf16 v[68:71], v[20:23], v[180:183], v[68:71]
    v_mfma_f32_16x16x32_bf16 v[68:71], v[24:27], v[188:191], v[68:71]
    s_setprio 0
    ds_read_b128 v[20:23], v5 offset:13312
    ds_read_b128 v[24:27], v5 offset:14336
    buffer_load_dwordx4 v[220:223], v7, s[12:15], s31 offen offset:2304 sc1
    s_add_u32 s31, s31, 4096
    s_waitcnt lgkmcnt(3)
    v_mfma_f32_16x16x32_bf16 v[72:75], v[28:31], v[176:179], v[72:75]
    s_setprio 1
    v_mfma_f32_16x16x32_bf16 v[72:75], v[12:15], v[184:187], v[72:75]
    v_mfma_f32_16x16x32_bf16 v[76:79], v[28:31], v[180:183], v[76:79]
    v_mfma_f32_16x16x32_bf16 v[76:79], v[12:15], v[188:191], v[76:79]
    s_setprio 0
    ds_read_b128 v[28:31], v5 offset:15360
    s_barrier
    ds_read_b128 v[12:15], v5 offset:16384
    s_add_u32 s34, s37, 16384
    s_add_u32 m0, s32, 131072
    s_nop 0
    buffer_load_dwordx4 v3, s[16:19], s34 offen sc1 lds
    s_waitcnt lgkmcnt(3)
    v_mfma_f32_16x16x32_bf16 v[80:83], v[16:19], v[176:179], v[80:83]
    s_setprio 1
    v_mfma_f32_16x16x32_bf16 v[80:83], v[20:23], v[184:187], v[80:83]
    v_mfma_f32_16x16x32_bf16 v[84:87], v[16:19], v[180:183], v[84:87]
    v_mfma_f32_16x16x32_bf16 v[84:87], v[20:23], v[188:191], v[84:87]
    s_setprio 0
    ds_read_b128 v[16:19], v5 offset:17408
    ds_read_b128 v[20:23], v5 offset:18432
    buffer_load_dwordx4 v[224:227], v7, s[12:15], s31 offen offset:0 sc1
    s_waitcnt lgkmcnt(3)
    v_mfma_f32_16x16x32_bf16 v[88:91], v[24:27], v[176:179], v[88:91]
    s_setprio 1
    v_mfma_f32_16x16x32_bf16 v[88:91], v[28:31], v[184:187], v[88:91]
    v_mfma_f32_16x16x32_bf16 v[92:95], v[24:27], v[180:183], v[92:95]
    v_mfma_f32_16x16x32_bf16 v[92:95], v[28:31], v[188:191], v[92:95]
    s_setprio 0
    ds_read_b128 v[24:27], v5 offset:19456
    ds_read_b128 v[28:31], v5 offset:20480
    s_add_u32 s34, s37, 90112
    s_add_u32 m0, s32, 139264
    s_nop 0
    buffer_load_dwordx4 v3, s[16:19], s34 offen sc1 lds
    s_waitcnt vmcnt(6)
    s_waitcnt lgkmcnt(3)
    v_mfma_f32_16x16x32_bf16 v[32:35], v[12:15], v[192:195], v[32:35]
    s_setprio 1
    v_mfma_f32_16x16x32_bf16 v[32:35], v[16:19], v[200:203], v[32:35]
    v_mfma_f32_16x16x32_bf16 v[36:39], v[12:15], v[196:199], v[36:39]
    v_mfma_f32_16x16x32_bf16 v[36:39], v[16:19], v[204:207], v[36:39]
    s_setprio 0
    ds_read_b128 v[12:15], v5 offset:21504
    ds_read_b128 v[16:19], v5 offset:22528
    v_add_f32 v105, v96, v97
    v_add_f32 v105, v105, v98
    buffer_load_dwordx4 v[228:231], v7, s[12:15], s31 offen offset:256 sc1
    v_add_f32 v105, v105, v99
    v_add_f32 v105, v105, v100
    s_waitcnt lgkmcnt(3)
    v_mfma_f32_16x16x32_bf16 v[40:43], v[20:23], v[192:195], v[40:43]
    s_setprio 1
    v_mfma_f32_16x16x32_bf16 v[40:43], v[24:27], v[200:203], v[40:43]
    v_mfma_f32_16x16x32_bf16 v[44:47], v[20:23], v[196:199], v[44:47]
    v_mfma_f32_16x16x32_bf16 v[44:47], v[24:27], v[204:207], v[44:47]
    s_setprio 0
    ds_read_b128 v[20:23], v5 offset:23552
    ds_read_b128 v[24:27], v5 offset:24576
    v_add_f32 v105, v105, v101
    v_add_f32 v105, v105, v102
    v_add_f32 v105, v105, v103
    v_add_f32 v105, v105, v104
    s_waitcnt lgkmcnt(3)
    v_mfma_f32_16x16x32_bf16 v[48:51], v[28:31], v[192:195], v[48:51]
    s_setprio 1
    v_mfma_f32_16x16x32_bf16 v[48:51], v[12:15], v[200:203], v[48:51]
    v_mfma_f32_16x16x32_bf16 v[52:55], v[28:31], v[196:199], v[52:55]
    v_mfma_f32_16x16x32_bf16 v[52:55], v[12:15], v[204:207], v[52:55]
    s_setprio 0
    ds_read_b128 v[28:31], v5 offset:25600
    ds_read_b128 v[12:15], v5 offset:26624
    v_mul_f32 v105, 0x3ae38e39, v105
    v_mov_b32 v107, v105
    buffer_load_dwordx4 v[232:235], v7, s[12:15], s31 offen offset:2048 sc1
    s_nop 0
    v_permlane32_swap_b32 v105, v107
    v_fma_f32 v107, -v105, v105, v107
    s_waitcnt lgkmcnt(3)
    v_mfma_f32_16x16x32_bf16 v[56:59], v[16:19], v[192:195], v[56:59]
    s_setprio 1
    v_mfma_f32_16x16x32_bf16 v[56:59], v[20:23], v[200:203], v[56:59]
    v_mfma_f32_16x16x32_bf16 v[60:63], v[16:19], v[196:199], v[60:63]
    v_mfma_f32_16x16x32_bf16 v[60:63], v[20:23], v[204:207], v[60:63]
    s_setprio 0
    ds_read_b128 v[16:19], v5 offset:27648
    ds_read_b128 v[20:23], v5 offset:28672
    v_sub_f32 v10, 0, v105
    v_max_f32 v107, 0, v107
    v_sub_f32 v11, 0, v105
    v_add_f32 v107, 0x3727c5ac, v107
    s_waitcnt lgkmcnt(3)
    v_mfma_f32_16x16x32_bf16 v[64:67], v[24:27], v[192:195], v[64:67]
    s_setprio 1
    v_mfma_f32_16x16x32_bf16 v[64:67], v[28:31], v[200:203], v[64:67]
    v_mfma_f32_16x16x32_bf16 v[68:71], v[24:27], v[196:199], v[68:71]
    v_mfma_f32_16x16x32_bf16 v[68:71], v[28:31], v[204:207], v[68:71]
    s_setprio 0
    ds_read_b128 v[24:27], v5 offset:29696
    ds_read_b128 v[28:31], v5 offset:30720
    v_rcp_f32 v8, v107
    v_rcp_f32 v9, v107
    buffer_load_dwordx4 v[236:239], v7, s[12:15], s31 offen offset:2304 sc1
    s_add_u32 s31, s31, 4096
    v_permlane16_swap_b32 v10, v11
    v_permlane16_swap_b32 v8, v9
    s_waitcnt lgkmcnt(3)
    v_mfma_f32_16x16x32_bf16 v[72:75], v[12:15], v[192:195], v[72:75]
    s_setprio 1
    v_mfma_f32_16x16x32_bf16 v[72:75], v[16:19], v[200:203], v[72:75]
    v_mfma_f32_16x16x32_bf16 v[76:79], v[12:15], v[196:199], v[76:79]
    v_mfma_f32_16x16x32_bf16 v[76:79], v[16:19], v[204:207], v[76:79]
    s_setprio 0
    ds_read_b128 v[12:15], v5 offset:31744
    s_barrier
    ds_read_b128 v[16:19], v5 offset:32768
    s_add_u32 s34, s38, 147456
    s_add_u32 m0, s32, 0
    s_nop 0
    buffer_load_dwordx4 v3, s[16:19], s34 offen sc1 lds
    s_waitcnt lgkmcnt(3)
    v_mfma_f32_16x16x32_bf16 v[80:83], v[20:23], v[192:195], v[80:83]
    s_setprio 1
    v_mfma_f32_16x16x32_bf16 v[80:83], v[24:27], v[200:203], v[80:83]
    v_mfma_f32_16x16x32_bf16 v[84:87], v[20:23], v[196:199], v[84:87]
    v_mfma_f32_16x16x32_bf16 v[84:87], v[24:27], v[204:207], v[84:87]
    s_setprio 0
    ds_read_b128 v[20:23], v5 offset:33792
    ds_read_b128 v[24:27], v5 offset:34816
    buffer_load_dwordx4 v[240:243], v7, s[12:15], s31 offen offset:0 sc1
    s_waitcnt lgkmcnt(3)
    v_mfma_f32_16x16x32_bf16 v[88:91], v[28:31], v[192:195], v[88:91]
    s_setprio 1
    v_mfma_f32_16x16x32_bf16 v[88:91], v[12:15], v[200:203], v[88:91]
    v_mfma_f32_16x16x32_bf16 v[92:95], v[28:31], v[196:199], v[92:95]
    v_mfma_f32_16x16x32_bf16 v[92:95], v[12:15], v[204:207], v[92:95]
    s_setprio 0
    ds_read_b128 v[28:31], v5 offset:35840
    ds_read_b128 v[12:15], v5 offset:36864
    s_add_u32 s34, s38, 155648
    s_add_u32 m0, s32, 8192
    s_nop 0
    buffer_load_dwordx4 v3, s[16:19], s34 offen sc1 lds
    s_waitcnt vmcnt(9)
    s_waitcnt lgkmcnt(3)
    v_mfma_f32_16x16x32_bf16 v[32:35], v[16:19], v[208:211], v[32:35]
    s_setprio 1
    v_mfma_f32_16x16x32_bf16 v[32:35], v[20:23], v[216:219], v[32:35]
    v_mfma_f32_16x16x32_bf16 v[36:39], v[16:19], v[212:215], v[36:39]
    v_mfma_f32_16x16x32_bf16 v[36:39], v[20:23], v[220:223], v[36:39]
    s_setprio 0
    ds_read_b128 v[16:19], v5 offset:37888
    ds_read_b128 v[20:23], v5 offset:38912
    buffer_load_dwordx4 v[244:247], v7, s[12:15], s31 offen offset:256 sc1
    s_waitcnt lgkmcnt(3)
    v_mfma_f32_16x16x32_bf16 v[40:43], v[24:27], v[208:211], v[40:43]
    s_setprio 1
    v_mfma_f32_16x16x32_bf16 v[40:43], v[28:31], v[216:219], v[40:43]
    v_mfma_f32_16x16x32_bf16 v[44:47], v[24:27], v[212:215], v[44:47]
    v_mfma_f32_16x16x32_bf16 v[44:47], v[28:31], v[220:223], v[44:47]
    s_setprio 0
    ds_read_b128 v[24:27], v5 offset:39936
    ds_read_b128 v[28:31], v5 offset:40960
    s_waitcnt lgkmcnt(3)
    v_mfma_f32_16x16x32_bf16 v[48:51], v[12:15], v[208:211], v[48:51]
    s_setprio 1
    v_mfma_f32_16x16x32_bf16 v[48:51], v[16:19], v[216:219], v[48:51]
    v_mfma_f32_16x16x32_bf16 v[52:55], v[12:15], v[212:215], v[52:55]
    v_mfma_f32_16x16x32_bf16 v[52:55], v[16:19], v[220:223], v[52:55]
    s_setprio 0
    ds_read_b128 v[12:15], v5 offset:41984
    ds_read_b128 v[16:19], v5 offset:43008
    buffer_load_dwordx4 v[248:251], v7, s[12:15], s31 offen offset:2048 sc1
    s_waitcnt lgkmcnt(3)
    v_mfma_f32_16x16x32_bf16 v[56:59], v[20:23], v[208:211], v[56:59]
    s_setprio 1
    v_mfma_f32_16x16x32_bf16 v[56:59], v[24:27], v[216:219], v[56:59]
    v_mfma_f32_16x16x32_bf16 v[60:63], v[20:23], v[212:215], v[60:63]
    v_mfma_f32_16x16x32_bf16 v[60:63], v[24:27], v[220:223], v[60:63]
    s_setprio 0
    ds_read_b128 v[20:23], v5 offset:44032
    ds_read_b128 v[24:27], v5 offset:45056
    s_waitcnt lgkmcnt(3)
    v_mfma_f32_16x16x32_bf16 v[64:67], v[28:31], v[208:211], v[64:67]
    s_setprio 1
    v_mfma_f32_16x16x32_bf16 v[64:67], v[12:15], v[216:219], v[64:67]
    v_mfma_f32_16x16x32_bf16 v[68:71], v[28:31], v[212:215], v[68:71]
    v_mfma_f32_16x16x32_bf16 v[68:71], v[12:15], v[220:223], v[68:71]
    s_setprio 0
    ds_read_b128 v[28:31], v5 offset:46080
    ds_read_b128 v[12:15], v5 offset:47104
    buffer_load_dwordx4 v[252:255], v7, s[12:15], s31 offen offset:2304 sc1
    s_add_u32 s31, s31, 4096
    s_waitcnt lgkmcnt(3)
    v_mfma_f32_16x16x32_bf16 v[72:75], v[16:19], v[208:211], v[72:75]
    s_setprio 1
    v_mfma_f32_16x16x32_bf16 v[72:75], v[20:23], v[216:219], v[72:75]
    v_mfma_f32_16x16x32_bf16 v[76:79], v[16:19], v[212:215], v[76:79]
    v_mfma_f32_16x16x32_bf16 v[76:79], v[20:23], v[220:223], v[76:79]
    s_setprio 0
    ds_read_b128 v[16:19], v5 offset:48128
    s_barrier
    ds_read_b128 v[20:23], v5 offset:49152
    s_add_u32 s34, s38, 163840
    s_add_u32 m0, s32, 16384
    s_nop 0
    buffer_load_dwordx4 v3, s[16:19], s34 offen sc1 lds
    s_waitcnt lgkmcnt(3)
    v_mfma_f32_16x16x32_bf16 v[80:83], v[24:27], v[208:211], v[80:83]
    s_setprio 1
    v_mfma_f32_16x16x32_bf16 v[80:83], v[28:31], v[216:219], v[80:83]
    v_mfma_f32_16x16x32_bf16 v[84:87], v[24:27], v[212:215], v[84:87]
    v_mfma_f32_16x16x32_bf16 v[84:87], v[28:31], v[220:223], v[84:87]
    s_setprio 0
    ds_read_b128 v[24:27], v5 offset:50176
    ds_read_b128 v[28:31], v5 offset:51200
    s_waitcnt lgkmcnt(3)
    v_mfma_f32_16x16x32_bf16 v[88:91], v[12:15], v[208:211], v[88:91]
    s_setprio 1
    v_mfma_f32_16x16x32_bf16 v[88:91], v[16:19], v[216:219], v[88:91]
    v_mfma_f32_16x16x32_bf16 v[92:95], v[12:15], v[212:215], v[92:95]
    v_mfma_f32_16x16x32_bf16 v[92:95], v[16:19], v[220:223], v[92:95]
    s_setprio 0
    ds_read_b128 v[12:15], v5 offset:52224
    ds_read_b128 v[16:19], v5 offset:53248
    s_add_u32 s34, s38, 172032
    s_add_u32 m0, s32, 24576
    s_nop 0
    buffer_load_dwordx4 v3, s[16:19], s34 offen sc1 lds
    ds_read_b128 v[96:99], v0 offset:0
    s_waitcnt vmcnt(8)
    s_waitcnt lgkmcnt(4)
    v_mfma_f32_16x16x32_bf16 v[32:35], v[20:23], v[224:227], v[32:35]
    s_setprio 1
    v_mfma_f32_16x16x32_bf16 v[32:35], v[24:27], v[232:235], v[32:35]
    v_mfma_f32_16x16x32_bf16 v[36:39], v[20:23], v[228:231], v[36:39]
    v_mfma_f32_16x16x32_bf16 v[36:39], v[24:27], v[236:239], v[36:39]
    s_setprio 0
    ds_read_b128 v[20:23], v5 offset:54272
    ds_read_b128 v[24:27], v5 offset:55296
    ds_read_b128 v[100:103], v0 offset:64
    s_waitcnt lgkmcnt(5)
    v_mfma_f32_16x16x32_bf16 v[40:43], v[28:31], v[224:227], v[40:43]
    s_setprio 1
    v_mfma_f32_16x16x32_bf16 v[40:43], v[12:15], v[232:235], v[40:43]
    v_mfma_f32_16x16x32_bf16 v[44:47], v[28:31], v[228:231], v[44:47]
    v_mfma_f32_16x16x32_bf16 v[44:47], v[12:15], v[236:239], v[44:47]
    s_setprio 0
    ds_read_b128 v[28:31], v5 offset:56320
    ds_read_b128 v[12:15], v5 offset:57344
    s_add_u32 s34, s38, 180224
    s_add_u32 m0, s32, 32768
    s_nop 0
    buffer_load_dwordx4 v3, s[16:19], s34 offen sc1 lds
    ds_read_b128 v[104:107], v0 offset:128
    s_waitcnt lgkmcnt(5)
    v_mfma_f32_16x16x32_bf16 v[48:51], v[16:19], v[224:227], v[48:51]
    s_setprio 1
    v_mfma_f32_16x16x32_bf16 v[48:51], v[20:23], v[232:235], v[48:51]
    v_mfma_f32_16x16x32_bf16 v[52:55], v[16:19], v[228:231], v[52:55]
    v_mfma_f32_16x16x32_bf16 v[52:55], v[20:23], v[236:239], v[52:55]
    s_setprio 0
    ds_read_b128 v[16:19], v5 offset:58368
    ds_read_b128 v[20:23], v5 offset:59392
    ds_read_b128 v[108:111], v0 offset:192
    v_fmac_f32 v32, v96, v10
    v_fmac_f32 v33, v97, v10
    v_fmac_f32 v34, v98, v10
    v_fmac_f32 v35, v99, v10
    v_fmac_f32 v36, v96, v11
    v_fmac_f32 v37, v97, v11
    v_fmac_f32 v38, v98, v11
    v_fmac_f32 v39, v99, v11
    s_waitcnt lgkmcnt(5)
    v_mfma_f32_16x16x32_bf16 v[56:59], v[24:27], v[224:227], v[56:59]
    s_setprio 1
    v_mfma_f32_16x16x32_bf16 v[56:59], v[28:31], v[232:235], v[56:59]
    v_mfma_f32_16x16x32_bf16 v[60:63], v[24:27], v[228:231], v[60:63]
    v_mfma_f32_16x16x32_bf16 v[60:63], v[28:31], v[236:239], v[60:63]
    s_setprio 0
    ds_read_b128 v[24:27], v5 offset:60416
    ds_read_b128 v[28:31], v5 offset:61440
    s_add_u32 s34, s38, 188416
    s_add_u32 m0, s32, 40960
    s_nop 0
    buffer_load_dwordx4 v3, s[16:19], s34 offen sc1 lds
    ds_read_b128 v[96:99], v0 offset:256
    v_fmac_f32 v40, v100, v10
    v_fmac_f32 v41, v101, v10
    v_fmac_f32 v42, v102, v10
    v_fmac_f32 v43, v103, v10
    v_fmac_f32 v44, v100, v11
    v_fmac_f32 v45, v101, v11
    v_fmac_f32 v46, v102, v11
    v_fmac_f32 v47, v103, v11
    s_waitcnt lgkmcnt(5)
    v_mfma_f32_16x16x32_bf16 v[64:67], v[12:15], v[224:227], v[64:67]
    s_setprio 1
    v_mfma_f32_16x16x32_bf16 v[64:67], v[16:19], v[232:235], v[64:67]
    v_mfma_f32_16x16x32_bf16 v[68:71], v[12:15], v[228:231], v[68:71]
    v_mfma_f32_16x16x32_bf16 v[68:71], v[16:19], v[236:239], v[68:71]
    s_setprio 0
    ds_read_b128 v[12:15], v5 offset:62464
    ds_read_b128 v[16:19], v5 offset:63488
    ds_read_b128 v[100:103], v0 offset:320
    v_fmac_f32 v48, v104, v10
    v_fmac_f32 v49, v105, v10
    v_fmac_f32 v50, v106, v10
    v_fmac_f32 v51, v107, v10
    v_fmac_f32 v52, v104, v11
    v_fmac_f32 v53, v105, v11
    v_fmac_f32 v54, v106, v11
    v_fmac_f32 v55, v107, v11
    s_waitcnt lgkmcnt(5)
    v_mfma_f32_16x16x32_bf16 v[72:75], v[20:23], v[224:227], v[72:75]
    s_setprio 1
    v_mfma_f32_16x16x32_bf16 v[72:75], v[24:27], v[232:235], v[72:75]
    v_mfma_f32_16x16x32_bf16 v[76:79], v[20:23], v[228:231], v[76:79]
    v_mfma_f32_16x16x32_bf16 v[76:79], v[24:27], v[236:239], v[76:79]
    s_setprio 0
    ds_read_b128 v[20:23], v5 offset:64512
    s_barrier
    ds_read_b128 v[24:27], v6 offset:0
    s_add_u32 s34, s38, 196608
    s_add_u32 m0, s32, 49152
    s_nop 0
    buffer_load_dwordx4 v3, s[16:19], s34 offen sc1 lds
    ds_read_b128 v[104:107], v0 offset:384
    v_fmac_f32 v56, v108, v10
    v_fmac_f32 v57, v109, v10
    v_fmac_f32 v58, v110, v10
    v_fmac_f32 v59, v111, v10
    v_fmac_f32 v60, v108, v11
    v_fmac_f32 v61, v109, v11
    v_fmac_f32 v62, v110, v11
    v_fmac_f32 v63, v111, v11
    s_waitcnt lgkmcnt(5)
    v_mfma_f32_16x16x32_bf16 v[80:83], v[28:31], v[224:227], v[80:83]
    s_setprio 1
    v_mfma_f32_16x16x32_bf16 v[80:83], v[12:15], v[232:235], v[80:83]
    v_mfma_f32_16x16x32_bf16 v[84:87], v[28:31], v[228:231], v[84:87]
    v_mfma_f32_16x16x32_bf16 v[84:87], v[12:15], v[236:239], v[84:87]
    s_setprio 0
    ds_read_b128 v[28:31], v6 offset:1024
    ds_read_b128 v[12:15], v6 offset:2048
    ds_read_b128 v[108:111], v0 offset:448
    v_fmac_f32 v64, v96, v10
    v_fmac_f32 v65, v97, v10
    v_fmac_f32 v66, v98, v10
    v_fmac_f32 v67, v99, v10
    v_fmac_f32 v68, v96, v11
    v_fmac_f32 v69, v97, v11
    v_fmac_f32 v70, v98, v11
    v_fmac_f32 v71, v99, v11
    s_waitcnt lgkmcnt(5)
    v_mfma_f32_16x16x32_bf16 v[88:91], v[16:19], v[224:227], v[88:91]
    s_setprio 1
    v_mfma_f32_16x16x32_bf16 v[88:91], v[20:23], v[232:235], v[88:91]
    v_mfma_f32_16x16x32_bf16 v[92:95], v[16:19], v[228:231], v[92:95]
    v_mfma_f32_16x16x32_bf16 v[92:95], v[20:23], v[236:239], v[92:95]
    s_setprio 0
    ds_read_b128 v[16:19], v6 offset:3072
    ds_read_b128 v[20:23], v6 offset:4096
    s_add_u32 s34, s38, 204800
    s_add_u32 m0, s32, 57344
    s_nop 0
    buffer_load_dwordx4 v3, s[16:19], s34 offen sc1 lds
    v_fmac_f32 v72, v100, v10
    v_fmac_f32 v73, v101, v10
    v_fmac_f32 v74, v102, v10
    v_fmac_f32 v75, v103, v10
    v_fmac_f32 v76, v100, v11
    v_fmac_f32 v77, v101, v11
    v_fmac_f32 v78, v102, v11
    v_fmac_f32 v79, v103, v11
    s_waitcnt vmcnt(6)
    s_waitcnt lgkmcnt(4)
    v_mfma_f32_16x16x32_bf16 v[32:35], v[24:27], v[240:243], v[32:35]
    s_setprio 1
    v_mfma_f32_16x16x32_bf16 v[32:35], v[28:31], v[248:251], v[32:35]
    v_mfma_f32_16x16x32_bf16 v[36:39], v[24:27], v[244:247], v[36:39]
    v_mfma_f32_16x16x32_bf16 v[36:39], v[28:31], v[252:255], v[36:39]
    s_setprio 0
    ds_read_b128 v[24:27], v6 offset:5120
    ds_read_b128 v[28:31], v6 offset:6144
    v_fmac_f32 v80, v104, v10
    v_fmac_f32 v81, v105, v10
    v_fmac_f32 v82, v106, v10
    v_fmac_f32 v83, v107, v10
    v_fmac_f32 v84, v104, v11
    v_fmac_f32 v85, v105, v11
    v_fmac_f32 v86, v106, v11
    v_fmac_f32 v87, v107, v11
    s_waitcnt lgkmcnt(3)
    v_mfma_f32_16x16x32_bf16 v[40:43], v[12:15], v[240:243], v[40:43]
    s_setprio 1
    v_mfma_f32_16x16x32_bf16 v[40:43], v[16:19], v[248:251], v[40:43]
    v_mfma_f32_16x16x32_bf16 v[44:47], v[12:15], v[244:247], v[44:47]
    v_mfma_f32_16x16x32_bf16 v[44:47], v[16:19], v[252:255], v[44:47]
    s_setprio 0
    ds_read_b128 v[12:15], v6 offset:7168
    ds_read_b128 v[16:19], v6 offset:8192
    v_fmac_f32 v88, v108, v10
    v_fmac_f32 v89, v109, v10
    v_fmac_f32 v90, v110, v10
    v_fmac_f32 v91, v111, v10
    v_fmac_f32 v92, v108, v11
    v_fmac_f32 v93, v109, v11
    v_fmac_f32 v94, v110, v11
    v_fmac_f32 v95, v111, v11
    s_waitcnt lgkmcnt(3)
    v_mfma_f32_16x16x32_bf16 v[48:51], v[20:23], v[240:243], v[48:51]
    s_setprio 1
    v_mfma_f32_16x16x32_bf16 v[48:51], v[24:27], v[248:251], v[48:51]
    v_mfma_f32_16x16x32_bf16 v[52:55], v[20:23], v[244:247], v[52:55]
    v_mfma_f32_16x16x32_bf16 v[52:55], v[24:27], v[252:255], v[52:55]
    s_setprio 0
    ds_read_b128 v[20:23], v6 offset:9216
    ds_read_b128 v[24:27], v6 offset:10240
    s_waitcnt lgkmcnt(3)
    v_mfma_f32_16x16x32_bf16 v[56:59], v[28:31], v[240:243], v[56:59]
    s_setprio 1
    v_mfma_f32_16x16x32_bf16 v[56:59], v[12:15], v[248:251], v[56:59]
    v_mfma_f32_16x16x32_bf16 v[60:63], v[28:31], v[244:247], v[60:63]
    v_mfma_f32_16x16x32_bf16 v[60:63], v[12:15], v[252:255], v[60:63]
    s_setprio 0
    ds_read_b128 v[28:31], v6 offset:11264
    ds_read_b128 v[12:15], v6 offset:12288
    s_waitcnt lgkmcnt(3)
    v_mfma_f32_16x16x32_bf16 v[64:67], v[16:19], v[240:243], v[64:67]
    s_setprio 1
    v_mfma_f32_16x16x32_bf16 v[64:67], v[20:23], v[248:251], v[64:67]
    v_mfma_f32_16x16x32_bf16 v[68:71], v[16:19], v[244:247], v[68:71]
    v_mfma_f32_16x16x32_bf16 v[68:71], v[20:23], v[252:255], v[68:71]
    s_setprio 0
    ds_read_b128 v[16:19], v6 offset:13312
    ds_read_b128 v[20:23], v6 offset:14336
    s_waitcnt lgkmcnt(3)
    v_mfma_f32_16x16x32_bf16 v[72:75], v[24:27], v[240:243], v[72:75]
    s_setprio 1
    v_mfma_f32_16x16x32_bf16 v[72:75], v[28:31], v[248:251], v[72:75]
    v_mfma_f32_16x16x32_bf16 v[76:79], v[24:27], v[244:247], v[76:79]
    v_mfma_f32_16x16x32_bf16 v[76:79], v[28:31], v[252:255], v[76:79]
    s_setprio 0
    ds_read_b128 v[24:27], v6 offset:15360
    s_barrier
    ds_read_b128 v[28:31], v4 offset:0
    s_add_u32 s34, s38, 212992
    s_add_u32 m0, s32, 65536
    s_nop 0
    buffer_load_dwordx4 v3, s[16:19], s34 offen sc1 lds
    ds_read_b128 v[96:99], v0 offset:512
    s_waitcnt lgkmcnt(4)
    v_mfma_f32_16x16x32_bf16 v[80:83], v[12:15], v[240:243], v[80:83]
    s_setprio 1
    v_mfma_f32_16x16x32_bf16 v[80:83], v[16:19], v[248:251], v[80:83]
    v_mfma_f32_16x16x32_bf16 v[84:87], v[12:15], v[244:247], v[84:87]
    v_mfma_f32_16x16x32_bf16 v[84:87], v[16:19], v[252:255], v[84:87]
    s_setprio 0
    ds_read_b128 v[12:15], v4 offset:1024
    ds_read_b128 v[16:19], v4 offset:2048
    s_waitcnt lgkmcnt(2)
    v_mul_f32 v100, v96, v11
    v_mul_f32 v101, v97, v11
    v_mul_f32 v102, v98, v11
    v_mul_f32 v103, v99, v11
    v_mul_f32 v96, v96, v10
    v_mul_f32 v97, v97, v10
    v_mul_f32 v98, v98, v10
    v_mul_f32 v99, v99, v10
    v_mfma_f32_16x16x32_bf16 v[88:91], v[20:23], v[240:243], v[88:91]
    s_setprio 1
    v_mfma_f32_16x16x32_bf16 v[88:91], v[24:27], v[248:251], v[88:91]
    v_mfma_f32_16x16x32_bf16 v[92:95], v[20:23], v[244:247], v[92:95]
    v_mfma_f32_16x16x32_bf16 v[92:95], v[24:27], v[252:255], v[92:95]
    s_setprio 0
    ds_read_b128 v[20:23], v4 offset:3072
    ds_read_b128 v[24:27], v4 offset:4096
    s_add_u32 s34, s38, 221184
    s_add_u32 m0, s32, 73728
    s_nop 0
    buffer_load_dwordx4 v3, s[16:19], s34 offen sc1 lds
    s_waitcnt lgkmcnt(3)
    v_mfma_f32_16x16x32_bf16 v[96:99], v[28:31], v[112:115], v[96:99]
    s_setprio 1
    v_mfma_f32_16x16x32_bf16 v[96:99], v[12:15], v[120:123], v[96:99]
    v_mfma_f32_16x16x32_bf16 v[100:103], v[28:31], v[116:119], v[100:103]
    v_mfma_f32_16x16x32_bf16 v[100:103], v[12:15], v[124:127], v[100:103]
    s_setprio 0
    ds_read_b128 v[28:31], v4 offset:5120
    ds_read_b128 v[12:15], v4 offset:6144
    v_max_f32 v32, 0, v32
    s_waitcnt lgkmcnt(3)
    v_mfma_f32_16x16x32_bf16 v[96:99], v[16:19], v[128:131], v[96:99]
    s_setprio 1
    v_mfma_f32_16x16x32_bf16 v[96:99], v[20:23], v[136:139], v[96:99]
    v_mfma_f32_16x16x32_bf16 v[100:103], v[16:19], v[132:135], v[100:103]
    v_mfma_f32_16x16x32_bf16 v[100:103], v[20:23], v[140:143], v[100:103]
    s_setprio 0
    ds_read_b128 v[16:19], v4 offset:7168
    ds_read_b128 v[20:23], v4 offset:8192
    v_max_f32 v33, 0, v33
    v_max_f32 v34, 0, v34
    v_max_f32 v35, 0, v35
    v_mul_f32 v40, v40, v8
    s_waitcnt lgkmcnt(3)
    v_mfma_f32_16x16x32_bf16 v[96:99], v[24:27], v[144:147], v[96:99]
    s_setprio 1
    v_mfma_f32_16x16x32_bf16 v[96:99], v[28:31], v[152:155], v[96:99]
    v_mfma_f32_16x16x32_bf16 v[100:103], v[24:27], v[148:151], v[100:103]
    v_mfma_f32_16x16x32_bf16 v[100:103], v[28:31], v[156:159], v[100:103]
    s_setprio 0
    ds_read_b128 v[24:27], v4 offset:9216
    ds_read_b128 v[28:31], v4 offset:10240
    v_mul_f32 v41, v41, v8
    v_mul_f32 v42, v42, v8
    v_mul_f32 v43, v43, v8
    v_mul_f32 v40, v32, v40
    s_waitcnt lgkmcnt(3)
    v_mfma_f32_16x16x32_bf16 v[96:99], v[12:15], v[160:163], v[96:99]
    s_setprio 1
    v_mfma_f32_16x16x32_bf16 v[96:99], v[16:19], v[168:171], v[96:99]
    v_mfma_f32_16x16x32_bf16 v[100:103], v[12:15], v[164:167], v[100:103]
    v_mfma_f32_16x16x32_bf16 v[100:103], v[16:19], v[172:175], v[100:103]
    s_setprio 0
    ds_read_b128 v[12:15], v4 offset:11264
    ds_read_b128 v[16:19], v4 offset:12288
    v_mul_f32 v41, v33, v41
    v_mul_f32 v42, v34, v42
    v_mul_f32 v43, v35, v43
    v_cvt_pk_bf16_f32 v32, v40, v41
    s_waitcnt lgkmcnt(3)
    v_mfma_f32_16x16x32_bf16 v[96:99], v[20:23], v[176:179], v[96:99]
    s_setprio 1
    v_mfma_f32_16x16x32_bf16 v[96:99], v[24:27], v[184:187], v[96:99]
    v_mfma_f32_16x16x32_bf16 v[100:103], v[20:23], v[180:183], v[100:103]
    v_mfma_f32_16x16x32_bf16 v[100:103], v[24:27], v[188:191], v[100:103]
    s_setprio 0
    ds_read_b128 v[20:23], v4 offset:13312
    ds_read_b128 v[24:27], v4 offset:14336
    v_cvt_pk_bf16_f32 v33, v42, v43
    v_max_f32 v36, 0, v36
    v_max_f32 v37, 0, v37
    v_max_f32 v38, 0, v38
    s_waitcnt lgkmcnt(3)
    v_mfma_f32_16x16x32_bf16 v[96:99], v[28:31], v[192:195], v[96:99]
    s_setprio 1
    v_mfma_f32_16x16x32_bf16 v[96:99], v[12:15], v[200:203], v[96:99]
    v_mfma_f32_16x16x32_bf16 v[100:103], v[28:31], v[196:199], v[100:103]
    v_mfma_f32_16x16x32_bf16 v[100:103], v[12:15], v[204:207], v[100:103]
    s_setprio 0
    ds_read_b128 v[28:31], v4 offset:15360
    s_waitcnt vmcnt(6)
    s_barrier
    ds_read_b128 v[12:15], v4 offset:16384
    v_max_f32 v39, 0, v39
    v_mul_f32 v44, v44, v9
    s_add_u32 s34, s38, 229376
    s_add_u32 m0, s32, 81920
    s_nop 0
    buffer_load_dwordx4 v3, s[16:19], s34 offen sc1 lds
    v_mul_f32 v45, v45, v9
    v_mul_f32 v46, v46, v9
    s_waitcnt lgkmcnt(3)
    v_mfma_f32_16x16x32_bf16 v[96:99], v[16:19], v[208:211], v[96:99]
    s_setprio 1
    v_mfma_f32_16x16x32_bf16 v[96:99], v[20:23], v[216:219], v[96:99]
    v_mfma_f32_16x16x32_bf16 v[100:103], v[16:19], v[212:215], v[100:103]
    v_mfma_f32_16x16x32_bf16 v[100:103], v[20:23], v[220:223], v[100:103]
    s_setprio 0
    ds_read_b128 v[16:19], v4 offset:17408
    ds_read_b128 v[20:23], v4 offset:18432
    v_mul_f32 v47, v47, v9
    v_mul_f32 v44, v36, v44
    v_mul_f32 v45, v37, v45
    v_mul_f32 v46, v38, v46
    ds_read_b128 v[104:107], v0 offset:576
    s_waitcnt lgkmcnt(4)
    v_mfma_f32_16x16x32_bf16 v[96:99], v[24:27], v[224:227], v[96:99]
    s_setprio 1
    v_mfma_f32_16x16x32_bf16 v[96:99], v[28:31], v[232:235], v[96:99]
    v_mfma_f32_16x16x32_bf16 v[100:103], v[24:27], v[228:231], v[100:103]
    v_mfma_f32_16x16x32_bf16 v[100:103], v[28:31], v[236:239], v[100:103]
    s_setprio 0
    ds_read_b128 v[24:27], v4 offset:19456
    ds_read_b128 v[28:31], v4 offset:20480
    v_mul_f32 v47, v39, v47
    v_cvt_pk_bf16_f32 v36, v44, v45
    s_add_u32 s34, s38, 237568
    s_add_u32 m0, s32, 90112
    s_nop 0
    buffer_load_dwordx4 v3, s[16:19], s34 offen sc1 lds
    v_cvt_pk_bf16_f32 v37, v46, v47
    v_max_f32 v48, 0, v48
    s_waitcnt lgkmcnt(2)
    v_mul_f32 v108, v104, v11
    v_mul_f32 v109, v105, v11
    v_mul_f32 v110, v106, v11
    v_mul_f32 v111, v107, v11
    v_mul_f32 v104, v104, v10
    v_mul_f32 v105, v105, v10
    v_mul_f32 v106, v106, v10
    v_mul_f32 v107, v107, v10
    v_mfma_f32_16x16x32_bf16 v[96:99], v[12:15], v[240:243], v[96:99]
    s_setprio 1
    v_mfma_f32_16x16x32_bf16 v[96:99], v[16:19], v[248:251], v[96:99]
    v_mfma_f32_16x16x32_bf16 v[100:103], v[12:15], v[244:247], v[100:103]
    v_mfma_f32_16x16x32_bf16 v[100:103], v[16:19], v[252:255], v[100:103]
    s_setprio 0
    ds_read_b128 v[12:15], v4 offset:21504
    ds_read_b128 v[16:19], v4 offset:22528
    v_max_f32 v49, 0, v49
    v_max_f32 v50, 0, v50
    v_max_f32 v51, 0, v51
    v_mul_f32 v56, v56, v8
    s_waitcnt lgkmcnt(3)
    v_mfma_f32_16x16x32_bf16 v[104:107], v[20:23], v[112:115], v[104:107]
    s_setprio 1
    v_mfma_f32_16x16x32_bf16 v[104:107], v[24:27], v[120:123], v[104:107]
    v_mfma_f32_16x16x32_bf16 v[108:111], v[20:23], v[116:119], v[108:111]
    v_mfma_f32_16x16x32_bf16 v[108:111], v[24:27], v[124:127], v[108:111]
    s_setprio 0
    ds_read_b128 v[20:23], v4 offset:23552
    ds_read_b128 v[24:27], v4 offset:24576
    v_mul_f32 v57, v57, v8
    v_mul_f32 v58, v58, v8
    v_mul_f32 v59, v59, v8
    v_mul_f32 v56, v48, v56
    s_waitcnt lgkmcnt(3)
    v_mfma_f32_16x16x32_bf16 v[104:107], v[28:31], v[128:131], v[104:107]
    s_setprio 1
    v_mfma_f32_16x16x32_bf16 v[104:107], v[12:15], v[136:139], v[104:107]
    v_mfma_f32_16x16x32_bf16 v[108:111], v[28:31], v[132:135], v[108:111]
    v_mfma_f32_16x16x32_bf16 v[108:111], v[12:15], v[140:143], v[108:111]
    s_setprio 0
    ds_read_b128 v[28:31], v4 offset:25600
    ds_read_b128 v[12:15], v4 offset:26624
    v_mul_f32 v57, v49, v57
    v_mul_f32 v58, v50, v58
    v_mul_f32 v59, v51, v59
    v_cvt_pk_bf16_f32 v34, v56, v57
    s_waitcnt lgkmcnt(3)
    v_mfma_f32_16x16x32_bf16 v[104:107], v[16:19], v[144:147], v[104:107]
    s_setprio 1
    v_mfma_f32_16x16x32_bf16 v[104:107], v[20:23], v[152:155], v[104:107]
    v_mfma_f32_16x16x32_bf16 v[108:111], v[16:19], v[148:151], v[108:111]
    v_mfma_f32_16x16x32_bf16 v[108:111], v[20:23], v[156:159], v[108:111]
    s_setprio 0
    ds_read_b128 v[16:19], v4 offset:27648
    ds_read_b128 v[20:23], v4 offset:28672
    v_cvt_pk_bf16_f32 v35, v58, v59
    buffer_store_dwordx4 v[32:35], v3, s[12:15], s35 offen offset:0 sc1
    v_max_f32 v52, 0, v52
    v_max_f32 v53, 0, v53
    s_waitcnt lgkmcnt(3)
    v_mfma_f32_16x16x32_bf16 v[104:107], v[24:27], v[160:163], v[104:107]
    s_setprio 1
    v_mfma_f32_16x16x32_bf16 v[104:107], v[28:31], v[168:171], v[104:107]
    v_mfma_f32_16x16x32_bf16 v[108:111], v[24:27], v[164:167], v[108:111]
    v_mfma_f32_16x16x32_bf16 v[108:111], v[28:31], v[172:175], v[108:111]
    s_setprio 0
    ds_read_b128 v[24:27], v4 offset:29696
    ds_read_b128 v[28:31], v4 offset:30720
    v_max_f32 v54, 0, v54
    v_max_f32 v55, 0, v55
    v_mul_f32 v60, v60, v9
    v_mul_f32 v61, v61, v9
    s_waitcnt lgkmcnt(3)
    v_mfma_f32_16x16x32_bf16 v[104:107], v[12:15], v[176:179], v[104:107]
    s_setprio 1
    v_mfma_f32_16x16x32_bf16 v[104:107], v[16:19], v[184:187], v[104:107]
    v_mfma_f32_16x16x32_bf16 v[108:111], v[12:15], v[180:183], v[108:111]
    v_mfma_f32_16x16x32_bf16 v[108:111], v[16:19], v[188:191], v[108:111]
    s_setprio 0
    ds_read_b128 v[12:15], v4 offset:31744
    s_waitcnt vmcnt(7)
    s_barrier
    ds_read_b128 v[16:19], v4 offset:32768
    v_mul_f32 v62, v62, v9
    v_mul_f32 v63, v63, v9
    s_add_u32 s34, s38, 245760
    s_add_u32 m0, s32, 98304
    s_nop 0
    buffer_load_dwordx4 v3, s[16:19], s34 offen sc1 lds
    v_mul_f32 v60, v52, v60
    v_mul_f32 v61, v53, v61
    s_waitcnt lgkmcnt(3)
    v_mfma_f32_16x16x32_bf16 v[104:107], v[20:23], v[192:195], v[104:107]
    s_setprio 1
    v_mfma_f32_16x16x32_bf16 v[104:107], v[24:27], v[200:203], v[104:107]
    v_mfma_f32_16x16x32_bf16 v[108:111], v[20:23], v[196:199], v[108:111]
    v_mfma_f32_16x16x32_bf16 v[108:111], v[24:27], v[204:207], v[108:111]
    s_setprio 0
    ds_read_b128 v[20:23], v4 offset:33792
    ds_read_b128 v[24:27], v4 offset:34816
    v_mul_f32 v62, v54, v62
    v_mul_f32 v63, v55, v63
    v_cvt_pk_bf16_f32 v38, v60, v61
    v_cvt_pk_bf16_f32 v39, v62, v63
    s_waitcnt lgkmcnt(3)
    v_mfma_f32_16x16x32_bf16 v[104:107], v[28:31], v[208:211], v[104:107]
    s_setprio 1
    v_mfma_f32_16x16x32_bf16 v[104:107], v[12:15], v[216:219], v[104:107]
    v_mfma_f32_16x16x32_bf16 v[108:111], v[28:31], v[212:215], v[108:111]
    v_mfma_f32_16x16x32_bf16 v[108:111], v[12:15], v[220:223], v[108:111]
    s_setprio 0
    ds_read_b128 v[28:31], v4 offset:35840
    ds_read_b128 v[12:15], v4 offset:36864
    buffer_store_dwordx4 v[36:39], v3, s[12:15], s36 offen offset:0 sc1
    v_max_f32 v64, 0, v64
    s_add_u32 s34, s38, 253952
    s_add_u32 m0, s32, 106496
    s_nop 0
    buffer_load_dwordx4 v3, s[16:19], s34 offen sc1 lds
    v_max_f32 v65, 0, v65
    v_max_f32 v66, 0, v66
    ds_read_b128 v[32:35], v0 offset:640
    s_waitcnt lgkmcnt(4)
    v_mfma_f32_16x16x32_bf16 v[104:107], v[16:19], v[224:227], v[104:107]
    s_setprio 1
    v_mfma_f32_16x16x32_bf16 v[104:107], v[20:23], v[232:235], v[104:107]
    v_mfma_f32_16x16x32_bf16 v[108:111], v[16:19], v[228:231], v[108:111]
    v_mfma_f32_16x16x32_bf16 v[108:111], v[20:23], v[236:239], v[108:111]
    s_setprio 0
    ds_read_b128 v[16:19], v4 offset:37888
    ds_read_b128 v[20:23], v4 offset:38912
    v_max_f32 v67, 0, v67
    v_mul_f32 v72, v72, v8
    v_mul_f32 v73, v73, v8
    v_mul_f32 v74, v74, v8
    s_waitcnt lgkmcnt(2)
    v_mul_f32 v36, v32, v11
    v_mul_f32 v37, v33, v11
    v_mul_f32 v38, v34, v11
    v_mul_f32 v39, v35, v11
    v_mul_f32 v32, v32, v10
    v_mul_f32 v33, v33, v10
    v_mul_f32 v34, v34, v10
    v_mul_f32 v35, v35, v10
    v_mfma_f32_16x16x32_bf16 v[104:107], v[24:27], v[240:243], v[104:107]
    s_setprio 1
    v_mfma_f32_16x16x32_bf16 v[104:107], v[28:31], v[248:251], v[104:107]
    v_mfma_f32_16x16x32_bf16 v[108:111], v[24:27], v[244:247], v[108:111]
    v_mfma_f32_16x16x32_bf16 v[108:111], v[28:31], v[252:255], v[108:111]
    s_setprio 0
    ds_read_b128 v[24:27], v4 offset:39936
    ds_read_b128 v[28:31], v4 offset:40960
    v_mul_f32 v75, v75, v8
    v_mul_f32 v72, v64, v72
    v_mul_f32 v73, v65, v73
    v_mul_f32 v74, v66, v74
    s_waitcnt lgkmcnt(3)
    v_mfma_f32_16x16x32_bf16 v[32:35], v[12:15], v[112:115], v[32:35]
    s_setprio 1
    v_mfma_f32_16x16x32_bf16 v[32:35], v[16:19], v[120:123], v[32:35]
    v_mfma_f32_16x16x32_bf16 v[36:39], v[12:15], v[116:119], v[36:39]
    v_mfma_f32_16x16x32_bf16 v[36:39], v[16:19], v[124:127], v[36:39]
    s_setprio 0
    ds_read_b128 v[12:15], v4 offset:41984
    ds_read_b128 v[16:19], v4 offset:43008
    v_mul_f32 v75, v67, v75
    v_cvt_pk_bf16_f32 v64, v72, v73
    v_cvt_pk_bf16_f32 v65, v74, v75
    v_max_f32 v68, 0, v68
    s_waitcnt lgkmcnt(3)
    v_mfma_f32_16x16x32_bf16 v[32:35], v[20:23], v[128:131], v[32:35]
    s_setprio 1
    v_mfma_f32_16x16x32_bf16 v[32:35], v[24:27], v[136:139], v[32:35]
    v_mfma_f32_16x16x32_bf16 v[36:39], v[20:23], v[132:135], v[36:39]
    v_mfma_f32_16x16x32_bf16 v[36:39], v[24:27], v[140:143], v[36:39]
    s_setprio 0
    ds_read_b128 v[20:23], v4 offset:44032
    ds_read_b128 v[24:27], v4 offset:45056
    v_max_f32 v69, 0, v69
    v_max_f32 v70, 0, v70
    v_max_f32 v71, 0, v71
    v_mul_f32 v76, v76, v9
    s_waitcnt lgkmcnt(3)
    v_mfma_f32_16x16x32_bf16 v[32:35], v[28:31], v[144:147], v[32:35]
    s_setprio 1
    v_mfma_f32_16x16x32_bf16 v[32:35], v[12:15], v[152:155], v[32:35]
    v_mfma_f32_16x16x32_bf16 v[36:39], v[28:31], v[148:151], v[36:39]
    v_mfma_f32_16x16x32_bf16 v[36:39], v[12:15], v[156:159], v[36:39]
    s_setprio 0
    ds_read_b128 v[28:31], v4 offset:46080
    ds_read_b128 v[12:15], v4 offset:47104
    v_mul_f32 v77, v77, v9
    v_mul_f32 v78, v78, v9
    v_mul_f32 v79, v79, v9
    v_mul_f32 v76, v68, v76
    s_waitcnt lgkmcnt(3)
    v_mfma_f32_16x16x32_bf16 v[32:35], v[16:19], v[160:163], v[32:35]
    s_setprio 1
    v_mfma_f32_16x16x32_bf16 v[32:35], v[20:23], v[168:171], v[32:35]
    v_mfma_f32_16x16x32_bf16 v[36:39], v[16:19], v[164:167], v[36:39]
    v_mfma_f32_16x16x32_bf16 v[36:39], v[20:23], v[172:175], v[36:39]
    s_setprio 0
    ds_read_b128 v[16:19], v4 offset:48128
    s_waitcnt vmcnt(8)
    s_barrier
    ds_read_b128 v[20:23], v4 offset:49152
    v_mul_f32 v77, v69, v77
    v_mul_f32 v78, v70, v78
    s_add_u32 s34, s38, 262144
    s_add_u32 m0, s32, 114688
    s_nop 0
    buffer_load_dwordx4 v3, s[16:19], s34 offen sc1 lds
    v_mul_f32 v79, v71, v79
    v_cvt_pk_bf16_f32 v68, v76, v77
    s_waitcnt lgkmcnt(3)
    v_mfma_f32_16x16x32_bf16 v[32:35], v[24:27], v[176:179], v[32:35]
    s_setprio 1
    v_mfma_f32_16x16x32_bf16 v[32:35], v[28:31], v[184:187], v[32:35]
    v_mfma_f32_16x16x32_bf16 v[36:39], v[24:27], v[180:183], v[36:39]
    v_mfma_f32_16x16x32_bf16 v[36:39], v[28:31], v[188:191], v[36:39]
    s_setprio 0
    ds_read_b128 v[24:27], v4 offset:50176
    ds_read_b128 v[28:31], v4 offset:51200
    v_cvt_pk_bf16_f32 v69, v78, v79
    v_max_f32 v80, 0, v80
    v_max_f32 v81, 0, v81
    v_max_f32 v82, 0, v82
    s_waitcnt lgkmcnt(3)
    v_mfma_f32_16x16x32_bf16 v[32:35], v[12:15], v[192:195], v[32:35]
    s_setprio 1
    v_mfma_f32_16x16x32_bf16 v[32:35], v[16:19], v[200:203], v[32:35]
    v_mfma_f32_16x16x32_bf16 v[36:39], v[12:15], v[196:199], v[36:39]
    v_mfma_f32_16x16x32_bf16 v[36:39], v[16:19], v[204:207], v[36:39]
    s_setprio 0
    ds_read_b128 v[12:15], v4 offset:52224
    ds_read_b128 v[16:19], v4 offset:53248
    v_max_f32 v83, 0, v83
    v_mul_f32 v88, v88, v8
    s_add_u32 s34, s38, 270336
    s_add_u32 m0, s32, 122880
    s_nop 0
    buffer_load_dwordx4 v3, s[16:19], s34 offen sc1 lds
    v_mul_f32 v89, v89, v8
    v_mul_f32 v90, v90, v8
    s_waitcnt lgkmcnt(3)
    v_mfma_f32_16x16x32_bf16 v[32:35], v[20:23], v[208:211], v[32:35]
    s_setprio 1
    v_mfma_f32_16x16x32_bf16 v[32:35], v[24:27], v[216:219], v[32:35]
    v_mfma_f32_16x16x32_bf16 v[36:39], v[20:23], v[212:215], v[36:39]
    v_mfma_f32_16x16x32_bf16 v[36:39], v[24:27], v[220:223], v[36:39]
    s_setprio 0
    ds_read_b128 v[20:23], v4 offset:54272
    ds_read_b128 v[24:27], v4 offset:55296
    v_mul_f32 v91, v91, v8
    v_mul_f32 v88, v80, v88
    v_mul_f32 v89, v81, v89
    v_mul_f32 v90, v82, v90
    ds_read_b128 v[40:43], v0 offset:704
    s_waitcnt lgkmcnt(4)
    v_mfma_f32_16x16x32_bf16 v[32:35], v[28:31], v[224:227], v[32:35]
    s_setprio 1
    v_mfma_f32_16x16x32_bf16 v[32:35], v[12:15], v[232:235], v[32:35]
    v_mfma_f32_16x16x32_bf16 v[36:39], v[28:31], v[228:231], v[36:39]
    v_mfma_f32_16x16x32_bf16 v[36:39], v[12:15], v[236:239], v[36:39]
    s_setprio 0
    ds_read_b128 v[28:31], v4 offset:56320
    ds_read_b128 v[12:15], v4 offset:57344
    v_mul_f32 v91, v83, v91
    v_cvt_pk_bf16_f32 v66, v88, v89
    v_cvt_pk_bf16_f32 v67, v90, v91
    buffer_store_dwordx4 v[64:67], v3, s[12:15], s35 offen offset:1024 sc1
    s_waitcnt lgkmcnt(2)
    v_mul_f32 v44, v40, v11
    v_mul_f32 v45, v41, v11
    v_mul_f32 v46, v42, v11
    v_mul_f32 v47, v43, v11
    v_mul_f32 v40, v40, v10
    v_mul_f32 v41, v41, v10
    v_mul_f32 v42, v42, v10
    v_mul_f32 v43, v43, v10
    v_mfma_f32_16x16x32_bf16 v[32:35], v[16:19], v[240:243], v[32:35]
    s_setprio 1
    v_mfma_f32_16x16x32_bf16 v[32:35], v[20:23], v[248:251], v[32:35]
    v_mfma_f32_16x16x32_bf16 v[36:39], v[16:19], v[244:247], v[36:39]
    v_mfma_f32_16x16x32_bf16 v[36:39], v[20:23], v[252:255], v[36:39]
    s_setprio 0
    ds_read_b128 v[16:19], v4 offset:58368
    ds_read_b128 v[20:23], v4 offset:59392
    v_max_f32 v84, 0, v84
    v_max_f32 v85, 0, v85
    v_max_f32 v86, 0, v86
    v_max_f32 v87, 0, v87
    s_waitcnt lgkmcnt(3)
    v_mfma_f32_16x16x32_bf16 v[40:43], v[24:27], v[112:115], v[40:43]
    s_setprio 1
    v_mfma_f32_16x16x32_bf16 v[40:43], v[28:31], v[120:123], v[40:43]
    v_mfma_f32_16x16x32_bf16 v[44:47], v[24:27], v[116:119], v[44:47]
    v_mfma_f32_16x16x32_bf16 v[44:47], v[28:31], v[124:127], v[44:47]
    s_setprio 0
    ds_read_b128 v[24:27], v4 offset:60416
    ds_read_b128 v[28:31], v4 offset:61440
    v_mul_f32 v92, v92, v9
    v_mul_f32 v93, v93, v9
    v_mul_f32 v94, v94, v9
    v_mul_f32 v95, v95, v9
    s_waitcnt lgkmcnt(3)
    v_mfma_f32_16x16x32_bf16 v[40:43], v[12:15], v[128:131], v[40:43]
    s_setprio 1
    v_mfma_f32_16x16x32_bf16 v[40:43], v[16:19], v[136:139], v[40:43]
    v_mfma_f32_16x16x32_bf16 v[44:47], v[12:15], v[132:135], v[44:47]
    v_mfma_f32_16x16x32_bf16 v[44:47], v[16:19], v[140:143], v[44:47]
    s_setprio 0
    ds_read_b128 v[12:15], v4 offset:62464
    ds_read_b128 v[16:19], v4 offset:63488
    s_bfe_u32 s48, s2, 0x20001
    s_and_b32 s49, s2, 1
    s_lshl_b32 s49, s49, 3
    s_bfe_u32 s50, s2, 0x30003
    s_add_u32 s49, s49, s50
    s_lshr_b32 s50, s2, 6
    s_and_b32 s51, s24, 3
    s_lshr_b32 s52, s24, 2
    s_lshl_b32 s28, s50, 2
    s_add_u32 s28, s28, s48
    s_lshl_b32 s28, s28, 1
    s_add_u32 s28, s28, s52
    s_mul_i32 s28, s28, 165888
    s_add_u32 s28, s28, 25165824
    s_add_u32 s20, s8, s28
    s_addc_u32 s21, s9, 0
    s_and_b32 s21, s21, 0xffff
    s_mov_b32 s22, 165888
    s_mov_b32 s23, 0x20000
    s_lshl_b32 s53, s51, 10
    s_mul_i32 s54, s52, 12288
    s_add_u32 s55, s54, s53
    s_lshl_b32 s29, s49, 2
    s_add_u32 s29, s29, s51
    s_mul_i32 s46, s29, 294912
    s_lshl_b32 s30, s48, 1
    s_add_u32 s30, s30, s52
    s_mul_i32 s30, s30, 18432
    s_add_u32 s46, s46, s30
    s_add_u32 s46, s46, 31457280
    s_mul_i32 s47, s52, 147456
    s_sub_u32 s43, 147456, s47
    s_add_u32 s43, s43, s46
    s_add_u32 s46, s46, s47
    s_lshr_b32 s42, s49, 1
    s_lshl_b32 s42, s42, 2
    s_add_u32 s42, s42, s48
    s_lshl_b32 s42, s42, 10
    s_add_u32 s63, s42, 68190208
    s_add_u32 s42, s42, 68157440
    v_mul_f32 v92, v84, v92
    v_mul_f32 v93, v85, v93
    v_mul_f32 v94, v86, v94
    v_mul_f32 v95, v87, v95
    s_waitcnt lgkmcnt(3)
    v_mfma_f32_16x16x32_bf16 v[40:43], v[20:23], v[144:147], v[40:43]
    s_setprio 1
    v_mfma_f32_16x16x32_bf16 v[40:43], v[24:27], v[152:155], v[40:43]
    v_mfma_f32_16x16x32_bf16 v[44:47], v[20:23], v[148:151], v[44:47]
    v_mfma_f32_16x16x32_bf16 v[44:47], v[24:27], v[156:159], v[44:47]
    s_setprio 0
    ds_read_b128 v[20:23], v4 offset:64512
    s_waitcnt vmcnt(9)
    s_barrier
    ds_read_b128 v[24:27], v5 offset:0
    v_cvt_pk_bf16_f32 v70, v92, v93
    v_cvt_pk_bf16_f32 v71, v94, v95
    s_add_u32 s34, s38, 278528
    s_add_u32 m0, s32, 131072
    s_nop 0
    buffer_load_dwordx4 v3, s[16:19], s34 offen sc1 lds
    buffer_store_dwordx4 v[68:71], v3, s[12:15], s36 offen offset:1024 sc1
    v_max_f32 v96, 0, v96
    s_waitcnt lgkmcnt(3)
    v_mfma_f32_16x16x32_bf16 v[40:43], v[28:31], v[160:163], v[40:43]
    s_setprio 1
    v_mfma_f32_16x16x32_bf16 v[40:43], v[12:15], v[168:171], v[40:43]
    v_mfma_f32_16x16x32_bf16 v[44:47], v[28:31], v[164:167], v[44:47]
    v_mfma_f32_16x16x32_bf16 v[44:47], v[12:15], v[172:175], v[44:47]
    s_setprio 0
    ds_read_b128 v[28:31], v5 offset:1024
    ds_read_b128 v[12:15], v5 offset:2048
    v_max_f32 v97, 0, v97
    v_max_f32 v98, 0, v98
    v_max_f32 v99, 0, v99
    v_mul_f32 v104, v104, v8
    s_waitcnt lgkmcnt(3)
    v_mfma_f32_16x16x32_bf16 v[40:43], v[16:19], v[176:179], v[40:43]
    s_setprio 1
    v_mfma_f32_16x16x32_bf16 v[40:43], v[20:23], v[184:187], v[40:43]
    v_mfma_f32_16x16x32_bf16 v[44:47], v[16:19], v[180:183], v[44:47]
    v_mfma_f32_16x16x32_bf16 v[44:47], v[20:23], v[188:191], v[44:47]
    s_setprio 0
    ds_read_b128 v[16:19], v5 offset:3072
    ds_read_b128 v[20:23], v5 offset:4096
    v_mul_f32 v105, v105, v8
    v_mul_f32 v106, v106, v8
    s_add_u32 s34, s38, 286720
    s_add_u32 m0, s32, 139264
    s_nop 0
    buffer_load_dwordx4 v3, s[16:19], s34 offen sc1 lds
    v_mul_f32 v107, v107, v8
    v_mul_f32 v104, v96, v104
    s_waitcnt lgkmcnt(3)
    v_mfma_f32_16x16x32_bf16 v[40:43], v[24:27], v[192:195], v[40:43]
    s_setprio 1
    v_mfma_f32_16x16x32_bf16 v[40:43], v[28:31], v[200:203], v[40:43]
    v_mfma_f32_16x16x32_bf16 v[44:47], v[24:27], v[196:199], v[44:47]
    v_mfma_f32_16x16x32_bf16 v[44:47], v[28:31], v[204:207], v[44:47]
    s_setprio 0
    ds_read_b128 v[24:27], v5 offset:5120
    ds_read_b128 v[28:31], v5 offset:6144
    v_mul_f32 v105, v97, v105
    v_mul_f32 v106, v98, v106
    v_mul_f32 v107, v99, v107
    v_cvt_pk_bf16_f32 v96, v104, v105
    s_waitcnt lgkmcnt(3)
    v_mfma_f32_16x16x32_bf16 v[40:43], v[12:15], v[208:211], v[40:43]
    s_setprio 1
    v_mfma_f32_16x16x32_bf16 v[40:43], v[16:19], v[216:219], v[40:43]
    v_mfma_f32_16x16x32_bf16 v[44:47], v[12:15], v[212:215], v[44:47]
    v_mfma_f32_16x16x32_bf16 v[44:47], v[16:19], v[220:223], v[44:47]
    s_setprio 0
    ds_read_b128 v[12:15], v5 offset:7168
    ds_read_b128 v[16:19], v5 offset:8192
    v_cvt_pk_bf16_f32 v97, v106, v107
    v_max_f32 v100, 0, v100
    v_max_f32 v101, 0, v101
    v_max_f32 v102, 0, v102
    ds_read_b128 v[48:51], v0 offset:768
    s_waitcnt lgkmcnt(4)
    v_mfma_f32_16x16x32_bf16 v[40:43], v[20:23], v[224:227], v[40:43]
    s_setprio 1
    v_mfma_f32_16x16x32_bf16 v[40:43], v[24:27], v[232:235], v[40:43]
    v_mfma_f32_16x16x32_bf16 v[44:47], v[20:23], v[228:231], v[44:47]
    v_mfma_f32_16x16x32_bf16 v[44:47], v[24:27], v[236:239], v[44:47]
    s_setprio 0
    ds_read_b128 v[20:23], v5 offset:9216
    ds_read_b128 v[24:27], v5 offset:10240
    v_max_f32 v103, 0, v103
    v_mul_f32 v108, v108, v9
    v_mul_f32 v109, v109, v9
    v_mul_f32 v110, v110, v9
    s_waitcnt lgkmcnt(2)
    v_mul_f32 v52, v48, v11
    v_mul_f32 v53, v49, v11
    v_mul_f32 v54, v50, v11
    v_mul_f32 v55, v51, v11
    v_mul_f32 v48, v48, v10
    v_mul_f32 v49, v49, v10
    v_mul_f32 v50, v50, v10
    v_mul_f32 v51, v51, v10
    v_mfma_f32_16x16x32_bf16 v[40:43], v[28:31], v[240:243], v[40:43]
    s_setprio 1
    v_mfma_f32_16x16x32_bf16 v[40:43], v[12:15], v[248:251], v[40:43]
    v_mfma_f32_16x16x32_bf16 v[44:47], v[28:31], v[244:247], v[44:47]
    v_mfma_f32_16x16x32_bf16 v[44:47], v[12:15], v[252:255], v[44:47]
    s_setprio 0
    ds_read_b128 v[28:31], v5 offset:11264
    ds_read_b128 v[12:15], v5 offset:12288
    v_mul_f32 v111, v111, v9
    v_mul_f32 v108, v100, v108
    v_mul_f32 v109, v101, v109
    v_mul_f32 v110, v102, v110
    s_waitcnt lgkmcnt(3)
    v_mfma_f32_16x16x32_bf16 v[48:51], v[16:19], v[112:115], v[48:51]
    s_setprio 1
    v_mfma_f32_16x16x32_bf16 v[48:51], v[20:23], v[120:123], v[48:51]
    v_mfma_f32_16x16x32_bf16 v[52:55], v[16:19], v[116:119], v[52:55]
    v_mfma_f32_16x16x32_bf16 v[52:55], v[20:23], v[124:127], v[52:55]
    s_setprio 0
    ds_read_b128 v[16:19], v5 offset:13312
    ds_read_b128 v[20:23], v5 offset:14336
    v_mul_f32 v111, v103, v111
    v_cvt_pk_bf16_f32 v100, v108, v109
    v_cvt_pk_bf16_f32 v101, v110, v111
    s_waitcnt lgkmcnt(3)
    v_mfma_f32_16x16x32_bf16 v[48:51], v[24:27], v[128:131], v[48:51]
    s_setprio 1
    v_mfma_f32_16x16x32_bf16 v[48:51], v[28:31], v[136:139], v[48:51]
    v_mfma_f32_16x16x32_bf16 v[52:55], v[24:27], v[132:135], v[52:55]
    v_mfma_f32_16x16x32_bf16 v[52:55], v[28:31], v[140:143], v[52:55]
    s_setprio 0
    ds_read_b128 v[24:27], v5 offset:15360
    s_waitcnt vmcnt(10)
    s_barrier
    ds_read_b128 v[28:31], v5 offset:16384
    v_max_f32 v32, 0, v32
    v_max_f32 v33, 0, v33
    s_add_u32 s34, s41, 294912
    s_add_u32 m0, s32, 0
    s_nop 0
    buffer_load_dwordx4 v3, s[16:19], s34 offen sc1 lds
    v_max_f32 v34, 0, v34
    v_max_f32 v35, 0, v35
    s_waitcnt lgkmcnt(3)
    v_mfma_f32_16x16x32_bf16 v[48:51], v[12:15], v[144:147], v[48:51]
    s_setprio 1
    v_mfma_f32_16x16x32_bf16 v[48:51], v[16:19], v[152:155], v[48:51]
    v_mfma_f32_16x16x32_bf16 v[52:55], v[12:15], v[148:151], v[52:55]
    v_mfma_f32_16x16x32_bf16 v[52:55], v[16:19], v[156:159], v[52:55]
    s_setprio 0
    ds_read_b128 v[12:15], v5 offset:17408
    ds_read_b128 v[16:19], v5 offset:18432
    v_mul_f32 v40, v40, v8
    v_mul_f32 v41, v41, v8
    v_mul_f32 v42, v42, v8
    v_mul_f32 v43, v43, v8
    s_waitcnt lgkmcnt(3)
    v_mfma_f32_16x16x32_bf16 v[48:51], v[20:23], v[160:163], v[48:51]
    s_setprio 1
    v_mfma_f32_16x16x32_bf16 v[48:51], v[24:27], v[168:171], v[48:51]
    v_mfma_f32_16x16x32_bf16 v[52:55], v[20:23], v[164:167], v[52:55]
    v_mfma_f32_16x16x32_bf16 v[52:55], v[24:27], v[172:175], v[52:55]
    s_setprio 0
    ds_read_b128 v[20:23], v5 offset:19456
    ds_read_b128 v[24:27], v5 offset:20480
    v_mul_f32 v40, v32, v40
    v_mul_f32 v41, v33, v41
    s_add_u32 s34, s41, 303104
    s_add_u32 m0, s32, 8192
    s_nop 0
    buffer_load_dwordx4 v3, s[16:19], s34 offen sc1 lds
    v_mul_f32 v42, v34, v42
    v_mul_f32 v43, v35, v43
    s_waitcnt lgkmcnt(3)
    v_mfma_f32_16x16x32_bf16 v[48:51], v[28:31], v[176:179], v[48:51]
    s_setprio 1
    v_mfma_f32_16x16x32_bf16 v[48:51], v[12:15], v[184:187], v[48:51]
    v_mfma_f32_16x16x32_bf16 v[52:55], v[28:31], v[180:183], v[52:55]
    v_mfma_f32_16x16x32_bf16 v[52:55], v[12:15], v[188:191], v[52:55]
    s_setprio 0
    ds_read_b128 v[28:31], v5 offset:21504
    ds_read_b128 v[12:15], v5 offset:22528
    v_cvt_pk_bf16_f32 v98, v40, v41
    v_cvt_pk_bf16_f32 v99, v42, v43
    buffer_store_dwordx4 v[96:99], v3, s[12:15], s35 offen offset:2048 sc1
    v_max_f32 v36, 0, v36
    s_waitcnt lgkmcnt(3)
    v_mfma_f32_16x16x32_bf16 v[48:51], v[16:19], v[192:195], v[48:51]
    s_setprio 1
    v_mfma_f32_16x16x32_bf16 v[48:51], v[20:23], v[200:203], v[48:51]
    v_mfma_f32_16x16x32_bf16 v[52:55], v[16:19], v[196:199], v[52:55]
    v_mfma_f32_16x16x32_bf16 v[52:55], v[20:23], v[204:207], v[52:55]
    s_setprio 0
    ds_read_b128 v[16:19], v5 offset:23552
    ds_read_b128 v[20:23], v5 offset:24576
    v_max_f32 v37, 0, v37
    v_max_f32 v38, 0, v38
    v_max_f32 v39, 0, v39
    v_mul_f32 v44, v44, v9
    s_waitcnt lgkmcnt(3)
    v_mfma_f32_16x16x32_bf16 v[48:51], v[24:27], v[208:211], v[48:51]
    s_setprio 1
    v_mfma_f32_16x16x32_bf16 v[48:51], v[28:31], v[216:219], v[48:51]
    v_mfma_f32_16x16x32_bf16 v[52:55], v[24:27], v[212:215], v[52:55]
    v_mfma_f32_16x16x32_bf16 v[52:55], v[28:31], v[220:223], v[52:55]
    s_setprio 0
    ds_read_b128 v[24:27], v5 offset:25600
    ds_read_b128 v[28:31], v5 offset:26624
    v_mul_f32 v45, v45, v9
    v_mul_f32 v46, v46, v9
    v_mul_f32 v47, v47, v9
    v_mul_f32 v44, v36, v44
    ds_read_b128 v[56:59], v0 offset:832
    s_waitcnt lgkmcnt(4)
    v_mfma_f32_16x16x32_bf16 v[48:51], v[12:15], v[224:227], v[48:51]
    s_setprio 1
    v_mfma_f32_16x16x32_bf16 v[48:51], v[16:19], v[232:235], v[48:51]
    v_mfma_f32_16x16x32_bf16 v[52:55], v[12:15], v[228:231], v[52:55]
    v_mfma_f32_16x16x32_bf16 v[52:55], v[16:19], v[236:239], v[52:55]
    s_setprio 0
    ds_read_b128 v[12:15], v5 offset:27648
    ds_read_b128 v[16:19], v5 offset:28672
    v_mul_f32 v45, v37, v45
    v_mul_f32 v46, v38, v46
    v_mul_f32 v47, v39, v47
    v_cvt_pk_bf16_f32 v102, v44, v45
    s_waitcnt lgkmcnt(2)
    v_mul_f32 v60, v56, v11
    v_mul_f32 v61, v57, v11
    v_mul_f32 v62, v58, v11
    v_mul_f32 v63, v59, v11
    v_mul_f32 v56, v56, v10
    v_mul_f32 v57, v57, v10
    v_mul_f32 v58, v58, v10
    v_mul_f32 v59, v59, v10
    v_mfma_f32_16x16x32_bf16 v[48:51], v[20:23], v[240:243], v[48:51]
    s_setprio 1
    v_mfma_f32_16x16x32_bf16 v[48:51], v[24:27], v[248:251], v[48:51]
    v_mfma_f32_16x16x32_bf16 v[52:55], v[20:23], v[244:247], v[52:55]
    v_mfma_f32_16x16x32_bf16 v[52:55], v[24:27], v[252:255], v[52:55]
    s_setprio 0
    ds_read_b128 v[20:23], v5 offset:29696
    ds_read_b128 v[24:27], v5 offset:30720
    v_cvt_pk_bf16_f32 v103, v46, v47
    buffer_store_dwordx4 v[100:103], v3, s[12:15], s36 offen offset:2048 sc1
    s_waitcnt lgkmcnt(3)
    v_mfma_f32_16x16x32_bf16 v[56:59], v[28:31], v[112:115], v[56:59]
    s_setprio 1
    v_mfma_f32_16x16x32_bf16 v[56:59], v[12:15], v[120:123], v[56:59]
    v_mfma_f32_16x16x32_bf16 v[60:63], v[28:31], v[116:119], v[60:63]
    v_mfma_f32_16x16x32_bf16 v[60:63], v[12:15], v[124:127], v[60:63]
    s_setprio 0
    ds_read_b128 v[28:31], v5 offset:31744
    s_waitcnt vmcnt(10)
    s_barrier
    ds_read_b128 v[12:15], v5 offset:32768
    s_add_u32 s34, s41, 311296
    s_add_u32 m0, s32, 16384
    s_nop 0
    buffer_load_dwordx4 v3, s[16:19], s34 offen sc1 lds
    s_waitcnt lgkmcnt(3)
    v_mfma_f32_16x16x32_bf16 v[56:59], v[16:19], v[128:131], v[56:59]
    s_setprio 1
    v_mfma_f32_16x16x32_bf16 v[56:59], v[20:23], v[136:139], v[56:59]
    v_mfma_f32_16x16x32_bf16 v[60:63], v[16:19], v[132:135], v[60:63]
    v_mfma_f32_16x16x32_bf16 v[60:63], v[20:23], v[140:143], v[60:63]
    s_setprio 0
    ds_read_b128 v[16:19], v5 offset:33792
    ds_read_b128 v[20:23], v5 offset:34816
    s_add_u32 s34, s53, 0
    s_add_u32 m0, s55, 49152
    s_nop 0
    buffer_load_dwordx4 v3, s[20:23], s34 offen sc1 lds
    s_waitcnt lgkmcnt(3)
    v_mfma_f32_16x16x32_bf16 v[56:59], v[24:27], v[144:147], v[56:59]
    s_setprio 1
    v_mfma_f32_16x16x32_bf16 v[56:59], v[28:31], v[152:155], v[56:59]
    v_mfma_f32_16x16x32_bf16 v[60:63], v[24:27], v[148:151], v[60:63]
    v_mfma_f32_16x16x32_bf16 v[60:63], v[28:31], v[156:159], v[60:63]
    s_setprio 0
    ds_read_b128 v[24:27], v5 offset:35840
    ds_read_b128 v[28:31], v5 offset:36864
    s_add_u32 s34, s41, 319488
    s_add_u32 m0, s32, 24576
    s_nop 0
    buffer_load_dwordx4 v3, s[16:19], s34 offen sc1 lds
    s_waitcnt lgkmcnt(3)
    v_mfma_f32_16x16x32_bf16 v[56:59], v[12:15], v[160:163], v[56:59]
    s_setprio 1
    v_mfma_f32_16x16x32_bf16 v[56:59], v[16:19], v[168:171], v[56:59]
    v_mfma_f32_16x16x32_bf16 v[60:63], v[12:15], v[164:167], v[60:63]
    v_mfma_f32_16x16x32_bf16 v[60:63], v[16:19], v[172:175], v[60:63]
    s_setprio 0
    ds_read_b128 v[12:15], v5 offset:37888
    ds_read_b128 v[16:19], v5 offset:38912
    s_add_u32 s34, s53, 4096
    s_add_u32 m0, s55, 53248
    s_nop 0
    buffer_load_dwordx4 v3, s[20:23], s34 offen sc1 lds
    s_waitcnt lgkmcnt(3)
    v_mfma_f32_16x16x32_bf16 v[56:59], v[20:23], v[176:179], v[56:59]
    s_setprio 1
    v_mfma_f32_16x16x32_bf16 v[56:59], v[24:27], v[184:187], v[56:59]
    v_mfma_f32_16x16x32_bf16 v[60:63], v[20:23], v[180:183], v[60:63]
    v_mfma_f32_16x16x32_bf16 v[60:63], v[24:27], v[188:191], v[60:63]
    s_setprio 0
    ds_read_b128 v[20:23], v5 offset:39936
    ds_read_b128 v[24:27], v5 offset:40960
    s_waitcnt lgkmcnt(3)
    v_mfma_f32_16x16x32_bf16 v[56:59], v[28:31], v[192:195], v[56:59]
    s_setprio 1
    v_mfma_f32_16x16x32_bf16 v[56:59], v[12:15], v[200:203], v[56:59]
    v_mfma_f32_16x16x32_bf16 v[60:63], v[28:31], v[196:199], v[60:63]
    v_mfma_f32_16x16x32_bf16 v[60:63], v[12:15], v[204:207], v[60:63]
    s_setprio 0
    ds_read_b128 v[28:31], v5 offset:41984
    ds_read_b128 v[12:15], v5 offset:43008
    s_add_u32 s34, s53, 8192
    s_add_u32 m0, s55, 57344
    s_nop 0
    buffer_load_dwordx4 v3, s[20:23], s34 offen sc1 lds
    s_waitcnt lgkmcnt(3)
    v_mfma_f32_16x16x32_bf16 v[56:59], v[16:19], v[208:211], v[56:59]
    s_setprio 1
    v_mfma_f32_16x16x32_bf16 v[56:59], v[20:23], v[216:219], v[56:59]
    v_mfma_f32_16x16x32_bf16 v[60:63], v[16:19], v[212:215], v[60:63]
    v_mfma_f32_16x16x32_bf16 v[60:63], v[20:23], v[220:223], v[60:63]
    s_setprio 0
    ds_read_b128 v[16:19], v5 offset:44032
    ds_read_b128 v[20:23], v5 offset:45056
    ds_read_b128 v[64:67], v0 offset:896
    s_waitcnt lgkmcnt(4)
    v_mfma_f32_16x16x32_bf16 v[56:59], v[24:27], v[224:227], v[56:59]
    s_setprio 1
    v_mfma_f32_16x16x32_bf16 v[56:59], v[28:31], v[232:235], v[56:59]
    v_mfma_f32_16x16x32_bf16 v[60:63], v[24:27], v[228:231], v[60:63]
    v_mfma_f32_16x16x32_bf16 v[60:63], v[28:31], v[236:239], v[60:63]
    s_setprio 0
    ds_read_b128 v[24:27], v5 offset:46080
    ds_read_b128 v[28:31], v5 offset:47104
    s_waitcnt lgkmcnt(2)
    v_mul_f32 v68, v64, v11
    v_mul_f32 v69, v65, v11
    v_mul_f32 v70, v66, v11
    v_mul_f32 v71, v67, v11
    v_mul_f32 v64, v64, v10
    v_mul_f32 v65, v65, v10
    v_mul_f32 v66, v66, v10
    v_mul_f32 v67, v67, v10
    v_mfma_f32_16x16x32_bf16 v[56:59], v[12:15], v[240:243], v[56:59]
    s_setprio 1
    v_mfma_f32_16x16x32_bf16 v[56:59], v[16:19], v[248:251], v[56:59]
    v_mfma_f32_16x16x32_bf16 v[60:63], v[12:15], v[244:247], v[60:63]
    v_mfma_f32_16x16x32_bf16 v[60:63], v[16:19], v[252:255], v[60:63]
    s_setprio 0
    ds_read_b128 v[12:15], v5 offset:48128
    s_waitcnt vmcnt(5)
    s_barrier
    s_lshl_b32 s33, s45, 5
    s_add_u32 s33, s33, s44
    s_lshl_b32 s33, s33, 7
    s_add_u32 s56, s33, 68157440
    s_cmp_eq_u32 s24, 0
    s_cselect_b32 s56, s56, 2146435072
    v_mov_b32 v1, 1
    s_mov_b64 exec, 1
    buffer_store_dword v1, v3, s[12:15], s56 offen sc1
    s_mov_b64 exec, -1
    ds_read_b128 v[16:19], v5 offset:49152
    s_add_u32 s34, s41, 327680
    s_cmp_lt_u32 s24, 4
    s_cselect_b32 s34, s34, 2146435072
    s_add_u32 m0, s32, 32768
    s_nop 0
    buffer_load_dwordx4 v3, s[16:19], s34 offen sc1 lds
    s_waitcnt lgkmcnt(3)
    v_mfma_f32_16x16x32_bf16 v[64:67], v[20:23], v[112:115], v[64:67]
    s_setprio 1
    v_mfma_f32_16x16x32_bf16 v[64:67], v[24:27], v[120:123], v[64:67]
    v_mfma_f32_16x16x32_bf16 v[68:71], v[20:23], v[116:119], v[68:71]
    v_mfma_f32_16x16x32_bf16 v[68:71], v[24:27], v[124:127], v[68:71]
    s_setprio 0
    ds_read_b128 v[20:23], v5 offset:50176
    ds_read_b128 v[24:27], v5 offset:51200
    s_add_u32 s34, s53, 12288
    s_add_u32 m0, s55, 73728
    s_nop 0
    buffer_load_dwordx4 v3, s[20:23], s34 offen sc1 lds
    s_waitcnt lgkmcnt(3)
    v_mfma_f32_16x16x32_bf16 v[64:67], v[28:31], v[128:131], v[64:67]
    s_setprio 1
    v_mfma_f32_16x16x32_bf16 v[64:67], v[12:15], v[136:139], v[64:67]
    v_mfma_f32_16x16x32_bf16 v[68:71], v[28:31], v[132:135], v[68:71]
    v_mfma_f32_16x16x32_bf16 v[68:71], v[12:15], v[140:143], v[68:71]
    s_setprio 0
    ds_read_b128 v[28:31], v5 offset:52224
    ds_read_b128 v[12:15], v5 offset:53248
    v_max_f32 v48, 0, v48
    v_max_f32 v49, 0, v49
    v_max_f32 v50, 0, v50
    v_max_f32 v51, 0, v51
    s_waitcnt lgkmcnt(3)
    v_mfma_f32_16x16x32_bf16 v[64:67], v[16:19], v[144:147], v[64:67]
    s_setprio 1
    v_mfma_f32_16x16x32_bf16 v[64:67], v[20:23], v[152:155], v[64:67]
    v_mfma_f32_16x16x32_bf16 v[68:71], v[16:19], v[148:151], v[68:71]
    v_mfma_f32_16x16x32_bf16 v[68:71], v[20:23], v[156:159], v[68:71]
    s_setprio 0
    ds_read_b128 v[16:19], v5 offset:54272
    ds_read_b128 v[20:23], v5 offset:55296
    v_mul_f32 v56, v56, v8
    v_mul_f32 v57, v57, v8
    s_add_u32 s34, s53, 16384
    s_add_u32 m0, s55, 77824
    s_nop 0
    buffer_load_dwordx4 v3, s[20:23], s34 offen sc1 lds
    v_mul_f32 v58, v58, v8
    v_mul_f32 v59, v59, v8
    s_waitcnt lgkmcnt(3)
    v_mfma_f32_16x16x32_bf16 v[64:67], v[24:27], v[160:163], v[64:67]
    s_setprio 1
    v_mfma_f32_16x16x32_bf16 v[64:67], v[28:31], v[168:171], v[64:67]
    v_mfma_f32_16x16x32_bf16 v[68:71], v[24:27], v[164:167], v[68:71]
    v_mfma_f32_16x16x32_bf16 v[68:71], v[28:31], v[172:175], v[68:71]
    s_setprio 0
    ds_read_b128 v[24:27], v5 offset:56320
    ds_read_b128 v[28:31], v5 offset:57344
    v_mul_f32 v56, v48, v56
    v_mul_f32 v57, v49, v57
    v_mul_f32 v58, v50, v58
    v_mul_f32 v59, v51, v59
    s_waitcnt lgkmcnt(3)
    v_mfma_f32_16x16x32_bf16 v[64:67], v[12:15], v[176:179], v[64:67]
    s_setprio 1
    v_mfma_f32_16x16x32_bf16 v[64:67], v[16:19], v[184:187], v[64:67]
    v_mfma_f32_16x16x32_bf16 v[68:71], v[12:15], v[180:183], v[68:71]
    v_mfma_f32_16x16x32_bf16 v[68:71], v[16:19], v[188:191], v[68:71]
    s_setprio 0
    ds_read_b128 v[12:15], v5 offset:58368
    ds_read_b128 v[16:19], v5 offset:59392
    v_cvt_pk_bf16_f32 v48, v56, v57
    v_cvt_pk_bf16_f32 v49, v58, v59
    s_add_u32 s34, s53, 20480
    s_add_u32 m0, s55, 81920
    s_nop 0
    buffer_load_dwordx4 v3, s[20:23], s34 offen sc1 lds
    v_max_f32 v52, 0, v52
    v_max_f32 v53, 0, v53
    s_waitcnt lgkmcnt(3)
    v_mfma_f32_16x16x32_bf16 v[64:67], v[20:23], v[192:195], v[64:67]
    s_setprio 1
    v_mfma_f32_16x16x32_bf16 v[64:67], v[24:27], v[200:203], v[64:67]
    v_mfma_f32_16x16x32_bf16 v[68:71], v[20:23], v[196:199], v[68:71]
    v_mfma_f32_16x16x32_bf16 v[68:71], v[24:27], v[204:207], v[68:71]
    s_setprio 0
    ds_read_b128 v[20:23], v5 offset:60416
    ds_read_b128 v[24:27], v5 offset:61440
    v_max_f32 v54, 0, v54
    v_max_f32 v55, 0, v55
    v_mul_f32 v60, v60, v9
    v_mul_f32 v61, v61, v9
    s_waitcnt lgkmcnt(3)
    v_mfma_f32_16x16x32_bf16 v[64:67], v[28:31], v[208:211], v[64:67]
    s_setprio 1
    v_mfma_f32_16x16x32_bf16 v[64:67], v[12:15], v[216:219], v[64:67]
    v_mfma_f32_16x16x32_bf16 v[68:71], v[28:31], v[212:215], v[68:71]
    v_mfma_f32_16x16x32_bf16 v[68:71], v[12:15], v[220:223], v[68:71]
    s_setprio 0
    ds_read_b128 v[28:31], v5 offset:62464
    ds_read_b128 v[12:15], v5 offset:63488
    v_mul_f32 v62, v62, v9
    v_mul_f32 v63, v63, v9
    v_mul_f32 v60, v52, v60
    v_mul_f32 v61, v53, v61
    ds_read_b128 v[72:75], v0 offset:960
    s_waitcnt lgkmcnt(4)
    v_mfma_f32_16x16x32_bf16 v[64:67], v[16:19], v[224:227], v[64:67]
    s_setprio 1
    v_mfma_f32_16x16x32_bf16 v[64:67], v[20:23], v[232:235], v[64:67]
    v_mfma_f32_16x16x32_bf16 v[68:71], v[16:19], v[228:231], v[68:71]
    v_mfma_f32_16x16x32_bf16 v[68:71], v[20:23], v[236:239], v[68:71]
    s_setprio 0
    ds_read_b128 v[16:19], v5 offset:64512
    s_barrier
    ds_read_b128 v[20:23], v6 offset:0
    v_mul_f32 v62, v54, v62
    v_mul_f32 v63, v55, v63
    v_cvt_pk_bf16_f32 v52, v60, v61
    v_cvt_pk_bf16_f32 v53, v62, v63
    s_waitcnt lgkmcnt(2)
    v_mul_f32 v76, v72, v11
    v_mul_f32 v77, v73, v11
    v_mul_f32 v78, v74, v11
    v_mul_f32 v79, v75, v11
    v_mul_f32 v72, v72, v10
    v_mul_f32 v73, v73, v10
    v_mul_f32 v74, v74, v10
    v_mul_f32 v75, v75, v10
    v_mfma_f32_16x16x32_bf16 v[64:67], v[24:27], v[240:243], v[64:67]
    s_setprio 1
    v_mfma_f32_16x16x32_bf16 v[64:67], v[28:31], v[248:251], v[64:67]
    v_mfma_f32_16x16x32_bf16 v[68:71], v[24:27], v[244:247], v[68:71]
    v_mfma_f32_16x16x32_bf16 v[68:71], v[28:31], v[252:255], v[68:71]
    s_setprio 0
    ds_read_b128 v[24:27], v6 offset:1024
    ds_read_b128 v[28:31], v6 offset:2048
    s_waitcnt lgkmcnt(3)
    v_mfma_f32_16x16x32_bf16 v[72:75], v[12:15], v[112:115], v[72:75]
    s_setprio 1
    v_mfma_f32_16x16x32_bf16 v[72:75], v[16:19], v[120:123], v[72:75]
    v_mfma_f32_16x16x32_bf16 v[76:79], v[12:15], v[116:119], v[76:79]
    v_mfma_f32_16x16x32_bf16 v[76:79], v[16:19], v[124:127], v[76:79]
    s_setprio 0
    ds_read_b128 v[12:15], v6 offset:3072
    ds_read_b128 v[16:19], v6 offset:4096
    s_waitcnt lgkmcnt(3)
    v_mfma_f32_16x16x32_bf16 v[72:75], v[20:23], v[128:131], v[72:75]
    s_setprio 1
    v_mfma_f32_16x16x32_bf16 v[72:75], v[24:27], v[136:139], v[72:75]
    v_mfma_f32_16x16x32_bf16 v[76:79], v[20:23], v[132:135], v[76:79]
    v_mfma_f32_16x16x32_bf16 v[76:79], v[24:27], v[140:143], v[76:79]
    s_setprio 0
    ds_read_b128 v[20:23], v6 offset:5120
    ds_read_b128 v[24:27], v6 offset:6144
    s_waitcnt lgkmcnt(3)
    v_mfma_f32_16x16x32_bf16 v[72:75], v[28:31], v[144:147], v[72:75]
    s_setprio 1
    v_mfma_f32_16x16x32_bf16 v[72:75], v[12:15], v[152:155], v[72:75]
    v_mfma_f32_16x16x32_bf16 v[76:79], v[28:31], v[148:151], v[76:79]
    v_mfma_f32_16x16x32_bf16 v[76:79], v[12:15], v[156:159], v[76:79]
    s_setprio 0
    ds_read_b128 v[28:31], v6 offset:7168
    ds_read_b128 v[12:15], v6 offset:8192
    s_waitcnt lgkmcnt(3)
    v_mfma_f32_16x16x32_bf16 v[72:75], v[16:19], v[160:163], v[72:75]
    s_setprio 1
    v_mfma_f32_16x16x32_bf16 v[72:75], v[20:23], v[168:171], v[72:75]
    v_mfma_f32_16x16x32_bf16 v[76:79], v[16:19], v[164:167], v[76:79]
    v_mfma_f32_16x16x32_bf16 v[76:79], v[20:23], v[172:175], v[76:79]
    s_setprio 0
    ds_read_b128 v[16:19], v6 offset:9216
    ds_read_b128 v[20:23], v6 offset:10240
    s_waitcnt lgkmcnt(3)
    v_mfma_f32_16x16x32_bf16 v[72:75], v[24:27], v[176:179], v[72:75]
    s_setprio 1
    v_mfma_f32_16x16x32_bf16 v[72:75], v[28:31], v[184:187], v[72:75]
    v_mfma_f32_16x16x32_bf16 v[76:79], v[24:27], v[180:183], v[76:79]
    v_mfma_f32_16x16x32_bf16 v[76:79], v[28:31], v[188:191], v[76:79]
    s_setprio 0
    ds_read_b128 v[24:27], v6 offset:11264
    ds_read_b128 v[28:31], v6 offset:12288
    s_waitcnt lgkmcnt(3)
    v_mfma_f32_16x16x32_bf16 v[72:75], v[12:15], v[192:195], v[72:75]
    s_setprio 1
    v_mfma_f32_16x16x32_bf16 v[72:75], v[16:19], v[200:203], v[72:75]
    v_mfma_f32_16x16x32_bf16 v[76:79], v[12:15], v[196:199], v[76:79]
    v_mfma_f32_16x16x32_bf16 v[76:79], v[16:19], v[204:207], v[76:79]
    s_setprio 0
    ds_read_b128 v[12:15], v6 offset:13312
    ds_read_b128 v[16:19], v6 offset:14336
    s_waitcnt lgkmcnt(3)
    v_mfma_f32_16x16x32_bf16 v[72:75], v[20:23], v[208:211], v[72:75]
    s_setprio 1
    v_mfma_f32_16x16x32_bf16 v[72:75], v[24:27], v[216:219], v[72:75]
    v_mfma_f32_16x16x32_bf16 v[76:79], v[20:23], v[212:215], v[76:79]
    v_mfma_f32_16x16x32_bf16 v[76:79], v[24:27], v[220:223], v[76:79]
    s_setprio 0
    ds_read_b128 v[20:23], v6 offset:15360
    s_barrier
    v_and_b32 v7, 7, v2
    v_lshlrev_b32 v7, 7, v7
    s_cmp_eq_u32 s24, 0
    s_cselect_b32 s42, s42, 2146435072
    s_cselect_b32 s63, s63, 2146435072
    buffer_load_dword v1, v7, s[12:15], s42 offen sc1
    ds_read_b128 v[24:27], v4 offset:0
    ds_read_b128 v[80:83], v0 offset:1024
    s_waitcnt lgkmcnt(4)
    v_mfma_f32_16x16x32_bf16 v[72:75], v[28:31], v[224:227], v[72:75]
    s_setprio 1
    v_mfma_f32_16x16x32_bf16 v[72:75], v[12:15], v[232:235], v[72:75]
    v_mfma_f32_16x16x32_bf16 v[76:79], v[28:31], v[228:231], v[76:79]
    v_mfma_f32_16x16x32_bf16 v[76:79], v[12:15], v[236:239], v[76:79]
    s_setprio 0
    ds_read_b128 v[28:31], v4 offset:1024
    ds_read_b128 v[12:15], v4 offset:2048
    s_add_u32 s34, s53, 24576
    s_add_u32 m0, s55, 98304
    s_nop 0
    buffer_load_dwordx4 v3, s[20:23], s34 offen sc1 lds
    s_waitcnt lgkmcnt(2)
    v_mul_f32 v84, v80, v11
    v_mul_f32 v85, v81, v11
    v_mul_f32 v86, v82, v11
    v_mul_f32 v87, v83, v11
    v_mul_f32 v80, v80, v10
    v_mul_f32 v81, v81, v10
    v_mul_f32 v82, v82, v10
    v_mul_f32 v83, v83, v10
    v_mfma_f32_16x16x32_bf16 v[72:75], v[16:19], v[240:243], v[72:75]
    s_setprio 1
    v_mfma_f32_16x16x32_bf16 v[72:75], v[20:23], v[248:251], v[72:75]
    v_mfma_f32_16x16x32_bf16 v[76:79], v[16:19], v[244:247], v[76:79]
    v_mfma_f32_16x16x32_bf16 v[76:79], v[20:23], v[252:255], v[76:79]
    s_setprio 0
    ds_read_b128 v[16:19], v4 offset:3072
    ds_read_b128 v[20:23], v4 offset:4096
    s_waitcnt lgkmcnt(3)
    v_mfma_f32_16x16x32_bf16 v[80:83], v[24:27], v[112:115], v[80:83]
    s_setprio 1
    v_mfma_f32_16x16x32_bf16 v[80:83], v[28:31], v[120:123], v[80:83]
    v_mfma_f32_16x16x32_bf16 v[84:87], v[24:27], v[116:119], v[84:87]
    v_mfma_f32_16x16x32_bf16 v[84:87], v[28:31], v[124:127], v[84:87]
    s_setprio 0
    ds_read_b128 v[24:27], v4 offset:5120
    ds_read_b128 v[28:31], v4 offset:6144
    s_add_u32 s34, s53, 28672
    s_add_u32 m0, s55, 102400
    s_nop 0
    buffer_load_dwordx4 v3, s[20:23], s34 offen sc1 lds
    s_waitcnt lgkmcnt(3)
    v_mfma_f32_16x16x32_bf16 v[80:83], v[12:15], v[128:131], v[80:83]
    s_setprio 1
    v_mfma_f32_16x16x32_bf16 v[80:83], v[16:19], v[136:139], v[80:83]
    v_mfma_f32_16x16x32_bf16 v[84:87], v[12:15], v[132:135], v[84:87]
    v_mfma_f32_16x16x32_bf16 v[84:87], v[16:19], v[140:143], v[84:87]
    s_setprio 0
    ds_read_b128 v[12:15], v4 offset:7168
    ds_read_b128 v[16:19], v4 offset:8192
    v_max_f32 v64, 0, v64
    v_max_f32 v65, 0, v65
    v_max_f32 v66, 0, v66
    v_max_f32 v67, 0, v67
    s_waitcnt lgkmcnt(3)
    v_mfma_f32_16x16x32_bf16 v[80:83], v[20:23], v[144:147], v[80:83]
    s_setprio 1
    v_mfma_f32_16x16x32_bf16 v[80:83], v[24:27], v[152:155], v[80:83]
    v_mfma_f32_16x16x32_bf16 v[84:87], v[20:23], v[148:151], v[84:87]
    v_mfma_f32_16x16x32_bf16 v[84:87], v[24:27], v[156:159], v[84:87]
    s_setprio 0
    ds_read_b128 v[20:23], v4 offset:9216
    ds_read_b128 v[24:27], v4 offset:10240
    v_mul_f32 v72, v72, v8
    v_mul_f32 v73, v73, v8
    s_add_u32 s34, s53, 32768
    s_add_u32 m0, s55, 106496
    s_nop 0
    buffer_load_dwordx4 v3, s[20:23], s34 offen sc1 lds
    v_mul_f32 v74, v74, v8
    v_mul_f32 v75, v75, v8
    s_waitcnt lgkmcnt(3)
    v_mfma_f32_16x16x32_bf16 v[80:83], v[28:31], v[160:163], v[80:83]
    s_setprio 1
    v_mfma_f32_16x16x32_bf16 v[80:83], v[12:15], v[168:171], v[80:83]
    v_mfma_f32_16x16x32_bf16 v[84:87], v[28:31], v[164:167], v[84:87]
    v_mfma_f32_16x16x32_bf16 v[84:87], v[12:15], v[172:175], v[84:87]
    s_setprio 0
    ds_read_b128 v[28:31], v4 offset:11264
    ds_read_b128 v[12:15], v4 offset:12288
    v_mul_f32 v72, v64, v72
    v_mul_f32 v73, v65, v73
    v_mul_f32 v74, v66, v74
    v_mul_f32 v75, v67, v75
    s_waitcnt lgkmcnt(3)
    v_mfma_f32_16x16x32_bf16 v[80:83], v[16:19], v[176:179], v[80:83]
    s_setprio 1
    v_mfma_f32_16x16x32_bf16 v[80:83], v[20:23], v[184:187], v[80:83]
    v_mfma_f32_16x16x32_bf16 v[84:87], v[16:19], v[180:183], v[84:87]
    v_mfma_f32_16x16x32_bf16 v[84:87], v[20:23], v[188:191], v[84:87]
    s_setprio 0
    ds_read_b128 v[16:19], v4 offset:13312
    ds_read_b128 v[20:23], v4 offset:14336
    v_cvt_pk_bf16_f32 v50, v72, v73
    v_cvt_pk_bf16_f32 v51, v74, v75
    buffer_store_dwordx4 v[48:51], v3, s[12:15], s35 offen offset:3072 sc1
    v_max_f32 v68, 0, v68
    s_waitcnt lgkmcnt(3)
    v_mfma_f32_16x16x32_bf16 v[80:83], v[24:27], v[192:195], v[80:83]
    s_setprio 1
    v_mfma_f32_16x16x32_bf16 v[80:83], v[28:31], v[200:203], v[80:83]
    v_mfma_f32_16x16x32_bf16 v[84:87], v[24:27], v[196:199], v[84:87]
    v_mfma_f32_16x16x32_bf16 v[84:87], v[28:31], v[204:207], v[84:87]
    s_setprio 0
    ds_read_b128 v[24:27], v4 offset:15360
    s_cmp_lg_u32 s24, 0
    s_cbranch_scc1 fused_kernel_f_b_fp
    s_waitcnt vmcnt(4)
    v_cmp_ne_u32 vcc, 1, v1
    s_nop 0
    s_cbranch_vccz fused_kernel_f_b_fp
    s_mov_b32 s57, 0
fused_kernel_f_bp:
    buffer_load_dword v1, v7, s[12:15], s42 offen sc1
    s_add_u32 s57, s57, 1
    s_waitcnt vmcnt(0)
    v_cmp_ne_u32 vcc, 1, v1
    s_cmp_gt_u32 s57, 0x40000
    s_cbranch_scc1 fused_kernel_f_bq
    s_cbranch_vccz fused_kernel_f_bq
    s_sleep 1
    s_branch fused_kernel_f_bp
fused_kernel_f_bq:
fused_kernel_f_b_fp:
    s_waitcnt vmcnt(12)
    s_barrier
    ds_read_b128 v[28:31], v4 offset:16384
    v_max_f32 v69, 0, v69
    v_max_f32 v70, 0, v70
    v_max_f32 v71, 0, v71
    v_mul_f32 v76, v76, v9
    s_waitcnt lgkmcnt(3)
    v_mfma_f32_16x16x32_bf16 v[80:83], v[12:15], v[208:211], v[80:83]
    s_setprio 1
    v_mfma_f32_16x16x32_bf16 v[80:83], v[16:19], v[216:219], v[80:83]
    v_mfma_f32_16x16x32_bf16 v[84:87], v[12:15], v[212:215], v[84:87]
    v_mfma_f32_16x16x32_bf16 v[84:87], v[16:19], v[220:223], v[84:87]
    s_setprio 0
    ds_read_b128 v[12:15], v4 offset:17408
    ds_read_b128 v[16:19], v4 offset:18432
    v_mul_f32 v77, v77, v9
    v_mul_f32 v78, v78, v9
    s_add_u32 s34, s53, 36864
    s_add_u32 m0, s55, 122880
    s_nop 0
    buffer_load_dwordx4 v3, s[20:23], s34 offen sc1 lds
    v_mul_f32 v79, v79, v9
    v_mul_f32 v76, v68, v76
    ds_read_b128 v[88:91], v0 offset:1088
    s_waitcnt lgkmcnt(4)
    v_mfma_f32_16x16x32_bf16 v[80:83], v[20:23], v[224:227], v[80:83]
    s_setprio 1
    v_mfma_f32_16x16x32_bf16 v[80:83], v[24:27], v[232:235], v[80:83]
    v_mfma_f32_16x16x32_bf16 v[84:87], v[20:23], v[228:231], v[84:87]
    v_mfma_f32_16x16x32_bf16 v[84:87], v[24:27], v[236:239], v[84:87]
    s_setprio 0
    ds_read_b128 v[20:23], v4 offset:19456
    ds_read_b128 v[24:27], v4 offset:20480
    v_mul_f32 v77, v69, v77
    v_mul_f32 v78, v70, v78
    v_mul_f32 v79, v71, v79
    v_cvt_pk_bf16_f32 v54, v76, v77
    s_waitcnt lgkmcnt(2)
    v_mul_f32 v92, v88, v11
    v_mul_f32 v93, v89, v11
    v_mul_f32 v94, v90, v11
    v_mul_f32 v95, v91, v11
    v_mul_f32 v88, v88, v10
    v_mul_f32 v89, v89, v10
    v_mul_f32 v90, v90, v10
    v_mul_f32 v91, v91, v10
    v_mfma_f32_16x16x32_bf16 v[80:83], v[28:31], v[240:243], v[80:83]
    s_setprio 1
    v_mfma_f32_16x16x32_bf16 v[80:83], v[12:15], v[248:251], v[80:83]
    v_mfma_f32_16x16x32_bf16 v[84:87], v[28:31], v[244:247], v[84:87]
    v_mfma_f32_16x16x32_bf16 v[84:87], v[12:15], v[252:255], v[84:87]
    s_setprio 0
    ds_read_b128 v[28:31], v4 offset:21504
    ds_read_b128 v[12:15], v4 offset:22528
    v_cvt_pk_bf16_f32 v55, v78, v79
    buffer_store_dwordx4 v[52:55], v3, s[12:15], s36 offen offset:3072 sc1
    s_add_u32 s34, s53, 40960
    s_add_u32 m0, s55, 126976
    s_nop 0
    buffer_load_dwordx4 v3, s[20:23], s34 offen sc1 lds
    s_waitcnt lgkmcnt(3)
    v_mfma_f32_16x16x32_bf16 v[88:91], v[16:19], v[112:115], v[88:91]
    s_setprio 1
    v_mfma_f32_16x16x32_bf16 v[88:91], v[20:23], v[120:123], v[88:91]
    v_mfma_f32_16x16x32_bf16 v[92:95], v[16:19], v[116:119], v[92:95]
    v_mfma_f32_16x16x32_bf16 v[92:95], v[20:23], v[124:127], v[92:95]
    s_setprio 0
    ds_read_b128 v[16:19], v4 offset:23552
    ds_read_b128 v[20:23], v4 offset:24576
    s_waitcnt lgkmcnt(3)
    v_mfma_f32_16x16x32_bf16 v[88:91], v[24:27], v[128:131], v[88:91]
    s_setprio 1
    v_mfma_f32_16x16x32_bf16 v[88:91], v[28:31], v[136:139], v[88:91]
    v_mfma_f32_16x16x32_bf16 v[92:95], v[24:27], v[132:135], v[92:95]
    v_mfma_f32_16x16x32_bf16 v[92:95], v[28:31], v[140:143], v[92:95]
    s_setprio 0
    ds_read_b128 v[24:27], v4 offset:25600
    ds_read_b128 v[28:31], v4 offset:26624
    s_add_u32 s30, s46, 0
    buffer_load_dwordx4 v[112:115], v3, s[12:15], s30 offen offset:0 sc1
    s_add_u32 s34, s53, 45056
    s_add_u32 m0, s55, 131072
    s_nop 0
    buffer_load_dwordx4 v3, s[20:23], s34 offen sc1 lds
    s_add_u32 s30, s43, 0
    buffer_load_dwordx4 v[116:119], v3, s[12:15], s30 offen offset:0 sc1
    s_waitcnt lgkmcnt(3)
    v_mfma_f32_16x16x32_bf16 v[88:91], v[12:15], v[144:147], v[88:91]
    s_setprio 1
    v_mfma_f32_16x16x32_bf16 v[88:91], v[16:19], v[152:155], v[88:91]
    v_mfma_f32_16x16x32_bf16 v[92:95], v[12:15], v[148:151], v[92:95]
    v_mfma_f32_16x16x32_bf16 v[92:95], v[16:19], v[156:159], v[92:95]
    s_setprio 0
    ds_read_b128 v[12:15], v4 offset:27648
    ds_read_b128 v[16:19], v4 offset:28672
    s_add_u32 s30, s46, 0
    buffer_load_dwordx4 v[120:123], v3, s[12:15], s30 offen offset:1024 sc1
    s_add_u32 s30, s43, 0
    buffer_load_dwordx4 v[124:127], v3, s[12:15], s30 offen offset:1024 sc1
    s_waitcnt lgkmcnt(3)
    v_mfma_f32_16x16x32_bf16 v[88:91], v[20:23], v[160:163], v[88:91]
    s_setprio 1
    v_mfma_f32_16x16x32_bf16 v[88:91], v[24:27], v[168:171], v[88:91]
    v_mfma_f32_16x16x32_bf16 v[92:95], v[20:23], v[164:167], v[92:95]
    v_mfma_f32_16x16x32_bf16 v[92:95], v[24:27], v[172:175], v[92:95]
    s_setprio 0
    ds_read_b128 v[20:23], v4 offset:29696
    ds_read_b128 v[24:27], v4 offset:30720
    s_add_u32 s30, s46, 0
    buffer_load_dwordx4 v[128:131], v3, s[12:15], s30 offen offset:2048 sc1
    s_add_u32 s30, s43, 0
    buffer_load_dwordx4 v[132:135], v3, s[12:15], s30 offen offset:2048 sc1
    s_waitcnt lgkmcnt(3)
    v_mfma_f32_16x16x32_bf16 v[88:91], v[28:31], v[176:179], v[88:91]
    s_setprio 1
    v_mfma_f32_16x16x32_bf16 v[88:91], v[12:15], v[184:187], v[88:91]
    v_mfma_f32_16x16x32_bf16 v[92:95], v[28:31], v[180:183], v[92:95]
    v_mfma_f32_16x16x32_bf16 v[92:95], v[12:15], v[188:191], v[92:95]
    s_setprio 0
    ds_read_b128 v[28:31], v4 offset:31744
    s_waitcnt vmcnt(18)
    s_barrier
    ds_read_b128 v[12:15], v4 offset:32768
    s_add_u32 s30, s46, 4096
    buffer_load_dwordx4 v[136:139], v3, s[12:15], s30 offen offset:1024 sc1
    s_add_u32 s30, s43, 4096
    buffer_load_dwordx4 v[140:143], v3, s[12:15], s30 offen offset:1024 sc1
    s_waitcnt lgkmcnt(3)
    v_mfma_f32_16x16x32_bf16 v[88:91], v[16:19], v[192:195], v[88:91]
    s_setprio 1
    v_mfma_f32_16x16x32_bf16 v[88:91], v[20:23], v[200:203], v[88:91]
    v_mfma_f32_16x16x32_bf16 v[92:95], v[16:19], v[196:199], v[92:95]
    v_mfma_f32_16x16x32_bf16 v[92:95], v[20:23], v[204:207], v[92:95]
    s_setprio 0
    ds_read_b128 v[16:19], v4 offset:33792
    ds_read_b128 v[20:23], v4 offset:34816
    s_add_u32 s30, s46, 4096
    buffer_load_dwordx4 v[144:147], v3, s[12:15], s30 offen offset:2048 sc1
    s_add_u32 s30, s43, 4096
    buffer_load_dwordx4 v[148:151], v3, s[12:15], s30 offen offset:2048 sc1
    s_waitcnt lgkmcnt(3)
    v_mfma_f32_16x16x32_bf16 v[88:91], v[24:27], v[208:211], v[88:91]
    s_setprio 1
    v_mfma_f32_16x16x32_bf16 v[88:91], v[28:31], v[216:219], v[88:91]
    v_mfma_f32_16x16x32_bf16 v[92:95], v[24:27], v[212:215], v[92:95]
    v_mfma_f32_16x16x32_bf16 v[92:95], v[28:31], v[220:223], v[92:95]
    s_setprio 0
    ds_read_b128 v[24:27], v4 offset:35840
    s_waitcnt lgkmcnt(2)
    v_mfma_f32_16x16x32_bf16 v[88:91], v[12:15], v[224:227], v[88:91]
    s_setprio 1
    v_mfma_f32_16x16x32_bf16 v[88:91], v[16:19], v[232:235], v[88:91]
    v_mfma_f32_16x16x32_bf16 v[92:95], v[12:15], v[228:231], v[92:95]
    v_mfma_f32_16x16x32_bf16 v[92:95], v[16:19], v[236:239], v[92:95]
    s_setprio 0
    s_waitcnt lgkmcnt(0)
    v_mfma_f32_16x16x32_bf16 v[88:91], v[20:23], v[240:243], v[88:91]
    s_setprio 1
    v_mfma_f32_16x16x32_bf16 v[88:91], v[24:27], v[248:251], v[88:91]
    v_mfma_f32_16x16x32_bf16 v[92:95], v[20:23], v[244:247], v[92:95]
    v_mfma_f32_16x16x32_bf16 v[92:95], v[24:27], v[252:255], v[92:95]
    s_setprio 0
    v_max_f32 v80, 0, v80
    v_max_f32 v81, 0, v81
    v_max_f32 v82, 0, v82
    v_max_f32 v83, 0, v83
    s_nop 0
    v_mul_f32 v88, v88, v8
    v_mul_f32 v89, v89, v8
    v_mul_f32 v90, v90, v8
    v_mul_f32 v91, v91, v8
    v_mul_f32 v88, v80, v88
    v_mul_f32 v89, v81, v89
    v_mul_f32 v90, v82, v90
    v_mul_f32 v91, v83, v91
    v_cvt_pk_bf16_f32 v88, v88, v89
    v_cvt_pk_bf16_f32 v89, v90, v91
    v_max_f32 v84, 0, v84
    v_max_f32 v85, 0, v85
    v_max_f32 v86, 0, v86
    v_max_f32 v87, 0, v87
    v_mul_f32 v92, v92, v9
    v_mul_f32 v93, v93, v9
    v_mul_f32 v94, v94, v9
    v_mul_f32 v95, v95, v9
    v_mul_f32 v92, v84, v92
    v_mul_f32 v93, v85, v93
    v_mul_f32 v94, v86, v94
    v_mul_f32 v95, v87, v95
    v_cvt_pk_bf16_f32 v90, v92, v93
    v_cvt_pk_bf16_f32 v91, v94, v95
    v_lshrrev_b32 v7, 5, v2
    v_mul_u32_u24 v7, 146944, v7
    v_add_u32 v7, v7, v3
    v_permlane32_swap_b32 v88, v90
    v_permlane32_swap_b32 v89, v91
    buffer_store_dwordx4 v[88:91], v7, s[12:15], s27 offen sc1
    v_add_u32 v4, s54, v3
    v_add_u32 v5, 49152, v4
    v_add_u32 v6, 98304, v4
    v_and_b32 v14, 7, v2
    v_lshlrev_b32 v14, 7, v14
fused_kernel_f_cc:
    s_waitcnt vmcnt(10)
    s_barrier
    ds_read_b128 v[16:19], v5 offset:0
    ds_read_b128 v[20:23], v5 offset:1024
    ds_read_b128 v[24:27], v5 offset:2048
    ds_read_b128 v[28:31], v5 offset:3072
    ds_read_b128 v[32:35], v5 offset:4096
    ds_read_b128 v[36:39], v5 offset:5120
    s_waitcnt vmcnt(9)
    s_waitcnt lgkmcnt(5)
    v_mfma_f32_16x16x32_bf16 v[40:43], v[16:19], v[112:115], 0
    v_mfma_f32_16x16x32_bf16 v[44:47], v[16:19], v[116:119], 0
    ds_read_b128 v[16:19], v5 offset:6144
    s_waitcnt lgkmcnt(5)
    v_mfma_f32_16x16x32_bf16 v[48:51], v[20:23], v[112:115], 0
    v_mfma_f32_16x16x32_bf16 v[52:55], v[20:23], v[116:119], 0
    ds_read_b128 v[20:23], v5 offset:7168
    s_waitcnt lgkmcnt(5)
    v_mfma_f32_16x16x32_bf16 v[56:59], v[24:27], v[112:115], 0
    v_mfma_f32_16x16x32_bf16 v[60:63], v[24:27], v[116:119], 0
    ds_read_b128 v[24:27], v5 offset:8192
    s_waitcnt lgkmcnt(5)
    v_mfma_f32_16x16x32_bf16 v[64:67], v[28:31], v[112:115], 0
    v_mfma_f32_16x16x32_bf16 v[68:71], v[28:31], v[116:119], 0
    ds_read_b128 v[28:31], v5 offset:9216
    s_waitcnt lgkmcnt(5)
    v_mfma_f32_16x16x32_bf16 v[72:75], v[32:35], v[112:115], 0
    v_mfma_f32_16x16x32_bf16 v[76:79], v[32:35], v[116:119], 0
    ds_read_b128 v[32:35], v5 offset:10240
    s_waitcnt lgkmcnt(5)
    v_mfma_f32_16x16x32_bf16 v[80:83], v[36:39], v[112:115], 0
    v_mfma_f32_16x16x32_bf16 v[84:87], v[36:39], v[116:119], 0
    ds_read_b128 v[36:39], v5 offset:11264
    s_waitcnt lgkmcnt(5)
    v_mfma_f32_16x16x32_bf16 v[88:91], v[16:19], v[112:115], 0
    v_mfma_f32_16x16x32_bf16 v[92:95], v[16:19], v[116:119], 0
    ds_read_b128 v[16:19], v5 offset:24576
    s_waitcnt lgkmcnt(5)
    v_mfma_f32_16x16x32_bf16 v[96:99], v[20:23], v[112:115], 0
    v_mfma_f32_16x16x32_bf16 v[100:103], v[20:23], v[116:119], 0
    ds_read_b128 v[20:23], v5 offset:25600
    s_add_u32 s34, s53, 49152
    s_add_u32 m0, s55, 0
    s_nop 0
    buffer_load_dwordx4 v3, s[20:23], s34 offen sc1 lds
    s_waitcnt lgkmcnt(5)
    v_mfma_f32_16x16x32_bf16 v[104:107], v[24:27], v[112:115], 0
    v_mfma_f32_16x16x32_bf16 v[108:111], v[24:27], v[116:119], 0
    ds_read_b128 v[24:27], v5 offset:26624
    s_add_u32 s34, s53, 53248
    s_add_u32 m0, s55, 4096
    s_nop 0
    buffer_load_dwordx4 v3, s[20:23], s34 offen sc1 lds
    s_waitcnt vmcnt(9)
    s_waitcnt lgkmcnt(5)
    v_mfma_f32_16x16x32_bf16 v[40:43], v[28:31], v[120:123], v[40:43]
    v_mfma_f32_16x16x32_bf16 v[44:47], v[28:31], v[124:127], v[44:47]
    ds_read_b128 v[28:31], v5 offset:27648
    s_add_u32 s34, s53, 57344
    s_add_u32 m0, s55, 8192
    s_nop 0
    buffer_load_dwordx4 v3, s[20:23], s34 offen sc1 lds
    s_waitcnt lgkmcnt(5)
    v_mfma_f32_16x16x32_bf16 v[48:51], v[32:35], v[120:123], v[48:51]
    v_mfma_f32_16x16x32_bf16 v[52:55], v[32:35], v[124:127], v[52:55]
    ds_read_b128 v[32:35], v5 offset:28672
    s_add_u32 s30, s46, 4096
    buffer_load_dwordx4 v[152:155], v3, s[12:15], s30 offen offset:3072 sc1
    s_waitcnt lgkmcnt(5)
    v_mfma_f32_16x16x32_bf16 v[56:59], v[36:39], v[120:123], v[56:59]
    v_mfma_f32_16x16x32_bf16 v[60:63], v[36:39], v[124:127], v[60:63]
    ds_read_b128 v[36:39], v5 offset:29696
    s_add_u32 s30, s43, 4096
    buffer_load_dwordx4 v[156:159], v3, s[12:15], s30 offen offset:3072 sc1
    s_waitcnt lgkmcnt(5)
    v_mfma_f32_16x16x32_bf16 v[64:67], v[16:19], v[120:123], v[64:67]
    v_mfma_f32_16x16x32_bf16 v[68:71], v[16:19], v[124:127], v[68:71]
    ds_read_b128 v[16:19], v5 offset:30720
    s_waitcnt lgkmcnt(5)
    v_mfma_f32_16x16x32_bf16 v[72:75], v[20:23], v[120:123], v[72:75]
    v_mfma_f32_16x16x32_bf16 v[76:79], v[20:23], v[124:127], v[76:79]
    ds_read_b128 v[20:23], v5 offset:31744
    s_waitcnt lgkmcnt(5)
    v_mfma_f32_16x16x32_bf16 v[80:83], v[24:27], v[120:123], v[80:83]
    v_mfma_f32_16x16x32_bf16 v[84:87], v[24:27], v[124:127], v[84:87]
    ds_read_b128 v[24:27], v5 offset:32768
    s_waitcnt lgkmcnt(5)
    v_mfma_f32_16x16x32_bf16 v[88:91], v[28:31], v[120:123], v[88:91]
    v_mfma_f32_16x16x32_bf16 v[92:95], v[28:31], v[124:127], v[92:95]
    ds_read_b128 v[28:31], v5 offset:33792
    s_waitcnt lgkmcnt(5)
    v_mfma_f32_16x16x32_bf16 v[96:99], v[32:35], v[120:123], v[96:99]
    v_mfma_f32_16x16x32_bf16 v[100:103], v[32:35], v[124:127], v[100:103]
    ds_read_b128 v[32:35], v5 offset:34816
    s_waitcnt lgkmcnt(5)
    v_mfma_f32_16x16x32_bf16 v[104:107], v[36:39], v[120:123], v[104:107]
    v_mfma_f32_16x16x32_bf16 v[108:111], v[36:39], v[124:127], v[108:111]
    ds_read_b128 v[36:39], v5 offset:35840
    s_waitcnt vmcnt(10)
    s_waitcnt lgkmcnt(5)
    v_mfma_f32_16x16x32_bf16 v[40:43], v[16:19], v[128:131], v[40:43]
    v_mfma_f32_16x16x32_bf16 v[44:47], v[16:19], v[132:135], v[44:47]
    s_waitcnt vmcnt(5)
    s_barrier
    s_add_u32 s56, s56, 32768
    v_mov_b32 v10, 0
    v_mov_b32 v11, 1
    s_mov_b64 exec, 1
    buffer_store_dword v11, v10, s[12:15], s56 offen sc1
    s_mov_b64 exec, -1
    ds_read_b128 v[16:19], v6 offset:0
    s_add_u32 s34, s53, 61440
    s_add_u32 m0, s55, 24576
    s_nop 0
    buffer_load_dwordx4 v3, s[20:23], s34 offen sc1 lds
    s_waitcnt lgkmcnt(5)
    v_mfma_f32_16x16x32_bf16 v[48:51], v[20:23], v[128:131], v[48:51]
    v_mfma_f32_16x16x32_bf16 v[52:55], v[20:23], v[132:135], v[52:55]
    ds_read_b128 v[20:23], v6 offset:1024
    s_add_u32 s30, s46, 8192
    buffer_load_dwordx4 v[112:115], v3, s[12:15], s30 offen offset:1024 sc1
    s_waitcnt lgkmcnt(5)
    v_mfma_f32_16x16x32_bf16 v[56:59], v[24:27], v[128:131], v[56:59]
    v_mfma_f32_16x16x32_bf16 v[60:63], v[24:27], v[132:135], v[60:63]
    ds_read_b128 v[24:27], v6 offset:2048
    s_add_u32 s30, s43, 8192
    buffer_load_dwordx4 v[116:119], v3, s[12:15], s30 offen offset:1024 sc1
    s_waitcnt lgkmcnt(5)
    v_mfma_f32_16x16x32_bf16 v[64:67], v[28:31], v[128:131], v[64:67]
    v_mfma_f32_16x16x32_bf16 v[68:71], v[28:31], v[132:135], v[68:71]
    ds_read_b128 v[28:31], v6 offset:3072
    s_add_u32 s34, s53, 65536
    s_add_u32 m0, s55, 28672
    s_nop 0
    buffer_load_dwordx4 v3, s[20:23], s34 offen sc1 lds
    s_waitcnt lgkmcnt(5)
    v_mfma_f32_16x16x32_bf16 v[72:75], v[32:35], v[128:131], v[72:75]
    v_mfma_f32_16x16x32_bf16 v[76:79], v[32:35], v[132:135], v[76:79]
    ds_read_b128 v[32:35], v6 offset:4096
    s_add_u32 s34, s53, 69632
    s_add_u32 m0, s55, 32768
    s_nop 0
    buffer_load_dwordx4 v3, s[20:23], s34 offen sc1 lds
    s_waitcnt lgkmcnt(5)
    v_mfma_f32_16x16x32_bf16 v[80:83], v[36:39], v[128:131], v[80:83]
    v_mfma_f32_16x16x32_bf16 v[84:87], v[36:39], v[132:135], v[84:87]
    ds_read_b128 v[36:39], v6 offset:5120
    s_waitcnt lgkmcnt(5)
    v_mfma_f32_16x16x32_bf16 v[88:91], v[16:19], v[128:131], v[88:91]
    v_mfma_f32_16x16x32_bf16 v[92:95], v[16:19], v[132:135], v[92:95]
    ds_read_b128 v[16:19], v6 offset:6144
    s_waitcnt lgkmcnt(5)
    v_mfma_f32_16x16x32_bf16 v[96:99], v[20:23], v[128:131], v[96:99]
    v_mfma_f32_16x16x32_bf16 v[100:103], v[20:23], v[132:135], v[100:103]
    ds_read_b128 v[20:23], v6 offset:7168
    s_waitcnt lgkmcnt(5)
    v_mfma_f32_16x16x32_bf16 v[104:107], v[24:27], v[128:131], v[104:107]
    v_mfma_f32_16x16x32_bf16 v[108:111], v[24:27], v[132:135], v[108:111]
    ds_read_b128 v[24:27], v6 offset:8192
    s_waitcnt lgkmcnt(5)
    v_mfma_f32_16x16x32_bf16 v[40:43], v[28:31], v[136:139], v[40:43]
    v_mfma_f32_16x16x32_bf16 v[44:47], v[28:31], v[140:143], v[44:47]
    ds_read_b128 v[28:31], v6 offset:9216
    s_waitcnt lgkmcnt(5)
    v_mfma_f32_16x16x32_bf16 v[48:51], v[32:35], v[136:139], v[48:51]
    v_mfma_f32_16x16x32_bf16 v[52:55], v[32:35], v[140:143], v[52:55]
    ds_read_b128 v[32:35], v6 offset:10240
    s_add_u32 s30, s46, 8192
    buffer_load_dwordx4 v[120:123], v3, s[12:15], s30 offen offset:2048 sc1
    s_waitcnt lgkmcnt(5)
    v_mfma_f32_16x16x32_bf16 v[56:59], v[36:39], v[136:139], v[56:59]
    v_mfma_f32_16x16x32_bf16 v[60:63], v[36:39], v[140:143], v[60:63]
    ds_read_b128 v[36:39], v6 offset:11264
    s_add_u32 s30, s43, 8192
    buffer_load_dwordx4 v[124:127], v3, s[12:15], s30 offen offset:2048 sc1
    s_waitcnt lgkmcnt(5)
    v_mfma_f32_16x16x32_bf16 v[64:67], v[16:19], v[136:139], v[64:67]
    v_mfma_f32_16x16x32_bf16 v[68:71], v[16:19], v[140:143], v[68:71]
    s_barrier
    ds_read_b128 v[16:19], v6 offset:24576
    s_add_u32 s34, s53, 73728
    s_add_u32 m0, s55, 49152
    s_nop 0
    buffer_load_dwordx4 v3, s[20:23], s34 offen sc1 lds
    s_waitcnt lgkmcnt(5)
    v_mfma_f32_16x16x32_bf16 v[72:75], v[20:23], v[136:139], v[72:75]
    v_mfma_f32_16x16x32_bf16 v[76:79], v[20:23], v[140:143], v[76:79]
    ds_read_b128 v[20:23], v6 offset:25600
    s_add_u32 s34, s53, 77824
    s_add_u32 m0, s55, 53248
    s_nop 0
    buffer_load_dwordx4 v3, s[20:23], s34 offen sc1 lds
    s_waitcnt lgkmcnt(5)
    v_mfma_f32_16x16x32_bf16 v[80:83], v[24:27], v[136:139], v[80:83]
    v_mfma_f32_16x16x32_bf16 v[84:87], v[24:27], v[140:143], v[84:87]
    ds_read_b128 v[24:27], v6 offset:26624
    s_waitcnt lgkmcnt(5)
    v_mfma_f32_16x16x32_bf16 v[88:91], v[28:31], v[136:139], v[88:91]
    v_mfma_f32_16x16x32_bf16 v[92:95], v[28:31], v[140:143], v[92:95]
    ds_read_b128 v[28:31], v6 offset:27648
    s_waitcnt lgkmcnt(5)
    v_mfma_f32_16x16x32_bf16 v[96:99], v[32:35], v[136:139], v[96:99]
    v_mfma_f32_16x16x32_bf16 v[100:103], v[32:35], v[140:143], v[100:103]
    ds_read_b128 v[32:35], v6 offset:28672
    s_add_u32 s34, s53, 81920
    s_add_u32 m0, s55, 57344
    s_nop 0
    buffer_load_dwordx4 v3, s[20:23], s34 offen sc1 lds
    s_waitcnt lgkmcnt(5)
    v_mfma_f32_16x16x32_bf16 v[104:107], v[36:39], v[136:139], v[104:107]
    v_mfma_f32_16x16x32_bf16 v[108:111], v[36:39], v[140:143], v[108:111]
    ds_read_b128 v[36:39], v6 offset:29696
    s_waitcnt lgkmcnt(5)
    v_mfma_f32_16x16x32_bf16 v[40:43], v[16:19], v[144:147], v[40:43]
    v_mfma_f32_16x16x32_bf16 v[44:47], v[16:19], v[148:151], v[44:47]
    ds_read_b128 v[16:19], v6 offset:30720
    s_waitcnt lgkmcnt(5)
    v_mfma_f32_16x16x32_bf16 v[48:51], v[20:23], v[144:147], v[48:51]
    v_mfma_f32_16x16x32_bf16 v[52:55], v[20:23], v[148:151], v[52:55]
    ds_read_b128 v[20:23], v6 offset:31744
    s_add_u32 s30, s46, 8192
    buffer_load_dwordx4 v[128:131], v3, s[12:15], s30 offen offset:3072 sc1
    s_waitcnt lgkmcnt(5)
    v_mfma_f32_16x16x32_bf16 v[56:59], v[24:27], v[144:147], v[56:59]
    v_mfma_f32_16x16x32_bf16 v[60:63], v[24:27], v[148:151], v[60:63]
    ds_read_b128 v[24:27], v6 offset:32768
    s_add_u32 s30, s43, 8192
    buffer_load_dwordx4 v[132:135], v3, s[12:15], s30 offen offset:3072 sc1
    s_waitcnt lgkmcnt(5)
    v_mfma_f32_16x16x32_bf16 v[64:67], v[28:31], v[144:147], v[64:67]
    v_mfma_f32_16x16x32_bf16 v[68:71], v[28:31], v[148:151], v[68:71]
    ds_read_b128 v[28:31], v6 offset:33792
    s_waitcnt lgkmcnt(5)
    v_mfma_f32_16x16x32_bf16 v[72:75], v[32:35], v[144:147], v[72:75]
    v_mfma_f32_16x16x32_bf16 v[76:79], v[32:35], v[148:151], v[76:79]
    ds_read_b128 v[32:35], v6 offset:34816
    s_waitcnt lgkmcnt(5)
    v_mfma_f32_16x16x32_bf16 v[80:83], v[36:39], v[144:147], v[80:83]
    v_mfma_f32_16x16x32_bf16 v[84:87], v[36:39], v[148:151], v[84:87]
    ds_read_b128 v[36:39], v6 offset:35840
    s_waitcnt lgkmcnt(5)
    v_mfma_f32_16x16x32_bf16 v[88:91], v[16:19], v[144:147], v[88:91]
    v_mfma_f32_16x16x32_bf16 v[92:95], v[16:19], v[148:151], v[92:95]
    s_waitcnt vmcnt(15)
    s_barrier
    buffer_load_dword v15, v14, s[12:15], s63 offen sc1
    ds_read_b128 v[16:19], v4 offset:0
    s_waitcnt lgkmcnt(5)
    v_mfma_f32_16x16x32_bf16 v[96:99], v[20:23], v[144:147], v[96:99]
    v_mfma_f32_16x16x32_bf16 v[100:103], v[20:23], v[148:151], v[100:103]
    ds_read_b128 v[20:23], v4 offset:1024
    s_add_u32 s34, s53, 86016
    s_add_u32 m0, s55, 73728
    s_nop 0
    buffer_load_dwordx4 v3, s[20:23], s34 offen sc1 lds
    s_waitcnt lgkmcnt(5)
    v_mfma_f32_16x16x32_bf16 v[104:107], v[24:27], v[144:147], v[104:107]
    v_mfma_f32_16x16x32_bf16 v[108:111], v[24:27], v[148:151], v[108:111]
    ds_read_b128 v[24:27], v4 offset:2048
    s_add_u32 s34, s53, 90112
    s_add_u32 m0, s55, 77824
    s_nop 0
    buffer_load_dwordx4 v3, s[20:23], s34 offen sc1 lds
    s_waitcnt vmcnt(16)
    s_waitcnt lgkmcnt(5)
    v_mfma_f32_16x16x32_bf16 v[40:43], v[28:31], v[152:155], v[40:43]
    v_mfma_f32_16x16x32_bf16 v[44:47], v[28:31], v[156:159], v[44:47]
    ds_read_b128 v[28:31], v4 offset:3072
    s_add_u32 s34, s53, 94208
    s_add_u32 m0, s55, 81920
    s_nop 0
    buffer_load_dwordx4 v3, s[20:23], s34 offen sc1 lds
    s_waitcnt lgkmcnt(5)
    v_mfma_f32_16x16x32_bf16 v[48:51], v[32:35], v[152:155], v[48:51]
    v_mfma_f32_16x16x32_bf16 v[52:55], v[32:35], v[156:159], v[52:55]
    ds_read_b128 v[32:35], v4 offset:4096
    s_add_u32 s30, s46, 12288
    buffer_load_dwordx4 v[136:139], v3, s[12:15], s30 offen offset:2048 sc1
    s_waitcnt lgkmcnt(5)
    v_mfma_f32_16x16x32_bf16 v[56:59], v[36:39], v[152:155], v[56:59]
    v_mfma_f32_16x16x32_bf16 v[60:63], v[36:39], v[156:159], v[60:63]
    ds_read_b128 v[36:39], v4 offset:5120
    s_add_u32 s30, s43, 12288
    buffer_load_dwordx4 v[140:143], v3, s[12:15], s30 offen offset:2048 sc1
    s_waitcnt lgkmcnt(5)
    v_mfma_f32_16x16x32_bf16 v[64:67], v[16:19], v[152:155], v[64:67]
    v_mfma_f32_16x16x32_bf16 v[68:71], v[16:19], v[156:159], v[68:71]
    ds_read_b128 v[16:19], v4 offset:6144
    s_waitcnt lgkmcnt(5)
    v_mfma_f32_16x16x32_bf16 v[72:75], v[20:23], v[152:155], v[72:75]
    v_mfma_f32_16x16x32_bf16 v[76:79], v[20:23], v[156:159], v[76:79]
    ds_read_b128 v[20:23], v4 offset:7168
    s_waitcnt lgkmcnt(5)
    v_mfma_f32_16x16x32_bf16 v[80:83], v[24:27], v[152:155], v[80:83]
    v_mfma_f32_16x16x32_bf16 v[84:87], v[24:27], v[156:159], v[84:87]
    ds_read_b128 v[24:27], v4 offset:8192
    s_waitcnt lgkmcnt(5)
    v_mfma_f32_16x16x32_bf16 v[88:91], v[28:31], v[152:155], v[88:91]
    v_mfma_f32_16x16x32_bf16 v[92:95], v[28:31], v[156:159], v[92:95]
    ds_read_b128 v[28:31], v4 offset:9216
    s_waitcnt lgkmcnt(5)
    v_mfma_f32_16x16x32_bf16 v[96:99], v[32:35], v[152:155], v[96:99]
    v_mfma_f32_16x16x32_bf16 v[100:103], v[32:35], v[156:159], v[100:103]
    ds_read_b128 v[32:35], v4 offset:10240
    s_waitcnt lgkmcnt(5)
    v_mfma_f32_16x16x32_bf16 v[104:107], v[36:39], v[152:155], v[104:107]
    v_mfma_f32_16x16x32_bf16 v[108:111], v[36:39], v[156:159], v[108:111]
    ds_read_b128 v[36:39], v4 offset:11264
    s_waitcnt vmcnt(15)
    s_waitcnt lgkmcnt(5)
    v_mfma_f32_16x16x32_bf16 v[40:43], v[16:19], v[112:115], v[40:43]
    v_mfma_f32_16x16x32_bf16 v[44:47], v[16:19], v[116:119], v[44:47]
    s_cmp_lg_u32 s24, 0
    s_cbranch_scc1 fused_kernel_f_c_fp
    s_waitcnt vmcnt(5)
    v_cmp_ne_u32 vcc, 1, v15
    s_nop 0
    s_cbranch_vccz fused_kernel_f_c_fp
    s_mov_b32 s57, 0
fused_kernel_f_cp:
    buffer_load_dword v15, v14, s[12:15], s63 offen sc1
    s_add_u32 s57, s57, 1
    s_waitcnt vmcnt(0)
    v_cmp_ne_u32 vcc, 1, v15
    s_cmp_gt_u32 s57, 0x40000
    s_cbranch_scc1 fused_kernel_f_cq
    s_cbranch_vccz fused_kernel_f_cq
    s_sleep 1
    s_branch fused_kernel_f_cp
fused_kernel_f_cq:
fused_kernel_f_c_fp:
    s_waitcnt vmcnt(13)
    s_barrier
    ds_read_b128 v[16:19], v4 offset:24576
    s_add_u32 s34, s53, 98304
    s_add_u32 m0, s55, 98304
    s_nop 0
    buffer_load_dwordx4 v3, s[20:23], s34 offen sc1 lds
    s_waitcnt lgkmcnt(5)
    v_mfma_f32_16x16x32_bf16 v[48:51], v[20:23], v[112:115], v[48:51]
    v_mfma_f32_16x16x32_bf16 v[52:55], v[20:23], v[116:119], v[52:55]
    ds_read_b128 v[20:23], v4 offset:25600
    s_add_u32 s30, s46, 12288
    buffer_load_dwordx4 v[144:147], v3, s[12:15], s30 offen offset:3072 sc1
    s_waitcnt lgkmcnt(5)
    v_mfma_f32_16x16x32_bf16 v[56:59], v[24:27], v[112:115], v[56:59]
    v_mfma_f32_16x16x32_bf16 v[60:63], v[24:27], v[116:119], v[60:63]
    ds_read_b128 v[24:27], v4 offset:26624
    s_add_u32 s30, s43, 12288
    buffer_load_dwordx4 v[148:151], v3, s[12:15], s30 offen offset:3072 sc1
    s_waitcnt lgkmcnt(5)
    v_mfma_f32_16x16x32_bf16 v[64:67], v[28:31], v[112:115], v[64:67]
    v_mfma_f32_16x16x32_bf16 v[68:71], v[28:31], v[116:119], v[68:71]
    ds_read_b128 v[28:31], v4 offset:27648
    s_add_u32 s34, s53, 102400
    s_add_u32 m0, s55, 102400
    s_nop 0
    buffer_load_dwordx4 v3, s[20:23], s34 offen sc1 lds
    s_waitcnt lgkmcnt(5)
    v_mfma_f32_16x16x32_bf16 v[72:75], v[32:35], v[112:115], v[72:75]
    v_mfma_f32_16x16x32_bf16 v[76:79], v[32:35], v[116:119], v[76:79]
    ds_read_b128 v[32:35], v4 offset:28672
    s_waitcnt lgkmcnt(5)
    v_mfma_f32_16x16x32_bf16 v[80:83], v[36:39], v[112:115], v[80:83]
    v_mfma_f32_16x16x32_bf16 v[84:87], v[36:39], v[116:119], v[84:87]
    ds_read_b128 v[36:39], v4 offset:29696
    s_waitcnt lgkmcnt(5)
    v_mfma_f32_16x16x32_bf16 v[88:91], v[16:19], v[112:115], v[88:91]
    v_mfma_f32_16x16x32_bf16 v[92:95], v[16:19], v[116:119], v[92:95]
    ds_read_b128 v[16:19], v4 offset:30720
    s_waitcnt lgkmcnt(5)
    v_mfma_f32_16x16x32_bf16 v[96:99], v[20:23], v[112:115], v[96:99]
    v_mfma_f32_16x16x32_bf16 v[100:103], v[20:23], v[116:119], v[100:103]
    ds_read_b128 v[20:23], v4 offset:31744
    s_add_u32 s34, s53, 106496
    s_add_u32 m0, s55, 106496
    s_nop 0
    buffer_load_dwordx4 v3, s[20:23], s34 offen sc1 lds
    s_waitcnt lgkmcnt(5)
    v_mfma_f32_16x16x32_bf16 v[104:107], v[24:27], v[112:115], v[104:107]
    v_mfma_f32_16x16x32_bf16 v[108:111], v[24:27], v[116:119], v[108:111]
    ds_read_b128 v[24:27], v4 offset:32768
    s_waitcnt vmcnt(16)
    s_waitcnt lgkmcnt(5)
    v_mfma_f32_16x16x32_bf16 v[40:43], v[28:31], v[120:123], v[40:43]
    v_mfma_f32_16x16x32_bf16 v[44:47], v[28:31], v[124:127], v[44:47]
    ds_read_b128 v[28:31], v4 offset:33792
    s_waitcnt lgkmcnt(5)
    v_mfma_f32_16x16x32_bf16 v[48:51], v[32:35], v[120:123], v[48:51]
    v_mfma_f32_16x16x32_bf16 v[52:55], v[32:35], v[124:127], v[52:55]
    ds_read_b128 v[32:35], v4 offset:34816
    s_add_u32 s30, s46, 16384
    buffer_load_dwordx4 v[152:155], v3, s[12:15], s30 offen offset:0 sc1
    s_waitcnt lgkmcnt(5)
    v_mfma_f32_16x16x32_bf16 v[56:59], v[36:39], v[120:123], v[56:59]
    v_mfma_f32_16x16x32_bf16 v[60:63], v[36:39], v[124:127], v[60:63]
    ds_read_b128 v[36:39], v4 offset:35840
    s_add_u32 s30, s43, 16384
    buffer_load_dwordx4 v[156:159], v3, s[12:15], s30 offen offset:0 sc1
    s_waitcnt lgkmcnt(5)
    v_mfma_f32_16x16x32_bf16 v[64:67], v[16:19], v[120:123], v[64:67]
    v_mfma_f32_16x16x32_bf16 v[68:71], v[16:19], v[124:127], v[68:71]
    s_waitcnt vmcnt(15)
    s_barrier
    ds_read_b128 v[16:19], v5 offset:0
    s_add_u32 s34, s53, 110592
    s_add_u32 m0, s55, 122880
    s_nop 0
    buffer_load_dwordx4 v3, s[20:23], s34 offen sc1 lds
    s_waitcnt lgkmcnt(5)
    v_mfma_f32_16x16x32_bf16 v[72:75], v[20:23], v[120:123], v[72:75]
    v_mfma_f32_16x16x32_bf16 v[76:79], v[20:23], v[124:127], v[76:79]
    ds_read_b128 v[20:23], v5 offset:1024
    s_waitcnt lgkmcnt(5)
    v_mfma_f32_16x16x32_bf16 v[80:83], v[24:27], v[120:123], v[80:83]
    v_mfma_f32_16x16x32_bf16 v[84:87], v[24:27], v[124:127], v[84:87]
    ds_read_b128 v[24:27], v5 offset:2048
    s_waitcnt lgkmcnt(5)
    v_mfma_f32_16x16x32_bf16 v[88:91], v[28:31], v[120:123], v[88:91]
    v_mfma_f32_16x16x32_bf16 v[92:95], v[28:31], v[124:127], v[92:95]
    ds_read_b128 v[28:31], v5 offset:3072
    s_waitcnt lgkmcnt(5)
    v_mfma_f32_16x16x32_bf16 v[96:99], v[32:35], v[120:123], v[96:99]
    v_mfma_f32_16x16x32_bf16 v[100:103], v[32:35], v[124:127], v[100:103]
    ds_read_b128 v[32:35], v5 offset:4096
    s_add_u32 s34, s53, 114688
    s_add_u32 m0, s55, 126976
    s_nop 0
    buffer_load_dwordx4 v3, s[20:23], s34 offen sc1 lds
    s_waitcnt lgkmcnt(5)
    v_mfma_f32_16x16x32_bf16 v[104:107], v[36:39], v[120:123], v[104:107]
    v_mfma_f32_16x16x32_bf16 v[108:111], v[36:39], v[124:127], v[108:111]
    ds_read_b128 v[36:39], v5 offset:5120
    s_waitcnt vmcnt(15)
    s_waitcnt lgkmcnt(5)
    v_mfma_f32_16x16x32_bf16 v[40:43], v[16:19], v[128:131], v[40:43]
    v_mfma_f32_16x16x32_bf16 v[44:47], v[16:19], v[132:135], v[44:47]
    ds_read_b128 v[16:19], v5 offset:6144
    s_add_u32 s34, s53, 118784
    s_add_u32 m0, s55, 131072
    s_nop 0
    buffer_load_dwordx4 v3, s[20:23], s34 offen sc1 lds
    s_waitcnt lgkmcnt(5)
    v_mfma_f32_16x16x32_bf16 v[48:51], v[20:23], v[128:131], v[48:51]
    v_mfma_f32_16x16x32_bf16 v[52:55], v[20:23], v[132:135], v[52:55]
    ds_read_b128 v[20:23], v5 offset:7168
    s_add_u32 s30, s46, 0
    buffer_load_dwordx4 v[112:115], v3, s[12:15], s30 offen offset:3072 sc1
    s_waitcnt lgkmcnt(5)
    v_mfma_f32_16x16x32_bf16 v[56:59], v[24:27], v[128:131], v[56:59]
    v_mfma_f32_16x16x32_bf16 v[60:63], v[24:27], v[132:135], v[60:63]
    ds_read_b128 v[24:27], v5 offset:8192
    s_add_u32 s30, s43, 0
    buffer_load_dwordx4 v[116:119], v3, s[12:15], s30 offen offset:3072 sc1
    s_waitcnt lgkmcnt(5)
    v_mfma_f32_16x16x32_bf16 v[64:67], v[28:31], v[128:131], v[64:67]
    v_mfma_f32_16x16x32_bf16 v[68:71], v[28:31], v[132:135], v[68:71]
    ds_read_b128 v[28:31], v5 offset:9216
    s_waitcnt lgkmcnt(5)
    v_mfma_f32_16x16x32_bf16 v[72:75], v[32:35], v[128:131], v[72:75]
    v_mfma_f32_16x16x32_bf16 v[76:79], v[32:35], v[132:135], v[76:79]
    ds_read_b128 v[32:35], v5 offset:10240
    s_waitcnt lgkmcnt(5)
    v_mfma_f32_16x16x32_bf16 v[80:83], v[36:39], v[128:131], v[80:83]
    v_mfma_f32_16x16x32_bf16 v[84:87], v[36:39], v[132:135], v[84:87]
    ds_read_b128 v[36:39], v5 offset:11264
    s_waitcnt lgkmcnt(5)
    v_mfma_f32_16x16x32_bf16 v[88:91], v[16:19], v[128:131], v[88:91]
    v_mfma_f32_16x16x32_bf16 v[92:95], v[16:19], v[132:135], v[92:95]
    s_waitcnt vmcnt(14)
    s_barrier
    ds_read_b128 v[16:19], v5 offset:24576
    s_waitcnt lgkmcnt(5)
    v_mfma_f32_16x16x32_bf16 v[96:99], v[20:23], v[128:131], v[96:99]
    v_mfma_f32_16x16x32_bf16 v[100:103], v[20:23], v[132:135], v[100:103]
    ds_read_b128 v[20:23], v5 offset:25600
    s_add_u32 s34, s53, 122880
    s_add_u32 m0, s55, 0
    s_nop 0
    buffer_load_dwordx4 v3, s[20:23], s34 offen sc1 lds
    s_waitcnt lgkmcnt(5)
    v_mfma_f32_16x16x32_bf16 v[104:107], v[24:27], v[128:131], v[104:107]
    v_mfma_f32_16x16x32_bf16 v[108:111], v[24:27], v[132:135], v[108:111]
    ds_read_b128 v[24:27], v5 offset:26624
    s_waitcnt vmcnt(13)
    s_waitcnt lgkmcnt(5)
    v_mfma_f32_16x16x32_bf16 v[40:43], v[28:31], v[136:139], v[40:43]
    v_mfma_f32_16x16x32_bf16 v[44:47], v[28:31], v[140:143], v[44:47]
    ds_read_b128 v[28:31], v5 offset:27648
    s_add_u32 s34, s53, 126976
    s_add_u32 m0, s55, 4096
    s_nop 0
    buffer_load_dwordx4 v3, s[20:23], s34 offen sc1 lds
    s_waitcnt lgkmcnt(5)
    v_mfma_f32_16x16x32_bf16 v[48:51], v[32:35], v[136:139], v[48:51]
    v_mfma_f32_16x16x32_bf16 v[52:55], v[32:35], v[140:143], v[52:55]
    ds_read_b128 v[32:35], v5 offset:28672
    s_add_u32 s30, s46, 4096
    buffer_load_dwordx4 v[120:123], v3, s[12:15], s30 offen offset:0 sc1
    s_waitcnt lgkmcnt(5)
    v_mfma_f32_16x16x32_bf16 v[56:59], v[36:39], v[136:139], v[56:59]
    v_mfma_f32_16x16x32_bf16 v[60:63], v[36:39], v[140:143], v[60:63]
    ds_read_b128 v[36:39], v5 offset:29696
    s_add_u32 s30, s43, 4096
    buffer_load_dwordx4 v[124:127], v3, s[12:15], s30 offen offset:0 sc1
    s_waitcnt lgkmcnt(5)
    v_mfma_f32_16x16x32_bf16 v[64:67], v[16:19], v[136:139], v[64:67]
    v_mfma_f32_16x16x32_bf16 v[68:71], v[16:19], v[140:143], v[68:71]
    ds_read_b128 v[16:19], v5 offset:30720
    s_add_u32 s34, s53, 131072
    s_add_u32 m0, s55, 8192
    s_nop 0
    buffer_load_dwordx4 v3, s[20:23], s34 offen sc1 lds
    s_waitcnt lgkmcnt(5)
    v_mfma_f32_16x16x32_bf16 v[72:75], v[20:23], v[136:139], v[72:75]
    v_mfma_f32_16x16x32_bf16 v[76:79], v[20:23], v[140:143], v[76:79]
    ds_read_b128 v[20:23], v5 offset:31744
    s_waitcnt lgkmcnt(5)
    v_mfma_f32_16x16x32_bf16 v[80:83], v[24:27], v[136:139], v[80:83]
    v_mfma_f32_16x16x32_bf16 v[84:87], v[24:27], v[140:143], v[84:87]
    ds_read_b128 v[24:27], v5 offset:32768
    s_waitcnt lgkmcnt(5)
    v_mfma_f32_16x16x32_bf16 v[88:91], v[28:31], v[136:139], v[88:91]
    v_mfma_f32_16x16x32_bf16 v[92:95], v[28:31], v[140:143], v[92:95]
    ds_read_b128 v[28:31], v5 offset:33792
    s_waitcnt lgkmcnt(5)
    v_mfma_f32_16x16x32_bf16 v[96:99], v[32:35], v[136:139], v[96:99]
    v_mfma_f32_16x16x32_bf16 v[100:103], v[32:35], v[140:143], v[100:103]
    ds_read_b128 v[32:35], v5 offset:34816
    s_waitcnt lgkmcnt(5)
    v_mfma_f32_16x16x32_bf16 v[104:107], v[36:39], v[136:139], v[104:107]
    v_mfma_f32_16x16x32_bf16 v[108:111], v[36:39], v[140:143], v[108:111]
    ds_read_b128 v[36:39], v5 offset:35840
    s_waitcnt vmcnt(14)
    s_waitcnt lgkmcnt(5)
    v_mfma_f32_16x16x32_bf16 v[40:43], v[16:19], v[144:147], v[40:43]
    v_mfma_f32_16x16x32_bf16 v[44:47], v[16:19], v[148:151], v[44:47]
    s_waitcnt vmcnt(12)
    s_barrier
    ds_read_b128 v[16:19], v6 offset:0
    s_add_u32 s34, s53, 135168
    s_add_u32 m0, s55, 24576
    s_nop 0
    buffer_load_dwordx4 v3, s[20:23], s34 offen sc1 lds
    s_waitcnt lgkmcnt(5)
    v_mfma_f32_16x16x32_bf16 v[48:51], v[20:23], v[144:147], v[48:51]
    v_mfma_f32_16x16x32_bf16 v[52:55], v[20:23], v[148:151], v[52:55]
    ds_read_b128 v[20:23], v6 offset:1024
    s_add_u32 s30, s46, 8192
    buffer_load_dwordx4 v[128:131], v3, s[12:15], s30 offen offset:0 sc1
    s_waitcnt lgkmcnt(5)
    v_mfma_f32_16x16x32_bf16 v[56:59], v[24:27], v[144:147], v[56:59]
    v_mfma_f32_16x16x32_bf16 v[60:63], v[24:27], v[148:151], v[60:63]
    ds_read_b128 v[24:27], v6 offset:2048
    s_add_u32 s30, s43, 8192
    buffer_load_dwordx4 v[132:135], v3, s[12:15], s30 offen offset:0 sc1
    s_waitcnt lgkmcnt(5)
    v_mfma_f32_16x16x32_bf16 v[64:67], v[28:31], v[144:147], v[64:67]
    v_mfma_f32_16x16x32_bf16 v[68:71], v[28:31], v[148:151], v[68:71]
    ds_read_b128 v[28:31], v6 offset:3072
    s_add_u32 s34, s53, 139264
    s_add_u32 m0, s55, 28672
    s_nop 0
    buffer_load_dwordx4 v3, s[20:23], s34 offen sc1 lds
    s_waitcnt lgkmcnt(5)
    v_mfma_f32_16x16x32_bf16 v[72:75], v[32:35], v[144:147], v[72:75]
    v_mfma_f32_16x16x32_bf16 v[76:79], v[32:35], v[148:151], v[76:79]
    ds_read_b128 v[32:35], v6 offset:4096
    s_waitcnt lgkmcnt(5)
    v_mfma_f32_16x16x32_bf16 v[80:83], v[36:39], v[144:147], v[80:83]
    v_mfma_f32_16x16x32_bf16 v[84:87], v[36:39], v[148:151], v[84:87]
    ds_read_b128 v[36:39], v6 offset:5120
    s_waitcnt lgkmcnt(5)
    v_mfma_f32_16x16x32_bf16 v[88:91], v[16:19], v[144:147], v[88:91]
    v_mfma_f32_16x16x32_bf16 v[92:95], v[16:19], v[148:151], v[92:95]
    ds_read_b128 v[16:19], v6 offset:6144
    s_waitcnt lgkmcnt(5)
    v_mfma_f32_16x16x32_bf16 v[96:99], v[20:23], v[144:147], v[96:99]
    v_mfma_f32_16x16x32_bf16 v[100:103], v[20:23], v[148:151], v[100:103]
    ds_read_b128 v[20:23], v6 offset:7168
    s_add_u32 s34, s53, 143360
    s_add_u32 m0, s55, 32768
    s_nop 0
    buffer_load_dwordx4 v3, s[20:23], s34 offen sc1 lds
    s_waitcnt lgkmcnt(5)
    v_mfma_f32_16x16x32_bf16 v[104:107], v[24:27], v[144:147], v[104:107]
    v_mfma_f32_16x16x32_bf16 v[108:111], v[24:27], v[148:151], v[108:111]
    ds_read_b128 v[24:27], v6 offset:8192
    s_waitcnt vmcnt(15)
    s_waitcnt lgkmcnt(5)
    v_mfma_f32_16x16x32_bf16 v[40:43], v[28:31], v[152:155], v[40:43]
    v_mfma_f32_16x16x32_bf16 v[44:47], v[28:31], v[156:159], v[44:47]
    ds_read_b128 v[28:31], v6 offset:9216
    s_waitcnt lgkmcnt(5)
    v_mfma_f32_16x16x32_bf16 v[48:51], v[32:35], v[152:155], v[48:51]
    v_mfma_f32_16x16x32_bf16 v[52:55], v[32:35], v[156:159], v[52:55]
    ds_read_b128 v[32:35], v6 offset:10240
    s_add_u32 s30, s46, 12288
    buffer_load_dwordx4 v[136:139], v3, s[12:15], s30 offen offset:0 sc1
    s_waitcnt lgkmcnt(5)
    v_mfma_f32_16x16x32_bf16 v[56:59], v[36:39], v[152:155], v[56:59]
    v_mfma_f32_16x16x32_bf16 v[60:63], v[36:39], v[156:159], v[60:63]
    ds_read_b128 v[36:39], v6 offset:11264
    s_add_u32 s30, s43, 12288
    buffer_load_dwordx4 v[140:143], v3, s[12:15], s30 offen offset:0 sc1
    s_waitcnt lgkmcnt(5)
    v_mfma_f32_16x16x32_bf16 v[64:67], v[16:19], v[152:155], v[64:67]
    v_mfma_f32_16x16x32_bf16 v[68:71], v[16:19], v[156:159], v[68:71]
    s_waitcnt vmcnt(14)
    s_barrier
    ds_read_b128 v[16:19], v6 offset:24576
    s_add_u32 s34, s53, 147456
    s_add_u32 m0, s55, 49152
    s_nop 0
    buffer_load_dwordx4 v3, s[20:23], s34 offen sc1 lds
    s_waitcnt lgkmcnt(5)
    v_mfma_f32_16x16x32_bf16 v[72:75], v[20:23], v[152:155], v[72:75]
    v_mfma_f32_16x16x32_bf16 v[76:79], v[20:23], v[156:159], v[76:79]
    ds_read_b128 v[20:23], v6 offset:25600
    s_waitcnt lgkmcnt(5)
    v_mfma_f32_16x16x32_bf16 v[80:83], v[24:27], v[152:155], v[80:83]
    v_mfma_f32_16x16x32_bf16 v[84:87], v[24:27], v[156:159], v[84:87]
    ds_read_b128 v[24:27], v6 offset:26624
    s_waitcnt lgkmcnt(5)
    v_mfma_f32_16x16x32_bf16 v[88:91], v[28:31], v[152:155], v[88:91]
    v_mfma_f32_16x16x32_bf16 v[92:95], v[28:31], v[156:159], v[92:95]
    ds_read_b128 v[28:31], v6 offset:27648
    s_waitcnt lgkmcnt(5)
    v_mfma_f32_16x16x32_bf16 v[96:99], v[32:35], v[152:155], v[96:99]
    v_mfma_f32_16x16x32_bf16 v[100:103], v[32:35], v[156:159], v[100:103]
    ds_read_b128 v[32:35], v6 offset:28672
    s_add_u32 s34, s53, 151552
    s_add_u32 m0, s55, 53248
    s_nop 0
    buffer_load_dwordx4 v3, s[20:23], s34 offen sc1 lds
    s_waitcnt lgkmcnt(5)
    v_mfma_f32_16x16x32_bf16 v[104:107], v[36:39], v[152:155], v[104:107]
    v_mfma_f32_16x16x32_bf16 v[108:111], v[36:39], v[156:159], v[108:111]
    ds_read_b128 v[36:39], v6 offset:29696
    s_waitcnt vmcnt(14)
    s_waitcnt lgkmcnt(5)
    v_mfma_f32_16x16x32_bf16 v[40:43], v[16:19], v[112:115], v[40:43]
    v_mfma_f32_16x16x32_bf16 v[44:47], v[16:19], v[116:119], v[44:47]
    ds_read_b128 v[16:19], v6 offset:30720
    s_add_u32 s34, s53, 155648
    s_add_u32 m0, s55, 57344
    s_nop 0
    buffer_load_dwordx4 v3, s[20:23], s34 offen sc1 lds
    s_waitcnt lgkmcnt(5)
    v_mfma_f32_16x16x32_bf16 v[48:51], v[20:23], v[112:115], v[48:51]
    v_mfma_f32_16x16x32_bf16 v[52:55], v[20:23], v[116:119], v[52:55]
    ds_read_b128 v[20:23], v6 offset:31744
    s_add_u32 s30, s46, 12288
    buffer_load_dwordx4 v[144:147], v3, s[12:15], s30 offen offset:1024 sc1
    s_waitcnt lgkmcnt(5)
    v_mfma_f32_16x16x32_bf16 v[56:59], v[24:27], v[112:115], v[56:59]
    v_mfma_f32_16x16x32_bf16 v[60:63], v[24:27], v[116:119], v[60:63]
    ds_read_b128 v[24:27], v6 offset:32768
    s_add_u32 s30, s43, 12288
    buffer_load_dwordx4 v[148:151], v3, s[12:15], s30 offen offset:1024 sc1
    s_waitcnt lgkmcnt(5)
    v_mfma_f32_16x16x32_bf16 v[64:67], v[28:31], v[112:115], v[64:67]
    v_mfma_f32_16x16x32_bf16 v[68:71], v[28:31], v[116:119], v[68:71]
    ds_read_b128 v[28:31], v6 offset:33792
    s_waitcnt lgkmcnt(5)
    v_mfma_f32_16x16x32_bf16 v[72:75], v[32:35], v[112:115], v[72:75]
    v_mfma_f32_16x16x32_bf16 v[76:79], v[32:35], v[116:119], v[76:79]
    ds_read_b128 v[32:35], v6 offset:34816
    s_waitcnt lgkmcnt(5)
    v_mfma_f32_16x16x32_bf16 v[80:83], v[36:39], v[112:115], v[80:83]
    v_mfma_f32_16x16x32_bf16 v[84:87], v[36:39], v[116:119], v[84:87]
    ds_read_b128 v[36:39], v6 offset:35840
    s_waitcnt lgkmcnt(5)
    v_mfma_f32_16x16x32_bf16 v[88:91], v[16:19], v[112:115], v[88:91]
    v_mfma_f32_16x16x32_bf16 v[92:95], v[16:19], v[116:119], v[92:95]
    s_waitcnt vmcnt(12)
    s_barrier
    ds_read_b128 v[16:19], v4 offset:0
    s_waitcnt lgkmcnt(5)
    v_mfma_f32_16x16x32_bf16 v[96:99], v[20:23], v[112:115], v[96:99]
    v_mfma_f32_16x16x32_bf16 v[100:103], v[20:23], v[116:119], v[100:103]
    ds_read_b128 v[20:23], v4 offset:1024
    s_add_u32 s34, s53, 159744
    s_add_u32 m0, s55, 73728
    s_nop 0
    buffer_load_dwordx4 v3, s[20:23], s34 offen sc1 lds
    s_waitcnt lgkmcnt(5)
    v_mfma_f32_16x16x32_bf16 v[104:107], v[24:27], v[112:115], v[104:107]
    v_mfma_f32_16x16x32_bf16 v[108:111], v[24:27], v[116:119], v[108:111]
    ds_read_b128 v[24:27], v4 offset:2048
    s_waitcnt lgkmcnt(5)
    v_mfma_f32_16x16x32_bf16 v[40:43], v[28:31], v[120:123], v[40:43]
    v_mfma_f32_16x16x32_bf16 v[44:47], v[28:31], v[124:127], v[44:47]
    ds_read_b128 v[28:31], v4 offset:3072
    s_add_u32 s34, s53, 163840
    s_add_u32 m0, s55, 77824
    s_nop 0
    buffer_load_dwordx4 v3, s[20:23], s34 offen sc1 lds
    s_waitcnt lgkmcnt(5)
    v_mfma_f32_16x16x32_bf16 v[48:51], v[32:35], v[120:123], v[48:51]
    v_mfma_f32_16x16x32_bf16 v[52:55], v[32:35], v[124:127], v[52:55]
    ds_read_b128 v[32:35], v4 offset:4096
    s_add_u32 s30, s46, 16384
    buffer_load_dwordx4 v[152:155], v3, s[12:15], s30 offen offset:1024 sc1
    s_waitcnt lgkmcnt(5)
    v_mfma_f32_16x16x32_bf16 v[56:59], v[36:39], v[120:123], v[56:59]
    v_mfma_f32_16x16x32_bf16 v[60:63], v[36:39], v[124:127], v[60:63]
    ds_read_b128 v[36:39], v4 offset:5120
    s_add_u32 s30, s43, 16384
    buffer_load_dwordx4 v[156:159], v3, s[12:15], s30 offen offset:1024 sc1
    s_waitcnt lgkmcnt(5)
    v_mfma_f32_16x16x32_bf16 v[64:67], v[16:19], v[120:123], v[64:67]
    v_mfma_f32_16x16x32_bf16 v[68:71], v[16:19], v[124:127], v[68:71]
    ds_read_b128 v[16:19], v4 offset:6144
    v_and_b32 v7, 15, v2
    v_lshrrev_b32 v8, 4, v2
    s_lshl_b32 s47, s52, 4
    v_add_u32 v7, s47, v7
    v_lshlrev_b32 v11, 10, v8
    v_lshl_add_u32 v11, v7, 4, v11
    v_lshrrev_b32 v9, 1, v8
    v_and_b32 v10, 1, v8
    v_lshlrev_b32 v9, 10, v9
    v_lshl_add_u32 v9, v7, 4, v9
    v_lshl_add_u32 v9, v10, 3, v9
    s_mul_i32 s40, s29, 36
    s_lshl_b32 s41, s50, 3
    s_add_u32 s41, s41, s40
    s_lshr_b32 s42, s48, 1
    s_lshl_b32 s42, s42, 2
    s_add_u32 s41, s41, s42
    s_lshl_b32 s41, s41, 10
    s_and_b32 s42, s48, 1
    s_lshl_b32 s42, s42, 9
    s_add_u32 s41, s41, s42
    s_add_u32 s41, s41, 9699328
    s_and_b32 s42, s50, 1
    s_lshl_b32 s42, s42, 1
    s_add_u32 s42, s42, s40
    s_add_u32 s42, s42, 32
    s_lshl_b32 s42, s42, 10
    s_lshr_b32 s40, s50, 1
    s_lshl_b32 s40, s40, 9
    s_add_u32 s42, s42, s40
    s_add_u32 s42, s42, 9699328
    buffer_load_dwordx4 v[160:163], v11, s[12:15], s41 offen sc1
    buffer_load_dwordx2 v[164:165], v9, s[12:15], s42 offen sc1
    s_waitcnt lgkmcnt(5)
    v_mfma_f32_16x16x32_bf16 v[72:75], v[20:23], v[120:123], v[72:75]
    v_mfma_f32_16x16x32_bf16 v[76:79], v[20:23], v[124:127], v[76:79]
    ds_read_b128 v[20:23], v4 offset:7168
    s_waitcnt lgkmcnt(5)
    v_mfma_f32_16x16x32_bf16 v[80:83], v[24:27], v[120:123], v[80:83]
    v_mfma_f32_16x16x32_bf16 v[84:87], v[24:27], v[124:127], v[84:87]
    ds_read_b128 v[24:27], v4 offset:8192
    s_waitcnt lgkmcnt(5)
    v_mfma_f32_16x16x32_bf16 v[88:91], v[28:31], v[120:123], v[88:91]
    v_mfma_f32_16x16x32_bf16 v[92:95], v[28:31], v[124:127], v[92:95]
    ds_read_b128 v[28:31], v4 offset:9216
    s_waitcnt lgkmcnt(5)
    v_mfma_f32_16x16x32_bf16 v[96:99], v[32:35], v[120:123], v[96:99]
    v_mfma_f32_16x16x32_bf16 v[100:103], v[32:35], v[124:127], v[100:103]
    ds_read_b128 v[32:35], v4 offset:10240
    s_waitcnt lgkmcnt(5)
    v_mfma_f32_16x16x32_bf16 v[104:107], v[36:39], v[120:123], v[104:107]
    v_mfma_f32_16x16x32_bf16 v[108:111], v[36:39], v[124:127], v[108:111]
    ds_read_b128 v[36:39], v4 offset:11264
    s_waitcnt vmcnt(15)
    s_waitcnt lgkmcnt(5)
    v_mfma_f32_16x16x32_bf16 v[40:43], v[16:19], v[128:131], v[40:43]
    v_mfma_f32_16x16x32_bf16 v[44:47], v[16:19], v[132:135], v[44:47]
    s_waitcnt vmcnt(13)
    s_barrier
    ds_read_b128 v[16:19], v4 offset:24576
    s_waitcnt lgkmcnt(5)
    v_mfma_f32_16x16x32_bf16 v[48:51], v[20:23], v[128:131], v[48:51]
    v_mfma_f32_16x16x32_bf16 v[52:55], v[20:23], v[132:135], v[52:55]
    ds_read_b128 v[20:23], v4 offset:25600
    s_waitcnt lgkmcnt(5)
    v_mfma_f32_16x16x32_bf16 v[56:59], v[24:27], v[128:131], v[56:59]
    v_mfma_f32_16x16x32_bf16 v[60:63], v[24:27], v[132:135], v[60:63]
    ds_read_b128 v[24:27], v4 offset:26624
    s_waitcnt lgkmcnt(5)
    v_mfma_f32_16x16x32_bf16 v[64:67], v[28:31], v[128:131], v[64:67]
    v_mfma_f32_16x16x32_bf16 v[68:71], v[28:31], v[132:135], v[68:71]
    ds_read_b128 v[28:31], v4 offset:27648
    s_waitcnt lgkmcnt(5)
    v_mfma_f32_16x16x32_bf16 v[72:75], v[32:35], v[128:131], v[72:75]
    v_mfma_f32_16x16x32_bf16 v[76:79], v[32:35], v[132:135], v[76:79]
    ds_read_b128 v[32:35], v4 offset:28672
    s_mov_b32 s16, s6
    s_and_b32 s17, s7, 0xffff
    s_mov_b32 s18, 2359296
    s_mov_b32 s19, 0x20000
    s_lshl_b32 s38, s49, 2
    s_add_u32 s38, s38, s50
    s_lshl_b32 s38, s38, 3
    s_add_u32 s38, s38, s24
    s_lshl_b32 s38, s38, 14
    s_add_u32 s38, s38, 50331648
    s_xor_b32 s25, s48, 1
    s_mul_i32 s25, s25, 3072
    s_add_u32 s25, s25, s38
    s_xor_b32 s26, s48, 2
    s_mul_i32 s26, s26, 3072
    s_add_u32 s26, s26, s38
    s_xor_b32 s27, s48, 3
    s_mul_i32 s27, s27, 3072
    s_add_u32 s27, s27, s38
    s_mul_i32 s36, s48, 3072
    s_add_u32 s36, s36, s38
    s_xor_b32 s28, s48, s51
    s_lshl_b32 s28, s28, 9
    s_add_u32 s28, s28, s38
    s_add_u32 s28, s28, 11776
    s_add_u32 s37, s38, 12288
    s_lshl_b32 s61, s50, 8
    s_lshl_b32 s33, s48, 6
    s_add_u32 s61, s61, s33
    s_lshl_b32 s62, s50, 5
    s_cmp_eq_u32 s51, s48
    s_cselect_b32 s28, 2146435072, s28
    s_cselect_b32 s37, s37, 2146435072
    s_cselect_b32 s62, s62, 2146435072
    s_mov_b32 s59, 0x00003f80
    s_mov_b32 s60, 0x3f800000
    s_lshl_b32 s33, s29, 5
    v_add_u32 v7, s33, v7
    v_mul_u32_u24 v7, 1152, v7
    v_lshl_add_u32 v10, v8, 4, v7
    v_lshl_add_u32 v11, v8, 3, v7
    v_lshlrev_b32 v12, 3, v2
    v_min_u32 v8, 5, v2
    v_lshlrev_b32 v9, 10, v8
    v_add_u32 v9, s36, v9
    v_add_u32 v9, 1008, v9
    v_lshlrev_b32 v7, 9, v8
    v_add_u32 v7, s37, v7
    v_add_u32 v7, 4294966264, v7
    v_cmp_gt_u32 vcc, 3, v8
    s_nop 1
    v_cndmask_b32 v9, v7, v9, vcc
    s_waitcnt lgkmcnt(5)
    v_mfma_f32_16x16x32_bf16 v[80:83], v[36:39], v[128:131], v[80:83]
    v_mfma_f32_16x16x32_bf16 v[84:87], v[36:39], v[132:135], v[84:87]
    ds_read_b128 v[36:39], v4 offset:29696
    s_waitcnt lgkmcnt(5)
    v_mfma_f32_16x16x32_bf16 v[88:91], v[16:19], v[128:131], v[88:91]
    v_mfma_f32_16x16x32_bf16 v[92:95], v[16:19], v[132:135], v[92:95]
    ds_read_b128 v[16:19], v4 offset:30720
    s_waitcnt lgkmcnt(5)
    v_mfma_f32_16x16x32_bf16 v[96:99], v[20:23], v[128:131], v[96:99]
    v_mfma_f32_16x16x32_bf16 v[100:103], v[20:23], v[132:135], v[100:103]
    ds_read_b128 v[20:23], v4 offset:31744
    s_waitcnt lgkmcnt(5)
    v_mfma_f32_16x16x32_bf16 v[104:107], v[24:27], v[128:131], v[104:107]
    v_mfma_f32_16x16x32_bf16 v[108:111], v[24:27], v[132:135], v[108:111]
    ds_read_b128 v[24:27], v4 offset:32768
    s_waitcnt vmcnt(11)
    s_waitcnt lgkmcnt(5)
    v_mfma_f32_16x16x32_bf16 v[40:43], v[28:31], v[136:139], v[40:43]
    v_mfma_f32_16x16x32_bf16 v[44:47], v[28:31], v[140:143], v[44:47]
    ds_read_b128 v[28:31], v4 offset:33792
    s_waitcnt lgkmcnt(5)
    v_mfma_f32_16x16x32_bf16 v[48:51], v[32:35], v[136:139], v[48:51]
    v_mfma_f32_16x16x32_bf16 v[52:55], v[32:35], v[140:143], v[52:55]
    ds_read_b128 v[32:35], v4 offset:34816
    s_waitcnt lgkmcnt(5)
    v_mfma_f32_16x16x32_bf16 v[56:59], v[36:39], v[136:139], v[56:59]
    v_mfma_f32_16x16x32_bf16 v[60:63], v[36:39], v[140:143], v[60:63]
    ds_read_b128 v[36:39], v4 offset:35840
    s_waitcnt lgkmcnt(5)
    v_mfma_f32_16x16x32_bf16 v[64:67], v[16:19], v[136:139], v[64:67]
    v_mfma_f32_16x16x32_bf16 v[68:71], v[16:19], v[140:143], v[68:71]
    s_waitcnt vmcnt(8)
    s_barrier
    ds_read_b128 v[16:19], v5 offset:0
    s_waitcnt lgkmcnt(5)
    v_mfma_f32_16x16x32_bf16 v[72:75], v[20:23], v[136:139], v[72:75]
    v_mfma_f32_16x16x32_bf16 v[76:79], v[20:23], v[140:143], v[76:79]
    ds_read_b128 v[20:23], v5 offset:1024
    s_waitcnt lgkmcnt(5)
    v_mfma_f32_16x16x32_bf16 v[80:83], v[24:27], v[136:139], v[80:83]
    v_mfma_f32_16x16x32_bf16 v[84:87], v[24:27], v[140:143], v[84:87]
    ds_read_b128 v[24:27], v5 offset:2048
    s_waitcnt lgkmcnt(5)
    v_mfma_f32_16x16x32_bf16 v[88:91], v[28:31], v[136:139], v[88:91]
    v_mfma_f32_16x16x32_bf16 v[92:95], v[28:31], v[140:143], v[92:95]
    ds_read_b128 v[28:31], v5 offset:3072
    s_waitcnt lgkmcnt(5)
    v_mfma_f32_16x16x32_bf16 v[96:99], v[32:35], v[136:139], v[96:99]
    v_mfma_f32_16x16x32_bf16 v[100:103], v[32:35], v[140:143], v[100:103]
    ds_read_b128 v[32:35], v5 offset:4096
    s_waitcnt lgkmcnt(5)
    v_mfma_f32_16x16x32_bf16 v[104:107], v[36:39], v[136:139], v[104:107]
    v_mfma_f32_16x16x32_bf16 v[108:111], v[36:39], v[140:143], v[108:111]
    ds_read_b128 v[36:39], v5 offset:5120
    s_waitcnt vmcnt(6)
    s_waitcnt lgkmcnt(5)
    v_mfma_f32_16x16x32_bf16 v[40:43], v[16:19], v[144:147], v[40:43]
    v_mfma_f32_16x16x32_bf16 v[44:47], v[16:19], v[148:151], v[44:47]
    ds_read_b128 v[16:19], v5 offset:6144
    s_waitcnt lgkmcnt(5)
    v_mfma_f32_16x16x32_bf16 v[48:51], v[20:23], v[144:147], v[48:51]
    v_mfma_f32_16x16x32_bf16 v[52:55], v[20:23], v[148:151], v[52:55]
    ds_read_b128 v[20:23], v5 offset:7168
    s_waitcnt lgkmcnt(5)
    v_mfma_f32_16x16x32_bf16 v[56:59], v[24:27], v[144:147], v[56:59]
    v_mfma_f32_16x16x32_bf16 v[60:63], v[24:27], v[148:151], v[60:63]
    ds_read_b128 v[24:27], v5 offset:8192
    s_waitcnt lgkmcnt(5)
    v_mfma_f32_16x16x32_bf16 v[64:67], v[28:31], v[144:147], v[64:67]
    v_mfma_f32_16x16x32_bf16 v[68:71], v[28:31], v[148:151], v[68:71]
    ds_read_b128 v[220:223], v5 offset:9216
    s_waitcnt lgkmcnt(5)
    v_mfma_f32_16x16x32_bf16 v[72:75], v[32:35], v[144:147], v[72:75]
    v_mfma_f32_16x16x32_bf16 v[76:79], v[32:35], v[148:151], v[76:79]
    ds_read_b128 v[224:227], v5 offset:10240
    s_waitcnt lgkmcnt(5)
    v_mfma_f32_16x16x32_bf16 v[80:83], v[36:39], v[144:147], v[80:83]
    v_mfma_f32_16x16x32_bf16 v[84:87], v[36:39], v[148:151], v[84:87]
    ds_read_b128 v[228:231], v5 offset:11264
    s_waitcnt lgkmcnt(5)
    v_mfma_f32_16x16x32_bf16 v[88:91], v[16:19], v[144:147], v[88:91]
    v_mfma_f32_16x16x32_bf16 v[92:95], v[16:19], v[148:151], v[92:95]
    s_waitcnt vmcnt(4)
    s_barrier
    ds_read_b128 v[232:235], v5 offset:24576
    s_waitcnt lgkmcnt(5)
    v_mfma_f32_16x16x32_bf16 v[96:99], v[20:23], v[144:147], v[96:99]
    v_mfma_f32_16x16x32_bf16 v[100:103], v[20:23], v[148:151], v[100:103]
    ds_read_b128 v[236:239], v5 offset:25600
    s_waitcnt lgkmcnt(5)
    v_mfma_f32_16x16x32_bf16 v[104:107], v[24:27], v[144:147], v[104:107]
    v_mfma_f32_16x16x32_bf16 v[108:111], v[24:27], v[148:151], v[108:111]
    ds_read_b128 v[240:243], v5 offset:26624
    s_waitcnt vmcnt(2)
    s_waitcnt lgkmcnt(5)
    v_mfma_f32_16x16x32_bf16 v[44:47], v[220:223], v[156:159], v[44:47]
    ds_read_b128 v[244:247], v5 offset:27648
    s_waitcnt lgkmcnt(5)
    v_mfma_f32_16x16x32_bf16 v[52:55], v[224:227], v[156:159], v[52:55]
    ds_read_b128 v[248:251], v5 offset:28672
    s_waitcnt lgkmcnt(5)
    v_mfma_f32_16x16x32_bf16 v[60:63], v[228:231], v[156:159], v[60:63]
    ds_read_b128 v[252:255], v5 offset:29696
    s_waitcnt lgkmcnt(5)
    v_mfma_f32_16x16x32_bf16 v[68:71], v[232:235], v[156:159], v[68:71]
    s_waitcnt lgkmcnt(4)
    v_mfma_f32_16x16x32_bf16 v[76:79], v[236:239], v[156:159], v[76:79]
    s_waitcnt lgkmcnt(3)
    v_mfma_f32_16x16x32_bf16 v[84:87], v[240:243], v[156:159], v[84:87]
    s_waitcnt lgkmcnt(2)
    v_mfma_f32_16x16x32_bf16 v[92:95], v[244:247], v[156:159], v[92:95]
    s_waitcnt lgkmcnt(1)
    v_mfma_f32_16x16x32_bf16 v[100:103], v[248:251], v[156:159], v[100:103]
    s_waitcnt lgkmcnt(0)
    v_mfma_f32_16x16x32_bf16 v[108:111], v[252:255], v[156:159], v[108:111]
fused_kernel_f_tail:
    s_mul_i32 s34, s51, 9216
    s_mul_i32 s35, s52, 98304
    s_add_u32 s33, s34, s35
    s_sub_u32 s35, 98304, s35
    s_add_u32 s35, s35, s34
    v_add_u32 v13, s33, v3
    v_add_u32 v14, s35, v3
    v_mfma_f32_16x16x32_bf16 v[40:43], v[220:223], v[152:155], v[40:43]
    ds_write_b128 v13, v[44:47] offset:0
    v_mfma_f32_16x16x32_bf16 v[48:51], v[224:227], v[152:155], v[48:51]
    ds_write_b128 v13, v[52:55] offset:1024
    v_mfma_f32_16x16x32_bf16 v[56:59], v[228:231], v[152:155], v[56:59]
    ds_write_b128 v13, v[60:63] offset:2048
    v_mfma_f32_16x16x32_bf16 v[64:67], v[232:235], v[152:155], v[64:67]
    ds_write_b128 v13, v[68:71] offset:3072
    v_mfma_f32_16x16x32_bf16 v[72:75], v[236:239], v[152:155], v[72:75]
    ds_write_b128 v13, v[76:79] offset:4096
    v_mfma_f32_16x16x32_bf16 v[80:83], v[240:243], v[152:155], v[80:83]
    ds_write_b128 v13, v[84:87] offset:5120
    v_mfma_f32_16x16x32_bf16 v[88:91], v[244:247], v[152:155], v[88:91]
    ds_write_b128 v13, v[92:95] offset:6144
    v_mfma_f32_16x16x32_bf16 v[96:99], v[248:251], v[152:155], v[96:99]
    ds_write_b128 v13, v[100:103] offset:7168
    v_mfma_f32_16x16x32_bf16 v[104:107], v[252:255], v[152:155], v[104:107]
    ds_write_b128 v13, v[108:111] offset:8192
    s_waitcnt lgkmcnt(0)
    s_barrier
    ds_read_b128 v[44:47], v14 offset:0
    ds_read_b128 v[52:55], v14 offset:1024
    ds_read_b128 v[60:63], v14 offset:2048
    ds_read_b128 v[68:71], v14 offset:3072
    ds_read_b128 v[76:79], v14 offset:4096
    ds_read_b128 v[84:87], v14 offset:5120
    ds_read_b128 v[92:95], v14 offset:6144
    ds_read_b128 v[100:103], v14 offset:7168
    ds_read_b128 v[108:111], v14 offset:8192
    s_waitcnt lgkmcnt(8)
    v_add_f32 v40, v40, v44
    v_add_f32 v41, v41, v45
    v_add_f32 v42, v42, v46
    v_add_f32 v43, v43, v47
    s_waitcnt lgkmcnt(7)
    v_add_f32 v48, v48, v52
    v_add_f32 v49, v49, v53
    v_add_f32 v50, v50, v54
    v_add_f32 v51, v51, v55
    s_waitcnt lgkmcnt(6)
    v_add_f32 v56, v56, v60
    v_add_f32 v57, v57, v61
    v_add_f32 v58, v58, v62
    v_add_f32 v59, v59, v63
    s_waitcnt lgkmcnt(5)
    v_add_f32 v64, v64, v68
    v_add_f32 v65, v65, v69
    v_add_f32 v66, v66, v70
    v_add_f32 v67, v67, v71
    s_waitcnt lgkmcnt(4)
    v_add_f32 v72, v72, v76
    v_add_f32 v73, v73, v77
    v_add_f32 v74, v74, v78
    v_add_f32 v75, v75, v79
    s_waitcnt lgkmcnt(3)
    v_add_f32 v80, v80, v84
    v_add_f32 v81, v81, v85
    v_add_f32 v82, v82, v86
    v_add_f32 v83, v83, v87
    s_waitcnt lgkmcnt(2)
    v_add_f32 v88, v88, v92
    v_add_f32 v89, v89, v93
    v_add_f32 v90, v90, v94
    v_add_f32 v91, v91, v95
    s_waitcnt lgkmcnt(1)
    v_add_f32 v96, v96, v100
    v_add_f32 v97, v97, v101
    v_add_f32 v98, v98, v102
    v_add_f32 v99, v99, v103
    s_waitcnt lgkmcnt(0)
    v_add_f32 v104, v104, v108
    v_add_f32 v105, v105, v109
    v_add_f32 v106, v106, v110
    v_add_f32 v107, v107, v111
    v_cvt_pk_bf16_f32 v184, v41, v49
    v_cvt_pk_bf16_f32 v185, v57, v65
    v_cvt_pk_bf16_f32 v186, v73, v81
    v_cvt_pk_bf16_f32 v187, v89, v97
    buffer_store_dwordx4 v[184:187], v3, s[12:15], s25 offen offset:0 sc1
    v_cvt_pk_bf16_f32 v188, v42, v50
    v_cvt_pk_bf16_f32 v189, v58, v66
    v_cvt_pk_bf16_f32 v190, v74, v82
    v_cvt_pk_bf16_f32 v191, v90, v98
    buffer_store_dwordx4 v[188:191], v3, s[12:15], s26 offen offset:1024 sc1
    v_cvt_pk_bf16_f32 v192, v43, v51
    v_cvt_pk_bf16_f32 v193, v59, v67
    v_cvt_pk_bf16_f32 v194, v75, v83
    v_cvt_pk_bf16_f32 v195, v91, v99
    buffer_store_dwordx4 v[192:195], v3, s[12:15], s27 offen offset:2048 sc1
    v_cvt_pk_bf16_f32 v180, v104, v105
    v_cvt_pk_bf16_f32 v181, v106, v107
    buffer_store_dwordx2 v[180:181], v12, s[12:15], s28 offen sc1
    s_waitcnt vmcnt(4)
    v_dot2_f32_bf16 v40, v160, s59, v40
    v_dot2_f32_bf16 v48, v160, s60, v48
    v_dot2_f32_bf16 v56, v161, s59, v56
    v_dot2_f32_bf16 v64, v161, s60, v64
    v_dot2_f32_bf16 v72, v162, s59, v72
    v_dot2_f32_bf16 v80, v162, s60, v80
    v_dot2_f32_bf16 v88, v163, s59, v88
    v_dot2_f32_bf16 v96, v163, s60, v96
    v_dot2_f32_bf16 v104, v164, s59, v104
    v_dot2_f32_bf16 v105, v164, s60, v105
    v_dot2_f32_bf16 v106, v165, s59, v106
    v_dot2_f32_bf16 v107, v165, s60, v107
    s_mov_b32 s57, 0
    s_waitcnt vmcnt(0)
    s_branch fused_kernel_f_lp2
fused_kernel_f_lp:
    s_sleep 4
    s_branch fused_kernel_f_lp2
    buffer_load_dword v15, v9, s[12:15], 0 offen sc1
    s_add_u32 s57, s57, 1
    s_waitcnt vmcnt(0)
    v_cmp_eq_u32 vcc, -1, v15
    s_cmp_gt_u32 s57, 0x40000
    s_cbranch_scc1 fused_kernel_f_lp2
    s_cbranch_vccnz fused_kernel_f_lp
fused_kernel_f_lp2:
    buffer_load_dwordx4 v[200:203], v3, s[12:15], s36 offen offset:0 sc1
    buffer_load_dwordx4 v[204:207], v3, s[12:15], s36 offen offset:1024 sc1
    buffer_load_dwordx4 v[208:211], v3, s[12:15], s36 offen offset:2048 sc1
    buffer_load_dwordx2 v[212:213], v12, s[12:15], s37 offen offset:0 sc1
    buffer_load_dwordx2 v[214:215], v12, s[12:15], s37 offen offset:512 sc1
    buffer_load_dwordx2 v[216:217], v12, s[12:15], s37 offen offset:1024 sc1
    s_waitcnt vmcnt(0)
fused_kernel_f_ck:
    v_max3_u32 v15, v200, v201, v202
    v_max3_u32 v15, v15, v203, v204
    v_max3_u32 v15, v15, v205, v206
    v_max3_u32 v15, v15, v207, v208
    v_max3_u32 v15, v15, v209, v210
    v_max3_u32 v15, v15, v211, v212
    v_max3_u32 v15, v15, v213, v214
    v_max3_u32 v15, v15, v215, v216
    v_max_u32 v15, v15, v217
    v_cmp_eq_u32 vcc, -1, v15
    s_add_u32 s57, s57, 1
    s_cmp_gt_u32 s57, 0x40000
    s_cbranch_scc1 fused_kernel_f_ok
    s_cbranch_vccnz fused_kernel_f_lp
fused_kernel_f_ok:
    v_dot2_f32_bf16 v40, v200, s59, v40
    v_dot2_f32_bf16 v48, v200, s60, v48
    v_dot2_f32_bf16 v56, v201, s59, v56
    v_dot2_f32_bf16 v64, v201, s60, v64
    v_dot2_f32_bf16 v72, v202, s59, v72
    v_dot2_f32_bf16 v80, v202, s60, v80
    v_dot2_f32_bf16 v88, v203, s59, v88
    v_dot2_f32_bf16 v96, v203, s60, v96
    v_dot2_f32_bf16 v104, v212, s59, v104
    v_dot2_f32_bf16 v105, v212, s60, v105
    v_dot2_f32_bf16 v106, v213, s59, v106
    v_dot2_f32_bf16 v107, v213, s60, v107
    v_dot2_f32_bf16 v40, v204, s59, v40
    v_dot2_f32_bf16 v48, v204, s60, v48
    v_dot2_f32_bf16 v56, v205, s59, v56
    v_dot2_f32_bf16 v64, v205, s60, v64
    v_dot2_f32_bf16 v72, v206, s59, v72
    v_dot2_f32_bf16 v80, v206, s60, v80
    v_dot2_f32_bf16 v88, v207, s59, v88
    v_dot2_f32_bf16 v96, v207, s60, v96
    v_dot2_f32_bf16 v104, v214, s59, v104
    v_dot2_f32_bf16 v105, v214, s60, v105
    v_dot2_f32_bf16 v106, v215, s59, v106
    v_dot2_f32_bf16 v107, v215, s60, v107
    v_dot2_f32_bf16 v40, v208, s59, v40
    v_dot2_f32_bf16 v48, v208, s60, v48
    v_dot2_f32_bf16 v56, v209, s59, v56
    v_dot2_f32_bf16 v64, v209, s60, v64
    v_dot2_f32_bf16 v72, v210, s59, v72
    v_dot2_f32_bf16 v80, v210, s60, v80
    v_dot2_f32_bf16 v88, v211, s59, v88
    v_dot2_f32_bf16 v96, v211, s60, v96
    v_dot2_f32_bf16 v104, v216, s59, v104
    v_dot2_f32_bf16 v105, v216, s60, v105
    v_dot2_f32_bf16 v106, v217, s59, v106
    v_dot2_f32_bf16 v107, v217, s60, v107
    v_cvt_pk_bf16_f32 v180, v40, v48
    v_cvt_pk_bf16_f32 v181, v56, v64
    v_cvt_pk_bf16_f32 v182, v72, v80
    v_cvt_pk_bf16_f32 v183, v88, v96
    v_cvt_pk_bf16_f32 v184, v104, v105
    v_cvt_pk_bf16_f32 v185, v106, v107
    buffer_store_dwordx4 v[180:183], v10, s[16:19], s61 offen
    buffer_store_dwordx2 v[184:185], v11, s[16:19], s62 offen offset:1024
fused_kernel_f_fl:
    s_endpgm
fused_kernel_slow:
    s_nop 15
    v_mov_b32 v21, v235
    v_mov_b32 v16, 0xff7fffff
    v_mov_b32 v137, 0
    s_mov_b32 s36, 0
    v_mov_b32 v32, 0
    v_mov_b32 v33, 0
    v_mov_b32 v34, 0
    v_mov_b32 v35, 0
    v_mov_b32 v36, 0
    v_mov_b32 v37, 0
    v_mov_b32 v38, 0
    v_mov_b32 v39, 0
    v_mov_b32 v40, 0
    v_mov_b32 v41, 0
    v_mov_b32 v42, 0
    v_mov_b32 v43, 0
    v_mov_b32 v44, 0
    v_mov_b32 v45, 0
    v_mov_b32 v46, 0
    v_mov_b32 v47, 0
fused_kernel_sloop:
    s_lshr_b32 s37, s36, 2
    s_mul_i32 s37, s37, 18432
    s_and_b32 s38, s36, 3
    s_lshl_b32 s39, s38, 11
    s_add_u32 s39, s39, s37
    v_add_u32 v18, s39, v3
    s_lshl_b32 s39, s38, 8
    s_add_u32 s39, s39, s37
    v_lshl_add_u32 v19, v2, 2, s39
    s_mul_i32 s39, s38, 2304
    s_add_u32 s39, s39, s37
    v_add_u32 v20, s39, v21
    ds_read_b128 v[128:131], v18
    ds_read_b128 v[132:135], v18 offset:1024
    ds_read_b32 v136, v19 offset:8192
    s_mov_b64 exec, s[28:29]
    ds_read_b128 v[144:147], v20 offset:9216
    ds_read_b128 v[148:151], v20 offset:9792
    ds_read_b128 v[152:155], v20 offset:10368
    ds_read_b128 v[156:159], v20 offset:10944
    s_mov_b64 exec, -1
    s_waitcnt lgkmcnt(0)
    v_mfma_f32_32x32x16_bf16 v[48:63], v[128:131], v[4:7], 0
    v_mfma_f32_32x32x16_bf16 v[64:79], v[132:135], v[4:7], 0
    s_nop 9
    v_mfma_f32_32x32x4_2b_bf16 v[48:79], v[136:137], v[8:9], v[48:79]
    s_nop 15
    s_nop 3
    v_max3_f32 v22, v16, v48, v49
    v_max3_f32 v22, v22, v50, v51
    v_max3_f32 v22, v22, v52, v53
    v_max3_f32 v22, v22, v54, v55
    v_max3_f32 v22, v22, v56, v57
    v_max3_f32 v22, v22, v58, v59
    v_max3_f32 v22, v22, v60, v61
    v_max3_f32 v22, v22, v62, v63
    v_max3_f32 v22, v22, v64, v65
    v_max3_f32 v22, v22, v66, v67
    v_max3_f32 v22, v22, v68, v69
    v_max3_f32 v22, v22, v70, v71
    v_max3_f32 v22, v22, v72, v73
    v_max3_f32 v22, v22, v74, v75
    v_max3_f32 v22, v22, v76, v77
    v_max3_f32 v22, v22, v78, v79
    v_mov_b32 v23, v22
    s_nop 1
    v_permlane32_swap_b32 v22, v23
    v_max_f32 v22, v22, v23
    v_sub_f32 v17, v16, v22
    v_exp_f32 v17, v17
    v_mov_b32 v16, v22
    v_mul_f32 v32, v32, v17
    v_mul_f32 v33, v33, v17
    v_mul_f32 v34, v34, v17
    v_mul_f32 v35, v35, v17
    v_mul_f32 v36, v36, v17
    v_mul_f32 v37, v37, v17
    v_mul_f32 v38, v38, v17
    v_mul_f32 v39, v39, v17
    v_mul_f32 v40, v40, v17
    v_mul_f32 v41, v41, v17
    v_mul_f32 v42, v42, v17
    v_mul_f32 v43, v43, v17
    v_mul_f32 v44, v44, v17
    v_mul_f32 v45, v45, v17
    v_mul_f32 v46, v46, v17
    v_mul_f32 v47, v47, v17
    v_sub_f32 v48, v48, v16
    v_sub_f32 v49, v49, v16
    v_sub_f32 v50, v50, v16
    v_sub_f32 v51, v51, v16
    v_sub_f32 v52, v52, v16
    v_sub_f32 v53, v53, v16
    v_sub_f32 v54, v54, v16
    v_sub_f32 v55, v55, v16
    v_sub_f32 v56, v56, v16
    v_sub_f32 v57, v57, v16
    v_sub_f32 v58, v58, v16
    v_sub_f32 v59, v59, v16
    v_sub_f32 v60, v60, v16
    v_sub_f32 v61, v61, v16
    v_sub_f32 v62, v62, v16
    v_sub_f32 v63, v63, v16
    v_sub_f32 v64, v64, v16
    v_sub_f32 v65, v65, v16
    v_sub_f32 v66, v66, v16
    v_sub_f32 v67, v67, v16
    v_sub_f32 v68, v68, v16
    v_sub_f32 v69, v69, v16
    v_sub_f32 v70, v70, v16
    v_sub_f32 v71, v71, v16
    v_sub_f32 v72, v72, v16
    v_sub_f32 v73, v73, v16
    v_sub_f32 v74, v74, v16
    v_sub_f32 v75, v75, v16
    v_sub_f32 v76, v76, v16
    v_sub_f32 v77, v77, v16
    v_sub_f32 v78, v78, v16
    v_sub_f32 v79, v79, v16
    v_exp_f32 v48, v48
    v_exp_f32 v49, v49
    v_exp_f32 v50, v50
    v_exp_f32 v51, v51
    v_exp_f32 v52, v52
    v_exp_f32 v53, v53
    v_exp_f32 v54, v54
    v_exp_f32 v55, v55
    v_exp_f32 v56, v56
    v_exp_f32 v57, v57
    v_exp_f32 v58, v58
    v_exp_f32 v59, v59
    v_exp_f32 v60, v60
    v_exp_f32 v61, v61
    v_exp_f32 v62, v62
    v_exp_f32 v63, v63
    v_exp_f32 v64, v64
    v_exp_f32 v65, v65
    v_exp_f32 v66, v66
    v_exp_f32 v67, v67
    v_exp_f32 v68, v68
    v_exp_f32 v69, v69
    v_exp_f32 v70, v70
    v_exp_f32 v71, v71
    v_exp_f32 v72, v72
    v_exp_f32 v73, v73
    v_exp_f32 v74, v74
    v_exp_f32 v75, v75
    v_exp_f32 v76, v76
    v_exp_f32 v77, v77
    v_exp_f32 v78, v78
    v_exp_f32 v79, v79
    v_cvt_pk_bf16_f32 v112, v48, v49
    v_cvt_pk_bf16_f32 v113, v50, v51
    v_cvt_pk_bf16_f32 v114, v52, v53
    v_cvt_pk_bf16_f32 v115, v54, v55
    v_cvt_pk_bf16_f32 v116, v56, v57
    v_cvt_pk_bf16_f32 v117, v58, v59
    v_cvt_pk_bf16_f32 v118, v60, v61
    v_cvt_pk_bf16_f32 v119, v62, v63
    v_cvt_pk_bf16_f32 v120, v64, v65
    v_cvt_pk_bf16_f32 v121, v66, v67
    v_cvt_pk_bf16_f32 v122, v68, v69
    v_cvt_pk_bf16_f32 v123, v70, v71
    v_cvt_pk_bf16_f32 v124, v72, v73
    v_cvt_pk_bf16_f32 v125, v74, v75
    v_cvt_pk_bf16_f32 v126, v76, v77
    v_cvt_pk_bf16_f32 v127, v78, v79
    v_mfma_f32_32x32x16_bf16 v[32:47], v[144:147], v[112:115], v[32:47]
    v_mfma_f32_32x32x16_bf16 v[32:47], v[148:151], v[116:119], v[32:47]
    v_mfma_f32_32x32x16_bf16 v[32:47], v[152:155], v[120:123], v[32:47]
    v_mfma_f32_32x32x16_bf16 v[32:47], v[156:159], v[124:127], v[32:47]
    s_add_u32 s36, s36, 1
    s_cmp_lt_u32 s36, 32
    s_nop 12
    s_cbranch_scc1 fused_kernel_sloop
    s_branch fused_kernel_fin
fused_kernel_end:
    s_endpgm
code_end:
    s_endpgm
.section .rodata,"a"
.p2align 6
.amdhsa_kernel fused_kernel
  .amdhsa_next_free_vgpr 256
  .amdhsa_next_free_sgpr 64
  .amdhsa_accum_offset 256
  .amdhsa_group_segment_fixed_size 0
  .amdhsa_kernarg_size 80
  .amdhsa_user_sgpr_count 2
  .amdhsa_user_sgpr_kernarg_segment_ptr 1
  .amdhsa_system_sgpr_workgroup_id_x 1
.end_amdhsa_kernel
```
